```python
import torch

def _softmax(x, axis=-1):
    return torch.softmax(x, dim=axis)
def _gelu(x):
    return torch.nn.functional.gelu(x, approximate="tanh")
def _silu(x):
    return torch.nn.functional.silu(x)
def _sigmoid(x):
    return torch.sigmoid(x)
def _layernorm(x, axis=-1, eps=1e-5):
    m = x.mean(dim=axis, keepdim=True)
    v = x.var(dim=axis, keepdim=True, unbiased=False)
    return (x - m) / torch.sqrt(v + eps)
def _scatter_add(tgt, idx, src, axis=0):
    return tgt.clone().index_add_(axis, idx, src)
def _segment_sum(src, seg, n):
    out = torch.zeros((n,) + src.shape[1:], dtype=src.dtype)
    return out.index_add_(0, seg, src)
def _pad(x, pw):
    flat = tuple(v for pair in reversed(pw) for v in pair)
    return torch.nn.functional.pad(x, flat)

kernel_name = 'concat_heads__mha_block_cached__mha_block_cached__near_ridge'

def setup_inputs():

    _w = (lambda a: (lambda t: t.to(torch.bfloat16) if t.is_floating_point() else t)(torch.as_tensor(a)))
    def _A_setup():
        B, Sq, D = 8, 128, 640
        H, Sk, Dh = 32, 1024, 192
        return {
            "x": _w((lambda *s: torch.randn(*s, dtype=torch.bfloat16) * 0.8)(B, Sq, D)),
            "k_cache": _w((lambda *s: torch.randn(*s, dtype=torch.bfloat16) * 0.8)(B, H, Sk, Dh)),
            "v_cache": _w((lambda *s: torch.randn(*s, dtype=torch.bfloat16) * 0.05)(B, H, Sk, Dh)),
            "wq": _w((lambda *s: torch.randn(*s, dtype=torch.bfloat16) * 0.8)(D, H * Dh) * (D ** -0.5)),
            "wo": _w((lambda *s: torch.randn(*s, dtype=torch.bfloat16) * 0.05)(H * Dh, D) * ((H * Dh) ** -0.5)),
        }
    _A_in = _A_setup()

    def _B_setup():
        B, Sq, D = 8, 128, 640
        H, Sk, Dh = 32, 1024, 192
        return {
            "x": _w((lambda *s: torch.randn(*s, dtype=torch.bfloat16) * 0.8)(B, Sq, D)),
            "k_cache": _w((lambda *s: torch.randn(*s, dtype=torch.bfloat16) * 0.8)(B, H, Sk, Dh)),
            "v_cache": _w((lambda *s: torch.randn(*s, dtype=torch.bfloat16) * 0.05)(B, H, Sk, Dh)),
            "wq": _w((lambda *s: torch.randn(*s, dtype=torch.bfloat16) * 0.8)(D, H * Dh) * (D ** -0.5)),
            "wo": _w((lambda *s: torch.randn(*s, dtype=torch.bfloat16) * 0.05)(H * Dh, D) * ((H * Dh) ** -0.5)),
        }
    _B_in = _B_setup()

    return {
        "A_x": _A_in["x"],
        "A_k_cache": _A_in["k_cache"],
        "A_v_cache": _A_in["v_cache"],
        "A_wq": _A_in["wq"],
        "A_wo": _A_in["wo"],
        "B_x": _B_in["x"],
        "B_k_cache": _B_in["k_cache"],
        "B_v_cache": _B_in["v_cache"],
        "B_wq": _B_in["wq"],
        "B_wo": _B_in["wo"],
    }

def reference(A_x, A_k_cache, A_v_cache, A_wq, A_wo, B_x, B_k_cache, B_v_cache, B_wq, B_wo):
    def _A_ref(x, k_cache, v_cache, wq, wo):
        B, Sq, D = x.shape
        H, Dh = 32, 192
        q = (lambda x, *d: x.permute(*d))((x @ wq).reshape(B, Sq, H, Dh), 0, 2, 1, 3)
        scores = torch.einsum("bhqd,bhkd->bhqk", q, k_cache) * (Dh ** -0.5)
        p = _softmax(scores, axis=-1)
        o = torch.einsum("bhqk,bhkd->bhqd", p, v_cache)
        return (lambda x, *d: x.permute(*d))(o, 0, 2, 1, 3).reshape(B, Sq, H * Dh) @ wo

    def _B_ref(x, k_cache, v_cache, wq, wo):
        B, Sq, D = x.shape
        H, Dh = 32, 192
        q = (lambda x, *d: x.permute(*d))((x @ wq).reshape(B, Sq, H, Dh), 0, 2, 1, 3)
        scores = torch.einsum("bhqd,bhkd->bhqk", q, k_cache) * (Dh ** -0.5)
        p = _softmax(scores, axis=-1)
        o = torch.einsum("bhqk,bhkd->bhqd", p, v_cache)
        return (lambda x, *d: x.permute(*d))(o, 0, 2, 1, 3).reshape(B, Sq, H * Dh) @ wo

    a = _A_ref(A_x, A_k_cache, A_v_cache, A_wq, A_wo)
    b = _B_ref(B_x, B_k_cache, B_v_cache, B_wq, B_wo)
    return torch.concatenate([a, b], axis=-1)
```

```asm
; @launch grid=(256,1,1) block=(512,1,1) lds=163840
.amdgcn_target "amdgcn-amd-amdhsa--gfx950"
.text
.globl concat_heads__mha_block_cached__mha_block_cached__near_ridge_kernel
.p2align 8
.type concat_heads__mha_block_cached__mha_block_cached__near_ridge_kernel,@function
concat_heads__mha_block_cached__mha_block_cached__near_ridge_kernel:
    s_cmp_ge_u32 s2, 256
    s_cbranch_scc1 L_k1_end
    s_and_b32 s3, s2, 7
    s_lshr_b32 s4, s2, 3
    s_lshr_b32 s5, s3, 2
    s_and_b32 s3, s3, 3
    s_lshl_b32 s3, s3, 2
    s_and_b32 s6, s4, 3
    s_add_u32 s90, s6, s3
    s_lshr_b32 s7, s4, 2
    s_mov_b32 s89, s7
    s_mov_b32 s91, s5
    s_lshl_b32 s3, s5, 3
    s_add_u32 s3, s3, s7
    s_lshl_b32 s3, s3, 4
    s_add_u32 s88, s3, s90
    s_mul_i32 s3, s5, 40
    s_add_u32 s0, s0, s3
    s_addc_u32 s1, s1, 0
    s_load_dwordx4 s[44:47], s[0:1], 0
    s_load_dwordx4 s[48:51], s[0:1], 16
    s_load_dwordx2 s[100:101], s[0:1], 32
    s_sub_u32 s0, s0, s3
    s_subb_u32 s1, s1, 0
    s_load_dwordx4 s[52:55], s[0:1], 88
    v_lshrrev_b32 v20, 6, v0
    v_and_b32 v0, 63, v0
    v_readfirstlane_b32 s92, v20
    v_lshrrev_b32 v20, 3, v0
    v_and_b32 v21, 7, v0
    v_lshrrev_b32 v22, 4, v0
    s_and_b32 s28, s92, 3
    s_lshr_b32 s93, s92, 2
    s_lshl_b32 s6, s90, 1
    s_add_u32 s6, s6, s93
    s_mul_i32 s29, s28, 3072
    s_mul_i32 s57, s92, 3072
    s_mul_i32 s30, s93, 12288
    v_mul_u32_u24 v23, 384, v20
    v_add_u32 v23, s29, v23
    s_lshl_b32 s35, s28, 2
    s_and_b32 s35, s35, 4
    v_xor_b32 v24, v21, v22
    v_xor_b32 v25, s35, v24
    v_lshl_add_u32 v1, v25, 4, v23
    v_and_b32 v25, 1, v22
    v_lshlrev_b32 v25, 2, v25
    v_xor_b32 v25, v21, v25
    v_lshrrev_b32 v26, 5, v0
    v_lshlrev_b32 v26, 1, v26
    v_xor_b32 v26, v25, v26
    v_lshl_add_u32 v2, v26, 4, v23
    s_lshl_b32 s35, s28, 3
    v_add_u32 v26, s35, v20
    v_mul_u32_u24 v26, 12288, v26
    s_and_b32 s35, s28, 1
    s_lshl_b32 s35, s35, 1
    v_xor_b32 v25, s35, v25
    v_lshl_add_u32 v3, v25, 4, v26
    s_lshl_b32 s35, s28, 5
    v_add_u32 v26, s35, v20
    v_mul_u32_u24 v26, 1280, v26
    v_lshl_add_u32 v4, v24, 4, v26
    v_xor_b32 v24, 4, v24
    v_lshl_add_u32 v5, v24, 4, v26
    v_add_u32 v5, 10240, v5
    v_and_b32 v20, 31, v0
    v_lshrrev_b32 v21, 5, v0
    v_bfe_u32 v22, v20, 1, 3
    v_xor_b32 v22, v22, v21
    v_lshlrev_b32 v22, 4, v22
    v_lshl_add_u32 v23, v20, 7, v22
    s_lshl_b32 s56, s28, 12
    s_add_u32 s56, s56, 122880
    v_and_b32 v26, 15, v0
    v_lshrrev_b32 v27, 4, v0
    v_lshrrev_b32 v28, 1, v26
    v_xor_b32 v28, v28, v27
    v_lshlrev_b32 v28, 4, v28
    v_lshl_add_u32 v28, v26, 7, v28
    v_add_u32 v12, s56, v28
    v_xor_b32 v13, 64, v12
    s_lshl_b32 s35, s93, 11
    s_add_u32 s56, s56, s35
    v_lshrrev_b32 v23, 3, v26
    v_mul_u32_u24 v23, 2048, v23
    v_add3_u32 v6, v28, v23, s30
    v_xor_b32 v7, 64, v6
    v_bfe_u32 v22, v0, 2, 2
    v_mul_u32_u24 v23, 3072, v21
    v_lshl_add_u32 v23, v22, 7, v23
    v_lshrrev_b32 v22, 1, v22
    v_lshl_add_u32 v23, v22, 6, v23
    v_and_b32 v22, 1, v27
    v_mul_u32_u24 v22, 544, v22
    v_add_u32 v23, v22, v23
    v_and_b32 v22, 3, v0
    v_lshl_add_u32 v23, v22, 3, v23
    v_add_u32 v23, 73728, v23
    v_add_u32 v8, s30, v23
    v_xor_b32 v9, 32, v8
    v_xor_b32 v10, 64, v8
    v_xor_b32 v11, 96, v8
    v_bfe_u32 v22, v0, 2, 2
    v_mul_u32_u24 v23, 3072, v27
    v_lshl_add_u32 v23, v22, 7, v23
    v_lshrrev_b32 v22, 1, v22
    v_lshl_add_u32 v23, v22, 6, v23
    v_and_b32 v22, 1, v27
    v_lshl_add_u32 v23, v22, 5, v23
    v_and_b32 v22, 3, v0
    v_lshl_add_u32 v23, v22, 3, v23
    s_mul_i32 s35, s93, 12288
    v_add_u32 v124, s35, v23
    v_xor_b32 v125, 32, v124
    v_xor_b32 v126, 64, v124
    v_xor_b32 v127, 96, v124
    v_add_u32 v128, 49152, v124
    v_add_u32 v129, 49152, v125
    v_add_u32 v130, 49152, v126
    v_add_u32 v131, 49152, v127
    s_add_u32 s29, s29, s30
    s_mov_b32 s59, 0x7f000000
    s_waitcnt lgkmcnt(0)
    s_lshl_b32 s3, s7, 5
    s_add_u32 s3, s3, s6
    s_mul_i32 s3, s3, 393216
    s_add_u32 s46, s46, s3
    s_addc_u32 s47, s47, 0
    s_add_u32 s48, s48, s3
    s_addc_u32 s49, s49, 0
    s_mov_b32 s8, s46
    s_and_b32 s9, s47, 0xffff
    s_mov_b32 s10, 393216
    s_mov_b32 s11, 0x00020000
    s_mov_b32 s12, s48
    s_and_b32 s13, s49, 0xffff
    s_mov_b32 s14, 393216
    s_mov_b32 s15, 0x00020000
    s_mul_i32 s3, s6, 384
    s_add_u32 s50, s50, s3
    s_addc_u32 s51, s51, 0
    s_sub_u32 s4, 7864320, s3
    s_mov_b32 s16, s50
    s_and_b32 s17, s51, 0xffff
    s_mov_b32 s18, s4
    s_mov_b32 s19, 0x00020000
    s_mul_i32 s3, s7, 163840
    s_add_u32 s44, s44, s3
    s_addc_u32 s45, s45, 0
    s_mov_b32 s20, s44
    s_and_b32 s21, s45, 0xffff
    s_mov_b32 s22, 163840
    s_mov_b32 s23, 0x00020000
    s_mov_b32 s24, s54
    s_and_b32 s25, s55, 0xffff
    s_mov_b32 s26, 41943040
    s_mov_b32 s27, 0x00020000
    s_mul_i32 s3, s90, 491520
    s_add_u32 s100, s100, s3
    s_addc_u32 s101, s101, 0
    s_mov_b32 s40, s52
    s_and_b32 s41, s53, 0xffff
    s_mov_b32 s42, 256
    s_mov_b32 s43, 0x00020000
    s_add_u32 s3, s54, 41943040
    s_addc_u32 s4, s55, 0
    s_mov_b32 s84, s3
    s_and_b32 s85, s4, 0xffff
    s_mov_b32 s86, 65536
    s_mov_b32 s87, 0x00020000
    s_mov_b32 s34, 0x3dd53b95
    s_mul_i32 s83, s6, 0
    s_mul_i32 s3, s7, 0
    s_add_u32 s83, s83, s3
    s_mul_i32 s3, s5, 0
    s_add_u32 s83, s83, s3
    s_and_b32 s83, s83, 31
    s_mul_i32 s99, s83, 12288
    s_add_u32 s3, s83, 2
    s_and_b32 s3, s3, 31
    s_mul_i32 s31, s3, 12288
    s_add_u32 s3, s83, 1
    s_and_b32 s3, s3, 31
    s_mul_i32 s32, s3, 12288
    s_mul_i32 s39, s93, 20480
    s_cmp_eq_u32 s92, 0
    s_cselect_b32 s94, 0, s59
    s_lshl_b32 s3, s88, 8
    s_add_u32 s3, s3, s94
    v_mov_b32 v48, 0
    v_lshlrev_b32 v49, 2, v0
    buffer_store_dword v48, v49, s[84:87], s3 offen sc0 sc1
    s_mov_b32 s35, 0
    s_add_u32 m0, s57, 49152
    s_nop 0
    buffer_load_dwordx4 v3, s[16:19], s35 offen offset:0  lds
    s_add_u32 m0, s57, 50048
    s_nop 0
    buffer_load_dwordx4 v3, s[16:19], s35 offen offset:128  lds
    s_add_u32 m0, s57, 50944
    s_nop 0
    buffer_load_dwordx4 v3, s[16:19], s35 offen offset:256  lds
    s_add_u32 m0, s56, 0
    s_nop 0
    buffer_load_dwordx4 v4, s[20:23], s39 offen offset:0  lds
    s_add_u32 m0, s56, 1024
    s_nop 0
    buffer_load_dwordx4 v5, s[20:23], s39 offen offset:0  lds
    s_mov_b32 s35, 393216
    s_add_u32 m0, s57, 73728
    s_nop 0
    buffer_load_dwordx4 v3, s[16:19], s35 offen offset:0  lds
    s_add_u32 m0, s57, 74624
    s_nop 0
    buffer_load_dwordx4 v3, s[16:19], s35 offen offset:128  lds
    s_add_u32 m0, s57, 75520
    s_nop 0
    buffer_load_dwordx4 v3, s[16:19], s35 offen offset:256  lds
    s_mov_b32 s35, 786432
    s_add_u32 m0, s57, 98304
    s_nop 0
    buffer_load_dwordx4 v3, s[16:19], s35 offen offset:0  lds
    s_add_u32 m0, s57, 99200
    s_nop 0
    buffer_load_dwordx4 v3, s[16:19], s35 offen offset:128  lds
    s_add_u32 m0, s57, 100096
    s_nop 0
    buffer_load_dwordx4 v3, s[16:19], s35 offen offset:256  lds
    s_add_u32 m0, s56, 16256
    s_nop 0
    buffer_load_dwordx4 v4, s[20:23], s39 offen offset:128  lds
    s_add_u32 m0, s56, 17280
    s_nop 0
    buffer_load_dwordx4 v5, s[20:23], s39 offen offset:128  lds
    s_mov_b32 s35, 1179648
    s_add_u32 m0, s57, 0
    s_nop 0
    buffer_load_dwordx4 v3, s[16:19], s35 offen offset:0  lds
    s_add_u32 m0, s57, 896
    s_nop 0
    buffer_load_dwordx4 v3, s[16:19], s35 offen offset:128  lds
    s_add_u32 m0, s57, 1792
    s_nop 0
    buffer_load_dwordx4 v3, s[16:19], s35 offen offset:256  lds
    s_mov_b32 s35, 1572864
    s_add_u32 m0, s57, 24576
    s_nop 0
    buffer_load_dwordx4 v3, s[16:19], s35 offen offset:0  lds
    s_add_u32 m0, s57, 25472
    s_nop 0
    buffer_load_dwordx4 v3, s[16:19], s35 offen offset:128  lds
    s_add_u32 m0, s57, 26368
    s_nop 0
    buffer_load_dwordx4 v3, s[16:19], s35 offen offset:256  lds
    s_add_u32 s36, s83, 0
    s_and_b32 s36, s36, 31
    s_mul_i32 s36, s36, 12288
    buffer_load_dwordx4 v[88:91], v1, s[8:11], s36 offen offset:0 sc1 nt
    s_add_u32 s36, s83, 0
    s_and_b32 s36, s36, 31
    s_mul_i32 s36, s36, 12288
    buffer_load_dwordx4 v[92:95], v1, s[8:11], s36 offen offset:128 sc1 nt
    s_add_u32 s36, s83, 0
    s_and_b32 s36, s36, 31
    s_mul_i32 s36, s36, 12288
    buffer_load_dwordx4 v[96:99], v1, s[8:11], s36 offen offset:256 sc1 nt
    s_add_u32 s36, s83, 1
    s_and_b32 s36, s36, 31
    s_mul_i32 s36, s36, 12288
    buffer_load_dwordx4 v[100:103], v1, s[8:11], s36 offen offset:0 sc1 nt
    s_add_u32 s36, s83, 1
    s_and_b32 s36, s36, 31
    s_mul_i32 s36, s36, 12288
    buffer_load_dwordx4 v[104:107], v1, s[8:11], s36 offen offset:128 sc1 nt
    s_add_u32 s36, s83, 1
    s_and_b32 s36, s36, 31
    s_mul_i32 s36, s36, 12288
    buffer_load_dwordx4 v[108:111], v1, s[8:11], s36 offen offset:256 sc1 nt
    s_add_u32 s36, s83, 0
    s_and_b32 s36, s36, 31
    s_mul_i32 s36, s36, 12288
    buffer_load_dwordx4 v[112:115], v2, s[12:15], s36 offen offset:0 sc1 nt
    s_add_u32 s36, s83, 0
    s_and_b32 s36, s36, 31
    s_mul_i32 s36, s36, 12288
    buffer_load_dwordx4 v[116:119], v2, s[12:15], s36 offen offset:128 sc1 nt
    s_add_u32 s36, s83, 0
    s_and_b32 s36, s36, 31
    s_mul_i32 s36, s36, 12288
    buffer_load_dwordx4 v[120:123], v2, s[12:15], s36 offen offset:256 sc1 nt
    s_waitcnt vmcnt(23) lgkmcnt(0)
    s_barrier
    s_mov_b64 exec, 1
    v_mov_b32 v159, 1
    buffer_atomic_add v159, off, s[40:43], s94 offset:252 sc1
    s_mov_b64 exec, -1
    s_nop 1
    ds_read_b128 v[16:19], v12 offset:0
    ds_read_b128 v[20:23], v12 offset:2048
    ds_read_b128 v[24:27], v13 offset:0
    ds_read_b128 v[28:31], v13 offset:2048
    ds_read_b64_tr_b16 v[48:49], v128 offset:0
    ds_read_b64_tr_b16 v[50:51], v128 offset:512
    ds_read_b64_tr_b16 v[52:53], v129 offset:0
    ds_read_b64_tr_b16 v[54:55], v129 offset:512
    ds_read_b64_tr_b16 v[56:57], v130 offset:0
    ds_read_b64_tr_b16 v[58:59], v130 offset:512
    ds_read_b64_tr_b16 v[60:61], v131 offset:0
    ds_read_b64_tr_b16 v[62:63], v131 offset:512
    ds_read_b64_tr_b16 v[64:65], v128 offset:1024
    ds_read_b64_tr_b16 v[66:67], v128 offset:1536
    s_waitcnt lgkmcnt(8)
    v_mfma_f32_16x16x32_bf16 v[160:163], v[48:51], v[16:19], 0
    ds_read_b64_tr_b16 v[68:69], v129 offset:1024
    v_mfma_f32_16x16x32_bf16 v[164:167], v[48:51], v[20:23], 0
    ds_read_b64_tr_b16 v[70:71], v129 offset:1536
    s_waitcnt lgkmcnt(8)
    v_mfma_f32_16x16x32_bf16 v[168:171], v[52:55], v[16:19], 0
    ds_read_b64_tr_b16 v[72:73], v130 offset:1024
    v_mfma_f32_16x16x32_bf16 v[172:175], v[52:55], v[20:23], 0
    ds_read_b64_tr_b16 v[74:75], v130 offset:1536
    s_waitcnt lgkmcnt(8)
    v_mfma_f32_16x16x32_bf16 v[176:179], v[56:59], v[16:19], 0
    ds_read_b64_tr_b16 v[76:77], v131 offset:1024
    v_mfma_f32_16x16x32_bf16 v[180:183], v[56:59], v[20:23], 0
    ds_read_b64_tr_b16 v[78:79], v131 offset:1536
    s_waitcnt lgkmcnt(8)
    v_mfma_f32_16x16x32_bf16 v[184:187], v[60:63], v[16:19], 0
    ds_read_b64_tr_b16 v[80:81], v128 offset:2048
    v_mfma_f32_16x16x32_bf16 v[188:191], v[60:63], v[20:23], 0
    ds_read_b64_tr_b16 v[82:83], v128 offset:2560
    s_waitcnt lgkmcnt(8)
    v_mfma_f32_16x16x32_bf16 v[192:195], v[64:67], v[16:19], 0
    ds_read_b64_tr_b16 v[48:49], v129 offset:2048
    v_mfma_f32_16x16x32_bf16 v[196:199], v[64:67], v[20:23], 0
    ds_read_b64_tr_b16 v[50:51], v129 offset:2560
    s_waitcnt lgkmcnt(8)
    v_mfma_f32_16x16x32_bf16 v[200:203], v[68:71], v[16:19], 0
    ds_read_b64_tr_b16 v[52:53], v130 offset:2048
    v_mfma_f32_16x16x32_bf16 v[204:207], v[68:71], v[20:23], 0
    ds_read_b64_tr_b16 v[54:55], v130 offset:2560
    s_waitcnt lgkmcnt(8)
    v_mfma_f32_16x16x32_bf16 v[208:211], v[72:75], v[16:19], 0
    ds_read_b64_tr_b16 v[56:57], v131 offset:2048
    v_mfma_f32_16x16x32_bf16 v[212:215], v[72:75], v[20:23], 0
    ds_read_b64_tr_b16 v[58:59], v131 offset:2560
    s_waitcnt lgkmcnt(8)
    v_mfma_f32_16x16x32_bf16 v[216:219], v[76:79], v[16:19], 0
    v_mfma_f32_16x16x32_bf16 v[220:223], v[76:79], v[20:23], 0
    s_waitcnt vmcnt(21) lgkmcnt(0)
    s_barrier
    v_mfma_f32_16x16x32_bf16 v[224:227], v[80:83], v[16:19], 0
    ds_read_b64_tr_b16 v[60:61], v128 offset:24576
    ds_read_b64_tr_b16 v[62:63], v128 offset:25088
    ds_read_b64_tr_b16 v[64:65], v129 offset:24576
    ds_read_b64_tr_b16 v[66:67], v129 offset:25088
    v_mfma_f32_16x16x32_bf16 v[228:231], v[80:83], v[20:23], 0
    s_mov_b32 s35, 1966080
    s_add_u32 m0, s57, 49152
    s_nop 0
    buffer_load_dwordx4 v3, s[16:19], s35 offen offset:0  lds
    v_mfma_f32_16x16x32_bf16 v[232:235], v[48:51], v[16:19], 0
    ds_read_b64_tr_b16 v[68:69], v130 offset:24576
    ds_read_b64_tr_b16 v[70:71], v130 offset:25088
    ds_read_b64_tr_b16 v[72:73], v131 offset:24576
    ds_read_b64_tr_b16 v[74:75], v131 offset:25088
    v_mfma_f32_16x16x32_bf16 v[236:239], v[48:51], v[20:23], 0
    s_add_u32 m0, s57, 50048
    s_nop 0
    buffer_load_dwordx4 v3, s[16:19], s35 offen offset:128  lds
    v_mfma_f32_16x16x32_bf16 v[240:243], v[52:55], v[16:19], 0
    ds_read_b64_tr_b16 v[76:77], v128 offset:25600
    ds_read_b64_tr_b16 v[78:79], v128 offset:26112
    ds_read_b64_tr_b16 v[80:81], v129 offset:25600
    ds_read_b64_tr_b16 v[82:83], v129 offset:26112
    v_mfma_f32_16x16x32_bf16 v[244:247], v[52:55], v[20:23], 0
    s_add_u32 m0, s57, 50944
    s_nop 0
    buffer_load_dwordx4 v3, s[16:19], s35 offen offset:256  lds
    v_mfma_f32_16x16x32_bf16 v[248:251], v[56:59], v[16:19], 0
    ds_read_b64_tr_b16 v[48:49], v130 offset:25600
    ds_read_b64_tr_b16 v[50:51], v130 offset:26112
    s_add_u32 m0, s56, -256
    v_mfma_f32_16x16x32_bf16 v[252:255], v[56:59], v[20:23], 0
    s_nop 0
    buffer_load_dwordx4 v4, s[20:23], s39 offen offset:256  lds
    s_waitcnt lgkmcnt(12)
    v_mfma_f32_16x16x32_bf16 v[160:163], v[60:63], v[24:27], v[160:163]
    ds_read_b64_tr_b16 v[52:53], v131 offset:25600
    ds_read_b64_tr_b16 v[54:55], v131 offset:26112
    s_add_u32 m0, s56, 768
    v_mfma_f32_16x16x32_bf16 v[164:167], v[60:63], v[28:31], v[164:167]
    s_nop 0
    buffer_load_dwordx4 v5, s[20:23], s39 offen offset:256  lds
    s_waitcnt lgkmcnt(12)
    v_mfma_f32_16x16x32_bf16 v[168:171], v[64:67], v[24:27], v[168:171]
    ds_read_b64_tr_b16 v[56:57], v128 offset:26624
    v_mfma_f32_16x16x32_bf16 v[172:175], v[64:67], v[28:31], v[172:175]
    ds_read_b64_tr_b16 v[58:59], v128 offset:27136
    s_waitcnt lgkmcnt(12)
    v_mfma_f32_16x16x32_bf16 v[176:179], v[68:71], v[24:27], v[176:179]
    ds_read_b64_tr_b16 v[60:61], v129 offset:26624
    v_mfma_f32_16x16x32_bf16 v[180:183], v[68:71], v[28:31], v[180:183]
    ds_read_b64_tr_b16 v[62:63], v129 offset:27136
    s_waitcnt lgkmcnt(12)
    v_mfma_f32_16x16x32_bf16 v[184:187], v[72:75], v[24:27], v[184:187]
    ds_read_b64_tr_b16 v[64:65], v130 offset:26624
    v_mfma_f32_16x16x32_bf16 v[188:191], v[72:75], v[28:31], v[188:191]
    ds_read_b64_tr_b16 v[66:67], v130 offset:27136
    s_waitcnt lgkmcnt(12)
    v_mfma_f32_16x16x32_bf16 v[192:195], v[76:79], v[24:27], v[192:195]
    ds_read_b64_tr_b16 v[68:69], v131 offset:26624
    v_mfma_f32_16x16x32_bf16 v[196:199], v[76:79], v[28:31], v[196:199]
    ds_read_b64_tr_b16 v[70:71], v131 offset:27136
    s_waitcnt lgkmcnt(12)
    v_mfma_f32_16x16x32_bf16 v[200:203], v[80:83], v[24:27], v[200:203]
    v_mfma_f32_16x16x32_bf16 v[204:207], v[80:83], v[28:31], v[204:207]
    s_waitcnt lgkmcnt(10)
    v_mfma_f32_16x16x32_bf16 v[208:211], v[48:51], v[24:27], v[208:211]
    v_mfma_f32_16x16x32_bf16 v[212:215], v[48:51], v[28:31], v[212:215]
    s_waitcnt lgkmcnt(8)
    v_mfma_f32_16x16x32_bf16 v[216:219], v[52:55], v[24:27], v[216:219]
    v_mfma_f32_16x16x32_bf16 v[220:223], v[52:55], v[28:31], v[220:223]
    s_waitcnt vmcnt(21) lgkmcnt(0)
    s_barrier
    v_mfma_f32_16x16x32_bf16 v[224:227], v[56:59], v[24:27], v[224:227]
    ds_read_b128 v[32:35], v12 offset:16384
    ds_read_b128 v[36:39], v12 offset:18432
    ds_read_b128 v[40:43], v13 offset:16384
    ds_read_b128 v[44:47], v13 offset:18432
    ds_read_b64_tr_b16 v[72:73], v128 offset:49152
    ds_read_b64_tr_b16 v[74:75], v128 offset:49664
    v_mfma_f32_16x16x32_bf16 v[228:231], v[56:59], v[28:31], v[228:231]
    ds_read_b64_tr_b16 v[76:77], v129 offset:49152
    ds_read_b64_tr_b16 v[78:79], v129 offset:49664
    s_mov_b32 s35, 2359296
    s_add_u32 m0, s57, 73728
    s_nop 0
    buffer_load_dwordx4 v3, s[16:19], s35 offen offset:0  lds
    v_mfma_f32_16x16x32_bf16 v[232:235], v[60:63], v[24:27], v[232:235]
    ds_read_b64_tr_b16 v[80:81], v130 offset:49152
    ds_read_b64_tr_b16 v[82:83], v130 offset:49664
    ds_read_b64_tr_b16 v[48:49], v131 offset:49152
    ds_read_b64_tr_b16 v[50:51], v131 offset:49664
    v_mfma_f32_16x16x32_bf16 v[236:239], v[60:63], v[28:31], v[236:239]
    s_add_u32 m0, s57, 74624
    s_nop 0
    buffer_load_dwordx4 v3, s[16:19], s35 offen offset:128  lds
    v_mfma_f32_16x16x32_bf16 v[240:243], v[64:67], v[24:27], v[240:243]
    ds_read_b64_tr_b16 v[52:53], v128 offset:50176
    v_mfma_f32_16x16x32_bf16 v[244:247], v[64:67], v[28:31], v[244:247]
    ds_read_b64_tr_b16 v[54:55], v128 offset:50688
    s_waitcnt lgkmcnt(13)
    ds_read_b64_tr_b16 v[56:57], v129 offset:50176
    ds_read_b64_tr_b16 v[58:59], v129 offset:50688
    s_add_u32 m0, s57, 75520
    s_nop 0
    buffer_load_dwordx4 v3, s[16:19], s35 offen offset:256  lds
    v_mfma_f32_16x16x32_bf16 v[248:251], v[68:71], v[24:27], v[248:251]
    v_mfma_f32_16x16x32_bf16 v[252:255], v[68:71], v[28:31], v[252:255]
    s_waitcnt lgkmcnt(13)
    ds_read_b64_tr_b16 v[60:61], v130 offset:50176
    ds_read_b64_tr_b16 v[62:63], v130 offset:50688
    s_waitcnt lgkmcnt(12)
    v_mfma_f32_16x16x32_bf16 v[160:163], v[72:75], v[32:35], v[160:163]
    ds_read_b64_tr_b16 v[64:65], v131 offset:50176
    v_mfma_f32_16x16x32_bf16 v[164:167], v[72:75], v[36:39], v[164:167]
    ds_read_b64_tr_b16 v[66:67], v131 offset:50688
    s_waitcnt lgkmcnt(12)
    v_mfma_f32_16x16x32_bf16 v[168:171], v[76:79], v[32:35], v[168:171]
    ds_read_b64_tr_b16 v[68:69], v128 offset:51200
    v_mfma_f32_16x16x32_bf16 v[172:175], v[76:79], v[36:39], v[172:175]
    ds_read_b64_tr_b16 v[70:71], v128 offset:51712
    s_waitcnt lgkmcnt(12)
    v_mfma_f32_16x16x32_bf16 v[176:179], v[80:83], v[32:35], v[176:179]
    ds_read_b64_tr_b16 v[72:73], v129 offset:51200
    v_mfma_f32_16x16x32_bf16 v[180:183], v[80:83], v[36:39], v[180:183]
    ds_read_b64_tr_b16 v[74:75], v129 offset:51712
    s_waitcnt lgkmcnt(12)
    v_mfma_f32_16x16x32_bf16 v[184:187], v[48:51], v[32:35], v[184:187]
    ds_read_b64_tr_b16 v[76:77], v130 offset:51200
    v_mfma_f32_16x16x32_bf16 v[188:191], v[48:51], v[36:39], v[188:191]
    ds_read_b64_tr_b16 v[78:79], v130 offset:51712
    s_waitcnt lgkmcnt(12)
    v_mfma_f32_16x16x32_bf16 v[192:195], v[52:55], v[32:35], v[192:195]
    ds_read_b64_tr_b16 v[80:81], v131 offset:51200
    v_mfma_f32_16x16x32_bf16 v[196:199], v[52:55], v[36:39], v[196:199]
    ds_read_b64_tr_b16 v[82:83], v131 offset:51712
    s_waitcnt lgkmcnt(12)
    v_mfma_f32_16x16x32_bf16 v[200:203], v[56:59], v[32:35], v[200:203]
    v_mfma_f32_16x16x32_bf16 v[204:207], v[56:59], v[36:39], v[204:207]
    s_waitcnt lgkmcnt(10)
    v_mfma_f32_16x16x32_bf16 v[208:211], v[60:63], v[32:35], v[208:211]
    v_mfma_f32_16x16x32_bf16 v[212:215], v[60:63], v[36:39], v[212:215]
    s_waitcnt lgkmcnt(8)
    v_mfma_f32_16x16x32_bf16 v[216:219], v[64:67], v[32:35], v[216:219]
    v_mfma_f32_16x16x32_bf16 v[220:223], v[64:67], v[36:39], v[220:223]
    s_waitcnt vmcnt(21) lgkmcnt(0)
    s_barrier
    v_mfma_f32_16x16x32_bf16 v[224:227], v[68:71], v[32:35], v[224:227]
    ds_read_b64_tr_b16 v[48:49], v124 offset:0
    ds_read_b64_tr_b16 v[50:51], v124 offset:512
    ds_read_b64_tr_b16 v[52:53], v125 offset:0
    ds_read_b64_tr_b16 v[54:55], v125 offset:512
    v_mfma_f32_16x16x32_bf16 v[228:231], v[68:71], v[36:39], v[228:231]
    s_mov_b32 s35, 2752512
    s_add_u32 m0, s57, 98304
    s_nop 0
    buffer_load_dwordx4 v3, s[16:19], s35 offen offset:0  lds
    v_mfma_f32_16x16x32_bf16 v[232:235], v[72:75], v[32:35], v[232:235]
    ds_read_b64_tr_b16 v[56:57], v126 offset:0
    ds_read_b64_tr_b16 v[58:59], v126 offset:512
    ds_read_b64_tr_b16 v[60:61], v127 offset:0
    ds_read_b64_tr_b16 v[62:63], v127 offset:512
    v_mfma_f32_16x16x32_bf16 v[236:239], v[72:75], v[36:39], v[236:239]
    s_add_u32 m0, s57, 99200
    s_nop 0
    buffer_load_dwordx4 v3, s[16:19], s35 offen offset:128  lds
    v_mfma_f32_16x16x32_bf16 v[240:243], v[76:79], v[32:35], v[240:243]
    ds_read_b64_tr_b16 v[64:65], v124 offset:1024
    ds_read_b64_tr_b16 v[66:67], v124 offset:1536
    ds_read_b64_tr_b16 v[68:69], v125 offset:1024
    ds_read_b64_tr_b16 v[70:71], v125 offset:1536
    v_mfma_f32_16x16x32_bf16 v[244:247], v[76:79], v[36:39], v[244:247]
    s_add_u32 m0, s57, 100096
    s_nop 0
    buffer_load_dwordx4 v3, s[16:19], s35 offen offset:256  lds
    v_mfma_f32_16x16x32_bf16 v[248:251], v[80:83], v[32:35], v[248:251]
    ds_read_b64_tr_b16 v[72:73], v126 offset:1024
    ds_read_b64_tr_b16 v[74:75], v126 offset:1536
    s_add_u32 m0, s56, 16000
    v_mfma_f32_16x16x32_bf16 v[252:255], v[80:83], v[36:39], v[252:255]
    s_nop 0
    buffer_load_dwordx4 v4, s[20:23], s39 offen offset:384  lds
    s_waitcnt lgkmcnt(12)
    v_mfma_f32_16x16x32_bf16 v[160:163], v[48:51], v[40:43], v[160:163]
    ds_read_b64_tr_b16 v[76:77], v127 offset:1024
    ds_read_b64_tr_b16 v[78:79], v127 offset:1536
    s_add_u32 m0, s56, 17024
    v_mfma_f32_16x16x32_bf16 v[164:167], v[48:51], v[44:47], v[164:167]
    s_nop 0
    buffer_load_dwordx4 v5, s[20:23], s39 offen offset:384  lds
    s_waitcnt lgkmcnt(12)
    v_mfma_f32_16x16x32_bf16 v[168:171], v[52:55], v[40:43], v[168:171]
    ds_read_b64_tr_b16 v[80:81], v124 offset:2048
    v_mfma_f32_16x16x32_bf16 v[172:175], v[52:55], v[44:47], v[172:175]
    ds_read_b64_tr_b16 v[82:83], v124 offset:2560
    s_waitcnt lgkmcnt(12)
    v_mfma_f32_16x16x32_bf16 v[176:179], v[56:59], v[40:43], v[176:179]
    ds_read_b64_tr_b16 v[48:49], v125 offset:2048
    v_mfma_f32_16x16x32_bf16 v[180:183], v[56:59], v[44:47], v[180:183]
    ds_read_b64_tr_b16 v[50:51], v125 offset:2560
    s_waitcnt lgkmcnt(12)
    v_mfma_f32_16x16x32_bf16 v[184:187], v[60:63], v[40:43], v[184:187]
    ds_read_b64_tr_b16 v[52:53], v126 offset:2048
    v_mfma_f32_16x16x32_bf16 v[188:191], v[60:63], v[44:47], v[188:191]
    ds_read_b64_tr_b16 v[54:55], v126 offset:2560
    s_waitcnt lgkmcnt(12)
    v_mfma_f32_16x16x32_bf16 v[192:195], v[64:67], v[40:43], v[192:195]
    ds_read_b64_tr_b16 v[56:57], v127 offset:2048
    v_mfma_f32_16x16x32_bf16 v[196:199], v[64:67], v[44:47], v[196:199]
    ds_read_b64_tr_b16 v[58:59], v127 offset:2560
    s_waitcnt lgkmcnt(12)
    v_mfma_f32_16x16x32_bf16 v[200:203], v[68:71], v[40:43], v[200:203]
    v_mfma_f32_16x16x32_bf16 v[204:207], v[68:71], v[44:47], v[204:207]
    s_waitcnt lgkmcnt(10)
    v_mfma_f32_16x16x32_bf16 v[208:211], v[72:75], v[40:43], v[208:211]
    v_mfma_f32_16x16x32_bf16 v[212:215], v[72:75], v[44:47], v[212:215]
    s_waitcnt lgkmcnt(8)
    v_mfma_f32_16x16x32_bf16 v[216:219], v[76:79], v[40:43], v[216:219]
    v_mfma_f32_16x16x32_bf16 v[220:223], v[76:79], v[44:47], v[220:223]
    s_waitcnt vmcnt(8) lgkmcnt(0)
    s_barrier
    v_mfma_f32_16x16x32_bf16 v[224:227], v[80:83], v[40:43], v[224:227]
    ds_read_b128 v[16:19], v12 offset:0
    ds_read_b128 v[20:23], v12 offset:2048
    ds_read_b128 v[24:27], v13 offset:0
    ds_read_b128 v[28:31], v13 offset:2048
    ds_read_b64_tr_b16 v[60:61], v124 offset:24576
    ds_read_b64_tr_b16 v[62:63], v124 offset:25088
    v_mfma_f32_16x16x32_bf16 v[228:231], v[80:83], v[44:47], v[228:231]
    ds_read_b64_tr_b16 v[64:65], v125 offset:24576
    ds_read_b64_tr_b16 v[66:67], v125 offset:25088
    s_mov_b32 s35, 3145728
    s_add_u32 m0, s57, 0
    s_nop 0
    buffer_load_dwordx4 v3, s[16:19], s35 offen offset:0  lds
    v_mfma_f32_16x16x32_bf16 v[232:235], v[48:51], v[40:43], v[232:235]
    ds_read_b64_tr_b16 v[68:69], v126 offset:24576
    ds_read_b64_tr_b16 v[70:71], v126 offset:25088
    ds_read_b64_tr_b16 v[72:73], v127 offset:24576
    ds_read_b64_tr_b16 v[74:75], v127 offset:25088
    v_mfma_f32_16x16x32_bf16 v[236:239], v[48:51], v[44:47], v[236:239]
    s_add_u32 m0, s57, 896
    s_nop 0
    buffer_load_dwordx4 v3, s[16:19], s35 offen offset:128  lds
    v_mfma_f32_16x16x32_bf16 v[240:243], v[52:55], v[40:43], v[240:243]
    ds_read_b64_tr_b16 v[76:77], v124 offset:25600
    v_mfma_f32_16x16x32_bf16 v[244:247], v[52:55], v[44:47], v[244:247]
    ds_read_b64_tr_b16 v[78:79], v124 offset:26112
    s_waitcnt lgkmcnt(13)
    ds_read_b64_tr_b16 v[80:81], v125 offset:25600
    ds_read_b64_tr_b16 v[82:83], v125 offset:26112
    s_add_u32 m0, s57, 1792
    s_nop 0
    buffer_load_dwordx4 v3, s[16:19], s35 offen offset:256  lds
    v_mfma_f32_16x16x32_bf16 v[248:251], v[56:59], v[40:43], v[248:251]
    v_mfma_f32_16x16x32_bf16 v[252:255], v[56:59], v[44:47], v[252:255]
    s_waitcnt lgkmcnt(13)
    ds_read_b64_tr_b16 v[48:49], v126 offset:25600
    ds_read_b64_tr_b16 v[50:51], v126 offset:26112
    s_waitcnt lgkmcnt(12)
    v_mfma_f32_16x16x32_bf16 v[160:163], v[60:63], v[16:19], v[160:163]
    ds_read_b64_tr_b16 v[52:53], v127 offset:25600
    v_mfma_f32_16x16x32_bf16 v[164:167], v[60:63], v[20:23], v[164:167]
    ds_read_b64_tr_b16 v[54:55], v127 offset:26112
    s_waitcnt lgkmcnt(12)
    v_mfma_f32_16x16x32_bf16 v[168:171], v[64:67], v[16:19], v[168:171]
    ds_read_b64_tr_b16 v[56:57], v124 offset:26624
    v_mfma_f32_16x16x32_bf16 v[172:175], v[64:67], v[20:23], v[172:175]
    ds_read_b64_tr_b16 v[58:59], v124 offset:27136
    s_waitcnt lgkmcnt(12)
    v_mfma_f32_16x16x32_bf16 v[176:179], v[68:71], v[16:19], v[176:179]
    ds_read_b64_tr_b16 v[60:61], v125 offset:26624
    v_mfma_f32_16x16x32_bf16 v[180:183], v[68:71], v[20:23], v[180:183]
    ds_read_b64_tr_b16 v[62:63], v125 offset:27136
    s_waitcnt lgkmcnt(12)
    v_mfma_f32_16x16x32_bf16 v[184:187], v[72:75], v[16:19], v[184:187]
    ds_read_b64_tr_b16 v[64:65], v126 offset:26624
    v_mfma_f32_16x16x32_bf16 v[188:191], v[72:75], v[20:23], v[188:191]
    ds_read_b64_tr_b16 v[66:67], v126 offset:27136
    s_waitcnt lgkmcnt(12)
    v_mfma_f32_16x16x32_bf16 v[192:195], v[76:79], v[16:19], v[192:195]
    ds_read_b64_tr_b16 v[68:69], v127 offset:26624
    v_mfma_f32_16x16x32_bf16 v[196:199], v[76:79], v[20:23], v[196:199]
    ds_read_b64_tr_b16 v[70:71], v127 offset:27136
    s_waitcnt lgkmcnt(12)
    v_mfma_f32_16x16x32_bf16 v[200:203], v[80:83], v[16:19], v[200:203]
    v_mfma_f32_16x16x32_bf16 v[204:207], v[80:83], v[20:23], v[204:207]
    s_waitcnt lgkmcnt(10)
    v_mfma_f32_16x16x32_bf16 v[208:211], v[48:51], v[16:19], v[208:211]
    v_mfma_f32_16x16x32_bf16 v[212:215], v[48:51], v[20:23], v[212:215]
    s_waitcnt lgkmcnt(8)
    v_mfma_f32_16x16x32_bf16 v[216:219], v[52:55], v[16:19], v[216:219]
    v_mfma_f32_16x16x32_bf16 v[220:223], v[52:55], v[20:23], v[220:223]
    s_waitcnt vmcnt(11) lgkmcnt(0)
    s_barrier
    v_mfma_f32_16x16x32_bf16 v[224:227], v[56:59], v[16:19], v[224:227]
    ds_read_b64_tr_b16 v[72:73], v128 offset:0
    ds_read_b64_tr_b16 v[74:75], v128 offset:512
    ds_read_b64_tr_b16 v[76:77], v129 offset:0
    ds_read_b64_tr_b16 v[78:79], v129 offset:512
    v_mfma_f32_16x16x32_bf16 v[228:231], v[56:59], v[20:23], v[228:231]
    s_mov_b32 s35, 3538944
    s_add_u32 m0, s57, 24576
    s_nop 0
    buffer_load_dwordx4 v3, s[16:19], s35 offen offset:0  lds
    v_mfma_f32_16x16x32_bf16 v[232:235], v[60:63], v[16:19], v[232:235]
    ds_read_b64_tr_b16 v[80:81], v130 offset:0
    ds_read_b64_tr_b16 v[82:83], v130 offset:512
    ds_read_b64_tr_b16 v[48:49], v131 offset:0
    ds_read_b64_tr_b16 v[50:51], v131 offset:512
    v_mfma_f32_16x16x32_bf16 v[236:239], v[60:63], v[20:23], v[236:239]
    s_add_u32 m0, s57, 25472
    s_nop 0
    buffer_load_dwordx4 v3, s[16:19], s35 offen offset:128  lds
    v_mfma_f32_16x16x32_bf16 v[240:243], v[64:67], v[16:19], v[240:243]
    ds_read_b64_tr_b16 v[52:53], v128 offset:1024
    ds_read_b64_tr_b16 v[54:55], v128 offset:1536
    ds_read_b64_tr_b16 v[56:57], v129 offset:1024
    ds_read_b64_tr_b16 v[58:59], v129 offset:1536
    v_mfma_f32_16x16x32_bf16 v[244:247], v[64:67], v[20:23], v[244:247]
    s_add_u32 m0, s57, 26368
    s_nop 0
    buffer_load_dwordx4 v3, s[16:19], s35 offen offset:256  lds
    v_mfma_f32_16x16x32_bf16 v[248:251], v[68:71], v[16:19], v[248:251]
    ds_read_b64_tr_b16 v[60:61], v130 offset:1024
    ds_read_b64_tr_b16 v[62:63], v130 offset:1536
    s_add_u32 m0, s56, -512
    v_mfma_f32_16x16x32_bf16 v[252:255], v[68:71], v[20:23], v[252:255]
    s_nop 0
    buffer_load_dwordx4 v4, s[20:23], s39 offen offset:512  lds
    s_waitcnt lgkmcnt(12)
    v_mfma_f32_16x16x32_bf16 v[160:163], v[72:75], v[24:27], v[160:163]
    ds_read_b64_tr_b16 v[64:65], v131 offset:1024
    ds_read_b64_tr_b16 v[66:67], v131 offset:1536
    s_add_u32 m0, s56, 512
    v_mfma_f32_16x16x32_bf16 v[164:167], v[72:75], v[28:31], v[164:167]
    s_nop 0
    buffer_load_dwordx4 v5, s[20:23], s39 offen offset:512  lds
    s_waitcnt lgkmcnt(12)
    v_mfma_f32_16x16x32_bf16 v[168:171], v[76:79], v[24:27], v[168:171]
    ds_read_b64_tr_b16 v[68:69], v128 offset:2048
    v_mfma_f32_16x16x32_bf16 v[172:175], v[76:79], v[28:31], v[172:175]
    ds_read_b64_tr_b16 v[70:71], v128 offset:2560
    s_waitcnt lgkmcnt(12)
    v_mfma_f32_16x16x32_bf16 v[176:179], v[80:83], v[24:27], v[176:179]
    ds_read_b64_tr_b16 v[72:73], v129 offset:2048
    v_mfma_f32_16x16x32_bf16 v[180:183], v[80:83], v[28:31], v[180:183]
    ds_read_b64_tr_b16 v[74:75], v129 offset:2560
    s_waitcnt lgkmcnt(12)
    v_mfma_f32_16x16x32_bf16 v[184:187], v[48:51], v[24:27], v[184:187]
    ds_read_b64_tr_b16 v[76:77], v130 offset:2048
    v_mfma_f32_16x16x32_bf16 v[188:191], v[48:51], v[28:31], v[188:191]
    ds_read_b64_tr_b16 v[78:79], v130 offset:2560
    s_waitcnt lgkmcnt(12)
    v_mfma_f32_16x16x32_bf16 v[192:195], v[52:55], v[24:27], v[192:195]
    ds_read_b64_tr_b16 v[80:81], v131 offset:2048
    v_mfma_f32_16x16x32_bf16 v[196:199], v[52:55], v[28:31], v[196:199]
    ds_read_b64_tr_b16 v[82:83], v131 offset:2560
    s_waitcnt lgkmcnt(12)
    v_mfma_f32_16x16x32_bf16 v[200:203], v[56:59], v[24:27], v[200:203]
    v_mfma_f32_16x16x32_bf16 v[204:207], v[56:59], v[28:31], v[204:207]
    s_waitcnt lgkmcnt(10)
    v_mfma_f32_16x16x32_bf16 v[208:211], v[60:63], v[24:27], v[208:211]
    v_mfma_f32_16x16x32_bf16 v[212:215], v[60:63], v[28:31], v[212:215]
    s_waitcnt lgkmcnt(8)
    v_mfma_f32_16x16x32_bf16 v[216:219], v[64:67], v[24:27], v[216:219]
    v_mfma_f32_16x16x32_bf16 v[220:223], v[64:67], v[28:31], v[220:223]
    s_waitcnt vmcnt(8) lgkmcnt(0)
    s_barrier
    v_mfma_f32_16x16x32_bf16 v[224:227], v[68:71], v[24:27], v[224:227]
    ds_read_b128 v[32:35], v12 offset:16384
    ds_read_b128 v[36:39], v12 offset:18432
    ds_read_b128 v[40:43], v13 offset:16384
    ds_read_b128 v[44:47], v13 offset:18432
    ds_read_b64_tr_b16 v[48:49], v128 offset:24576
    ds_read_b64_tr_b16 v[50:51], v128 offset:25088
    v_mfma_f32_16x16x32_bf16 v[228:231], v[68:71], v[28:31], v[228:231]
    ds_read_b64_tr_b16 v[52:53], v129 offset:24576
    ds_read_b64_tr_b16 v[54:55], v129 offset:25088
    s_mov_b32 s35, 3932160
    s_add_u32 m0, s57, 49152
    s_nop 0
    buffer_load_dwordx4 v3, s[16:19], s35 offen offset:0  lds
    v_mfma_f32_16x16x32_bf16 v[232:235], v[72:75], v[24:27], v[232:235]
    ds_read_b64_tr_b16 v[56:57], v130 offset:24576
    ds_read_b64_tr_b16 v[58:59], v130 offset:25088
    ds_read_b64_tr_b16 v[60:61], v131 offset:24576
    ds_read_b64_tr_b16 v[62:63], v131 offset:25088
    v_mfma_f32_16x16x32_bf16 v[236:239], v[72:75], v[28:31], v[236:239]
    s_add_u32 m0, s57, 50048
    s_nop 0
    buffer_load_dwordx4 v3, s[16:19], s35 offen offset:128  lds
    v_mfma_f32_16x16x32_bf16 v[240:243], v[76:79], v[24:27], v[240:243]
    ds_read_b64_tr_b16 v[64:65], v128 offset:25600
    v_mfma_f32_16x16x32_bf16 v[244:247], v[76:79], v[28:31], v[244:247]
    ds_read_b64_tr_b16 v[66:67], v128 offset:26112
    s_waitcnt lgkmcnt(13)
    ds_read_b64_tr_b16 v[68:69], v129 offset:25600
    ds_read_b64_tr_b16 v[70:71], v129 offset:26112
    s_add_u32 m0, s57, 50944
    s_nop 0
    buffer_load_dwordx4 v3, s[16:19], s35 offen offset:256  lds
    v_mfma_f32_16x16x32_bf16 v[248:251], v[80:83], v[24:27], v[248:251]
    v_mfma_f32_16x16x32_bf16 v[252:255], v[80:83], v[28:31], v[252:255]
    s_waitcnt lgkmcnt(13)
    ds_read_b64_tr_b16 v[72:73], v130 offset:25600
    ds_read_b64_tr_b16 v[74:75], v130 offset:26112
    s_waitcnt lgkmcnt(12)
    v_mfma_f32_16x16x32_bf16 v[160:163], v[48:51], v[32:35], v[160:163]
    ds_read_b64_tr_b16 v[76:77], v131 offset:25600
    v_mfma_f32_16x16x32_bf16 v[164:167], v[48:51], v[36:39], v[164:167]
    ds_read_b64_tr_b16 v[78:79], v131 offset:26112
    s_waitcnt lgkmcnt(12)
    v_mfma_f32_16x16x32_bf16 v[168:171], v[52:55], v[32:35], v[168:171]
    ds_read_b64_tr_b16 v[80:81], v128 offset:26624
    v_mfma_f32_16x16x32_bf16 v[172:175], v[52:55], v[36:39], v[172:175]
    ds_read_b64_tr_b16 v[82:83], v128 offset:27136
    s_waitcnt lgkmcnt(12)
    v_mfma_f32_16x16x32_bf16 v[176:179], v[56:59], v[32:35], v[176:179]
    ds_read_b64_tr_b16 v[48:49], v129 offset:26624
    v_mfma_f32_16x16x32_bf16 v[180:183], v[56:59], v[36:39], v[180:183]
    ds_read_b64_tr_b16 v[50:51], v129 offset:27136
    s_waitcnt lgkmcnt(12)
    v_mfma_f32_16x16x32_bf16 v[184:187], v[60:63], v[32:35], v[184:187]
    ds_read_b64_tr_b16 v[52:53], v130 offset:26624
    v_mfma_f32_16x16x32_bf16 v[188:191], v[60:63], v[36:39], v[188:191]
    ds_read_b64_tr_b16 v[54:55], v130 offset:27136
    s_waitcnt lgkmcnt(12)
    v_mfma_f32_16x16x32_bf16 v[192:195], v[64:67], v[32:35], v[192:195]
    ds_read_b64_tr_b16 v[56:57], v131 offset:26624
    v_mfma_f32_16x16x32_bf16 v[196:199], v[64:67], v[36:39], v[196:199]
    ds_read_b64_tr_b16 v[58:59], v131 offset:27136
    s_waitcnt lgkmcnt(12)
    v_mfma_f32_16x16x32_bf16 v[200:203], v[68:71], v[32:35], v[200:203]
    v_mfma_f32_16x16x32_bf16 v[204:207], v[68:71], v[36:39], v[204:207]
    s_waitcnt lgkmcnt(10)
    v_mfma_f32_16x16x32_bf16 v[208:211], v[72:75], v[32:35], v[208:211]
    v_mfma_f32_16x16x32_bf16 v[212:215], v[72:75], v[36:39], v[212:215]
    s_waitcnt lgkmcnt(8)
    v_mfma_f32_16x16x32_bf16 v[216:219], v[76:79], v[32:35], v[216:219]
    v_mfma_f32_16x16x32_bf16 v[220:223], v[76:79], v[36:39], v[220:223]
    s_waitcnt vmcnt(11) lgkmcnt(0)
    s_barrier
    v_mfma_f32_16x16x32_bf16 v[224:227], v[80:83], v[32:35], v[224:227]
    ds_read_b64_tr_b16 v[60:61], v128 offset:49152
    ds_read_b64_tr_b16 v[62:63], v128 offset:49664
    ds_read_b64_tr_b16 v[64:65], v129 offset:49152
    ds_read_b64_tr_b16 v[66:67], v129 offset:49664
    v_mfma_f32_16x16x32_bf16 v[228:231], v[80:83], v[36:39], v[228:231]
    s_mov_b32 s35, 4325376
    s_add_u32 m0, s57, 73728
    s_nop 0
    buffer_load_dwordx4 v3, s[16:19], s35 offen offset:0  lds
    v_mfma_f32_16x16x32_bf16 v[232:235], v[48:51], v[32:35], v[232:235]
    ds_read_b64_tr_b16 v[68:69], v130 offset:49152
    ds_read_b64_tr_b16 v[70:71], v130 offset:49664
    ds_read_b64_tr_b16 v[72:73], v131 offset:49152
    ds_read_b64_tr_b16 v[74:75], v131 offset:49664
    v_mfma_f32_16x16x32_bf16 v[236:239], v[48:51], v[36:39], v[236:239]
    s_add_u32 m0, s57, 74624
    s_nop 0
    buffer_load_dwordx4 v3, s[16:19], s35 offen offset:128  lds
    v_mfma_f32_16x16x32_bf16 v[240:243], v[52:55], v[32:35], v[240:243]
    ds_read_b64_tr_b16 v[76:77], v128 offset:50176
    ds_read_b64_tr_b16 v[78:79], v128 offset:50688
    ds_read_b64_tr_b16 v[80:81], v129 offset:50176
    ds_read_b64_tr_b16 v[82:83], v129 offset:50688
    v_mfma_f32_16x16x32_bf16 v[244:247], v[52:55], v[36:39], v[244:247]
    s_add_u32 m0, s57, 75520
    s_nop 0
    buffer_load_dwordx4 v3, s[16:19], s35 offen offset:256  lds
    v_mfma_f32_16x16x32_bf16 v[248:251], v[56:59], v[32:35], v[248:251]
    ds_read_b64_tr_b16 v[48:49], v130 offset:50176
    ds_read_b64_tr_b16 v[50:51], v130 offset:50688
    s_add_u32 m0, s56, 15744
    v_mfma_f32_16x16x32_bf16 v[252:255], v[56:59], v[36:39], v[252:255]
    s_nop 0
    buffer_load_dwordx4 v4, s[20:23], s39 offen offset:640  lds
    s_waitcnt lgkmcnt(12)
    v_mfma_f32_16x16x32_bf16 v[160:163], v[60:63], v[40:43], v[160:163]
    ds_read_b64_tr_b16 v[52:53], v131 offset:50176
    ds_read_b64_tr_b16 v[54:55], v131 offset:50688
    s_add_u32 m0, s56, 16768
    v_mfma_f32_16x16x32_bf16 v[164:167], v[60:63], v[44:47], v[164:167]
    s_nop 0
    buffer_load_dwordx4 v5, s[20:23], s39 offen offset:640  lds
    s_waitcnt lgkmcnt(12)
    v_mfma_f32_16x16x32_bf16 v[168:171], v[64:67], v[40:43], v[168:171]
    ds_read_b64_tr_b16 v[56:57], v128 offset:51200
    v_mfma_f32_16x16x32_bf16 v[172:175], v[64:67], v[44:47], v[172:175]
    ds_read_b64_tr_b16 v[58:59], v128 offset:51712
    s_waitcnt lgkmcnt(12)
    v_mfma_f32_16x16x32_bf16 v[176:179], v[68:71], v[40:43], v[176:179]
    ds_read_b64_tr_b16 v[60:61], v129 offset:51200
    v_mfma_f32_16x16x32_bf16 v[180:183], v[68:71], v[44:47], v[180:183]
    ds_read_b64_tr_b16 v[62:63], v129 offset:51712
    s_waitcnt lgkmcnt(12)
    v_mfma_f32_16x16x32_bf16 v[184:187], v[72:75], v[40:43], v[184:187]
    ds_read_b64_tr_b16 v[64:65], v130 offset:51200
    v_mfma_f32_16x16x32_bf16 v[188:191], v[72:75], v[44:47], v[188:191]
    ds_read_b64_tr_b16 v[66:67], v130 offset:51712
    s_waitcnt lgkmcnt(12)
    v_mfma_f32_16x16x32_bf16 v[192:195], v[76:79], v[40:43], v[192:195]
    ds_read_b64_tr_b16 v[68:69], v131 offset:51200
    v_mfma_f32_16x16x32_bf16 v[196:199], v[76:79], v[44:47], v[196:199]
    ds_read_b64_tr_b16 v[70:71], v131 offset:51712
    s_waitcnt lgkmcnt(12)
    v_mfma_f32_16x16x32_bf16 v[200:203], v[80:83], v[40:43], v[200:203]
    v_mfma_f32_16x16x32_bf16 v[204:207], v[80:83], v[44:47], v[204:207]
    s_waitcnt lgkmcnt(10)
    v_mfma_f32_16x16x32_bf16 v[208:211], v[48:51], v[40:43], v[208:211]
    v_mfma_f32_16x16x32_bf16 v[212:215], v[48:51], v[44:47], v[212:215]
    s_waitcnt lgkmcnt(8)
    v_mfma_f32_16x16x32_bf16 v[216:219], v[52:55], v[40:43], v[216:219]
    v_mfma_f32_16x16x32_bf16 v[220:223], v[52:55], v[44:47], v[220:223]
    s_waitcnt vmcnt(8) lgkmcnt(0)
    s_barrier
    v_mfma_f32_16x16x32_bf16 v[224:227], v[56:59], v[40:43], v[224:227]
    ds_read_b128 v[16:19], v12 offset:0
    ds_read_b128 v[20:23], v12 offset:2048
    ds_read_b128 v[24:27], v13 offset:0
    ds_read_b128 v[28:31], v13 offset:2048
    ds_read_b64_tr_b16 v[72:73], v124 offset:0
    ds_read_b64_tr_b16 v[74:75], v124 offset:512
    v_mfma_f32_16x16x32_bf16 v[228:231], v[56:59], v[44:47], v[228:231]
    ds_read_b64_tr_b16 v[76:77], v125 offset:0
    ds_read_b64_tr_b16 v[78:79], v125 offset:512
    s_mov_b32 s35, 4718592
    s_add_u32 m0, s57, 98304
    s_nop 0
    buffer_load_dwordx4 v3, s[16:19], s35 offen offset:0  lds
    v_mfma_f32_16x16x32_bf16 v[232:235], v[60:63], v[40:43], v[232:235]
    ds_read_b64_tr_b16 v[80:81], v126 offset:0
    ds_read_b64_tr_b16 v[82:83], v126 offset:512
    ds_read_b64_tr_b16 v[48:49], v127 offset:0
    ds_read_b64_tr_b16 v[50:51], v127 offset:512
    v_mfma_f32_16x16x32_bf16 v[236:239], v[60:63], v[44:47], v[236:239]
    s_add_u32 m0, s57, 99200
    s_nop 0
    buffer_load_dwordx4 v3, s[16:19], s35 offen offset:128  lds
    v_mfma_f32_16x16x32_bf16 v[240:243], v[64:67], v[40:43], v[240:243]
    ds_read_b64_tr_b16 v[52:53], v124 offset:1024
    v_mfma_f32_16x16x32_bf16 v[244:247], v[64:67], v[44:47], v[244:247]
    ds_read_b64_tr_b16 v[54:55], v124 offset:1536
    s_waitcnt lgkmcnt(13)
    ds_read_b64_tr_b16 v[56:57], v125 offset:1024
    ds_read_b64_tr_b16 v[58:59], v125 offset:1536
    s_add_u32 m0, s57, 100096
    s_nop 0
    buffer_load_dwordx4 v3, s[16:19], s35 offen offset:256  lds
    v_mfma_f32_16x16x32_bf16 v[248:251], v[68:71], v[40:43], v[248:251]
    v_mfma_f32_16x16x32_bf16 v[252:255], v[68:71], v[44:47], v[252:255]
    s_waitcnt lgkmcnt(13)
    ds_read_b64_tr_b16 v[60:61], v126 offset:1024
    ds_read_b64_tr_b16 v[62:63], v126 offset:1536
    s_waitcnt lgkmcnt(12)
    v_mfma_f32_16x16x32_bf16 v[160:163], v[72:75], v[16:19], v[160:163]
    ds_read_b64_tr_b16 v[64:65], v127 offset:1024
    v_mfma_f32_16x16x32_bf16 v[164:167], v[72:75], v[20:23], v[164:167]
    ds_read_b64_tr_b16 v[66:67], v127 offset:1536
    s_waitcnt lgkmcnt(12)
    v_mfma_f32_16x16x32_bf16 v[168:171], v[76:79], v[16:19], v[168:171]
    ds_read_b64_tr_b16 v[68:69], v124 offset:2048
    v_mfma_f32_16x16x32_bf16 v[172:175], v[76:79], v[20:23], v[172:175]
    ds_read_b64_tr_b16 v[70:71], v124 offset:2560
    s_waitcnt lgkmcnt(12)
    v_mfma_f32_16x16x32_bf16 v[176:179], v[80:83], v[16:19], v[176:179]
    ds_read_b64_tr_b16 v[72:73], v125 offset:2048
    v_mfma_f32_16x16x32_bf16 v[180:183], v[80:83], v[20:23], v[180:183]
    ds_read_b64_tr_b16 v[74:75], v125 offset:2560
    s_waitcnt lgkmcnt(12)
    v_mfma_f32_16x16x32_bf16 v[184:187], v[48:51], v[16:19], v[184:187]
    ds_read_b64_tr_b16 v[76:77], v126 offset:2048
    v_mfma_f32_16x16x32_bf16 v[188:191], v[48:51], v[20:23], v[188:191]
    ds_read_b64_tr_b16 v[78:79], v126 offset:2560
    s_waitcnt lgkmcnt(12)
    v_mfma_f32_16x16x32_bf16 v[192:195], v[52:55], v[16:19], v[192:195]
    ds_read_b64_tr_b16 v[80:81], v127 offset:2048
    v_mfma_f32_16x16x32_bf16 v[196:199], v[52:55], v[20:23], v[196:199]
    ds_read_b64_tr_b16 v[82:83], v127 offset:2560
    s_waitcnt lgkmcnt(12)
    v_mfma_f32_16x16x32_bf16 v[200:203], v[56:59], v[16:19], v[200:203]
    v_mfma_f32_16x16x32_bf16 v[204:207], v[56:59], v[20:23], v[204:207]
    s_waitcnt lgkmcnt(10)
    v_mfma_f32_16x16x32_bf16 v[208:211], v[60:63], v[16:19], v[208:211]
    v_mfma_f32_16x16x32_bf16 v[212:215], v[60:63], v[20:23], v[212:215]
    s_waitcnt lgkmcnt(8)
    v_mfma_f32_16x16x32_bf16 v[216:219], v[64:67], v[16:19], v[216:219]
    v_mfma_f32_16x16x32_bf16 v[220:223], v[64:67], v[20:23], v[220:223]
    s_waitcnt vmcnt(11) lgkmcnt(0)
    s_barrier
    v_mfma_f32_16x16x32_bf16 v[224:227], v[68:71], v[16:19], v[224:227]
    ds_read_b64_tr_b16 v[48:49], v124 offset:24576
    ds_read_b64_tr_b16 v[50:51], v124 offset:25088
    ds_read_b64_tr_b16 v[52:53], v125 offset:24576
    ds_read_b64_tr_b16 v[54:55], v125 offset:25088
    v_mfma_f32_16x16x32_bf16 v[228:231], v[68:71], v[20:23], v[228:231]
    s_mov_b32 s35, 5111808
    s_add_u32 m0, s57, 0
    s_nop 0
    buffer_load_dwordx4 v3, s[16:19], s35 offen offset:0  lds
    v_mfma_f32_16x16x32_bf16 v[232:235], v[72:75], v[16:19], v[232:235]
    ds_read_b64_tr_b16 v[56:57], v126 offset:24576
    ds_read_b64_tr_b16 v[58:59], v126 offset:25088
    ds_read_b64_tr_b16 v[60:61], v127 offset:24576
    ds_read_b64_tr_b16 v[62:63], v127 offset:25088
    v_mfma_f32_16x16x32_bf16 v[236:239], v[72:75], v[20:23], v[236:239]
    s_add_u32 m0, s57, 896
    s_nop 0
    buffer_load_dwordx4 v3, s[16:19], s35 offen offset:128  lds
    v_mfma_f32_16x16x32_bf16 v[240:243], v[76:79], v[16:19], v[240:243]
    ds_read_b64_tr_b16 v[64:65], v124 offset:25600
    ds_read_b64_tr_b16 v[66:67], v124 offset:26112
    ds_read_b64_tr_b16 v[68:69], v125 offset:25600
    ds_read_b64_tr_b16 v[70:71], v125 offset:26112
    v_mfma_f32_16x16x32_bf16 v[244:247], v[76:79], v[20:23], v[244:247]
    s_add_u32 m0, s57, 1792
    s_nop 0
    buffer_load_dwordx4 v3, s[16:19], s35 offen offset:256  lds
    v_mfma_f32_16x16x32_bf16 v[248:251], v[80:83], v[16:19], v[248:251]
    ds_read_b64_tr_b16 v[72:73], v126 offset:25600
    ds_read_b64_tr_b16 v[74:75], v126 offset:26112
    s_add_u32 m0, s56, -768
    v_mfma_f32_16x16x32_bf16 v[252:255], v[80:83], v[20:23], v[252:255]
    s_nop 0
    buffer_load_dwordx4 v4, s[20:23], s39 offen offset:768  lds
    s_waitcnt lgkmcnt(12)
    v_mfma_f32_16x16x32_bf16 v[160:163], v[48:51], v[24:27], v[160:163]
    ds_read_b64_tr_b16 v[76:77], v127 offset:25600
    ds_read_b64_tr_b16 v[78:79], v127 offset:26112
    s_add_u32 m0, s56, 256
    v_mfma_f32_16x16x32_bf16 v[164:167], v[48:51], v[28:31], v[164:167]
    s_nop 0
    buffer_load_dwordx4 v5, s[20:23], s39 offen offset:768  lds
    s_waitcnt lgkmcnt(12)
    v_mfma_f32_16x16x32_bf16 v[168:171], v[52:55], v[24:27], v[168:171]
    ds_read_b64_tr_b16 v[80:81], v124 offset:26624
    v_mfma_f32_16x16x32_bf16 v[172:175], v[52:55], v[28:31], v[172:175]
    ds_read_b64_tr_b16 v[82:83], v124 offset:27136
    s_waitcnt lgkmcnt(12)
    v_mfma_f32_16x16x32_bf16 v[176:179], v[56:59], v[24:27], v[176:179]
    ds_read_b64_tr_b16 v[48:49], v125 offset:26624
    v_mfma_f32_16x16x32_bf16 v[180:183], v[56:59], v[28:31], v[180:183]
    ds_read_b64_tr_b16 v[50:51], v125 offset:27136
    s_waitcnt lgkmcnt(12)
    v_mfma_f32_16x16x32_bf16 v[184:187], v[60:63], v[24:27], v[184:187]
    ds_read_b64_tr_b16 v[52:53], v126 offset:26624
    v_mfma_f32_16x16x32_bf16 v[188:191], v[60:63], v[28:31], v[188:191]
    ds_read_b64_tr_b16 v[54:55], v126 offset:27136
    s_waitcnt lgkmcnt(12)
    v_mfma_f32_16x16x32_bf16 v[192:195], v[64:67], v[24:27], v[192:195]
    ds_read_b64_tr_b16 v[56:57], v127 offset:26624
    v_mfma_f32_16x16x32_bf16 v[196:199], v[64:67], v[28:31], v[196:199]
    ds_read_b64_tr_b16 v[58:59], v127 offset:27136
    s_waitcnt lgkmcnt(12)
    v_mfma_f32_16x16x32_bf16 v[200:203], v[68:71], v[24:27], v[200:203]
    v_mfma_f32_16x16x32_bf16 v[204:207], v[68:71], v[28:31], v[204:207]
    s_waitcnt lgkmcnt(10)
    v_mfma_f32_16x16x32_bf16 v[208:211], v[72:75], v[24:27], v[208:211]
    v_mfma_f32_16x16x32_bf16 v[212:215], v[72:75], v[28:31], v[212:215]
    s_waitcnt lgkmcnt(8)
    v_mfma_f32_16x16x32_bf16 v[216:219], v[76:79], v[24:27], v[216:219]
    v_mfma_f32_16x16x32_bf16 v[220:223], v[76:79], v[28:31], v[220:223]
    s_waitcnt vmcnt(8) lgkmcnt(0)
    s_barrier
    v_mfma_f32_16x16x32_bf16 v[224:227], v[80:83], v[24:27], v[224:227]
    ds_read_b128 v[32:35], v12 offset:16384
    ds_read_b128 v[36:39], v12 offset:18432
    ds_read_b128 v[40:43], v13 offset:16384
    ds_read_b128 v[44:47], v13 offset:18432
    ds_read_b64_tr_b16 v[60:61], v128 offset:0
    ds_read_b64_tr_b16 v[62:63], v128 offset:512
    v_mfma_f32_16x16x32_bf16 v[228:231], v[80:83], v[28:31], v[228:231]
    ds_read_b64_tr_b16 v[64:65], v129 offset:0
    ds_read_b64_tr_b16 v[66:67], v129 offset:512
    s_mov_b32 s35, 5505024
    s_add_u32 m0, s57, 24576
    s_nop 0
    buffer_load_dwordx4 v3, s[16:19], s35 offen offset:0  lds
    v_mfma_f32_16x16x32_bf16 v[232:235], v[48:51], v[24:27], v[232:235]
    ds_read_b64_tr_b16 v[68:69], v130 offset:0
    ds_read_b64_tr_b16 v[70:71], v130 offset:512
    ds_read_b64_tr_b16 v[72:73], v131 offset:0
    ds_read_b64_tr_b16 v[74:75], v131 offset:512
    v_mfma_f32_16x16x32_bf16 v[236:239], v[48:51], v[28:31], v[236:239]
    s_add_u32 m0, s57, 25472
    s_nop 0
    buffer_load_dwordx4 v3, s[16:19], s35 offen offset:128  lds
    v_mfma_f32_16x16x32_bf16 v[240:243], v[52:55], v[24:27], v[240:243]
    ds_read_b64_tr_b16 v[76:77], v128 offset:1024
    v_mfma_f32_16x16x32_bf16 v[244:247], v[52:55], v[28:31], v[244:247]
    ds_read_b64_tr_b16 v[78:79], v128 offset:1536
    s_waitcnt lgkmcnt(13)
    ds_read_b64_tr_b16 v[80:81], v129 offset:1024
    ds_read_b64_tr_b16 v[82:83], v129 offset:1536
    s_add_u32 m0, s57, 26368
    s_nop 0
    buffer_load_dwordx4 v3, s[16:19], s35 offen offset:256  lds
    v_mfma_f32_16x16x32_bf16 v[248:251], v[56:59], v[24:27], v[248:251]
    v_mfma_f32_16x16x32_bf16 v[252:255], v[56:59], v[28:31], v[252:255]
    s_waitcnt lgkmcnt(13)
    ds_read_b64_tr_b16 v[48:49], v130 offset:1024
    ds_read_b64_tr_b16 v[50:51], v130 offset:1536
    s_waitcnt lgkmcnt(12)
    v_mfma_f32_16x16x32_bf16 v[160:163], v[60:63], v[32:35], v[160:163]
    ds_read_b64_tr_b16 v[52:53], v131 offset:1024
    v_mfma_f32_16x16x32_bf16 v[164:167], v[60:63], v[36:39], v[164:167]
    ds_read_b64_tr_b16 v[54:55], v131 offset:1536
    s_waitcnt lgkmcnt(12)
    v_mfma_f32_16x16x32_bf16 v[168:171], v[64:67], v[32:35], v[168:171]
    ds_read_b64_tr_b16 v[56:57], v128 offset:2048
    v_mfma_f32_16x16x32_bf16 v[172:175], v[64:67], v[36:39], v[172:175]
    ds_read_b64_tr_b16 v[58:59], v128 offset:2560
    s_waitcnt lgkmcnt(12)
    v_mfma_f32_16x16x32_bf16 v[176:179], v[68:71], v[32:35], v[176:179]
    ds_read_b64_tr_b16 v[60:61], v129 offset:2048
    v_mfma_f32_16x16x32_bf16 v[180:183], v[68:71], v[36:39], v[180:183]
    ds_read_b64_tr_b16 v[62:63], v129 offset:2560
    s_waitcnt lgkmcnt(12)
    v_mfma_f32_16x16x32_bf16 v[184:187], v[72:75], v[32:35], v[184:187]
    ds_read_b64_tr_b16 v[64:65], v130 offset:2048
    v_mfma_f32_16x16x32_bf16 v[188:191], v[72:75], v[36:39], v[188:191]
    ds_read_b64_tr_b16 v[66:67], v130 offset:2560
    s_waitcnt lgkmcnt(12)
    v_mfma_f32_16x16x32_bf16 v[192:195], v[76:79], v[32:35], v[192:195]
    ds_read_b64_tr_b16 v[68:69], v131 offset:2048
    v_mfma_f32_16x16x32_bf16 v[196:199], v[76:79], v[36:39], v[196:199]
    ds_read_b64_tr_b16 v[70:71], v131 offset:2560
    s_waitcnt lgkmcnt(12)
    v_mfma_f32_16x16x32_bf16 v[200:203], v[80:83], v[32:35], v[200:203]
    v_mfma_f32_16x16x32_bf16 v[204:207], v[80:83], v[36:39], v[204:207]
    s_waitcnt lgkmcnt(10)
    v_mfma_f32_16x16x32_bf16 v[208:211], v[48:51], v[32:35], v[208:211]
    v_mfma_f32_16x16x32_bf16 v[212:215], v[48:51], v[36:39], v[212:215]
    s_waitcnt lgkmcnt(8)
    v_mfma_f32_16x16x32_bf16 v[216:219], v[52:55], v[32:35], v[216:219]
    v_mfma_f32_16x16x32_bf16 v[220:223], v[52:55], v[36:39], v[220:223]
    s_waitcnt vmcnt(11) lgkmcnt(0)
    s_barrier
    v_mfma_f32_16x16x32_bf16 v[224:227], v[56:59], v[32:35], v[224:227]
    ds_read_b64_tr_b16 v[72:73], v128 offset:24576
    ds_read_b64_tr_b16 v[74:75], v128 offset:25088
    ds_read_b64_tr_b16 v[76:77], v129 offset:24576
    ds_read_b64_tr_b16 v[78:79], v129 offset:25088
    v_mfma_f32_16x16x32_bf16 v[228:231], v[56:59], v[36:39], v[228:231]
    s_mov_b32 s35, 5898240
    s_add_u32 m0, s57, 49152
    s_nop 0
    buffer_load_dwordx4 v3, s[16:19], s35 offen offset:0  lds
    v_mfma_f32_16x16x32_bf16 v[232:235], v[60:63], v[32:35], v[232:235]
    ds_read_b64_tr_b16 v[80:81], v130 offset:24576
    ds_read_b64_tr_b16 v[82:83], v130 offset:25088
    ds_read_b64_tr_b16 v[48:49], v131 offset:24576
    ds_read_b64_tr_b16 v[50:51], v131 offset:25088
    v_mfma_f32_16x16x32_bf16 v[236:239], v[60:63], v[36:39], v[236:239]
    s_add_u32 m0, s57, 50048
    s_nop 0
    buffer_load_dwordx4 v3, s[16:19], s35 offen offset:128  lds
    v_mfma_f32_16x16x32_bf16 v[240:243], v[64:67], v[32:35], v[240:243]
    ds_read_b64_tr_b16 v[52:53], v128 offset:25600
    ds_read_b64_tr_b16 v[54:55], v128 offset:26112
    ds_read_b64_tr_b16 v[56:57], v129 offset:25600
    ds_read_b64_tr_b16 v[58:59], v129 offset:26112
    v_mfma_f32_16x16x32_bf16 v[244:247], v[64:67], v[36:39], v[244:247]
    s_add_u32 m0, s57, 50944
    s_nop 0
    buffer_load_dwordx4 v3, s[16:19], s35 offen offset:256  lds
    v_mfma_f32_16x16x32_bf16 v[248:251], v[68:71], v[32:35], v[248:251]
    ds_read_b64_tr_b16 v[60:61], v130 offset:25600
    ds_read_b64_tr_b16 v[62:63], v130 offset:26112
    s_add_u32 m0, s56, 15488
    v_mfma_f32_16x16x32_bf16 v[252:255], v[68:71], v[36:39], v[252:255]
    s_nop 0
    buffer_load_dwordx4 v4, s[20:23], s39 offen offset:896  lds
    s_waitcnt lgkmcnt(12)
    v_mfma_f32_16x16x32_bf16 v[160:163], v[72:75], v[40:43], v[160:163]
    ds_read_b64_tr_b16 v[64:65], v131 offset:25600
    ds_read_b64_tr_b16 v[66:67], v131 offset:26112
    s_add_u32 m0, s56, 16512
    v_mfma_f32_16x16x32_bf16 v[164:167], v[72:75], v[44:47], v[164:167]
    s_nop 0
    buffer_load_dwordx4 v5, s[20:23], s39 offen offset:896  lds
    s_waitcnt lgkmcnt(12)
    v_mfma_f32_16x16x32_bf16 v[168:171], v[76:79], v[40:43], v[168:171]
    ds_read_b64_tr_b16 v[68:69], v128 offset:26624
    v_mfma_f32_16x16x32_bf16 v[172:175], v[76:79], v[44:47], v[172:175]
    ds_read_b64_tr_b16 v[70:71], v128 offset:27136
    s_waitcnt lgkmcnt(12)
    v_mfma_f32_16x16x32_bf16 v[176:179], v[80:83], v[40:43], v[176:179]
    ds_read_b64_tr_b16 v[72:73], v129 offset:26624
    v_mfma_f32_16x16x32_bf16 v[180:183], v[80:83], v[44:47], v[180:183]
    ds_read_b64_tr_b16 v[74:75], v129 offset:27136
    s_waitcnt lgkmcnt(12)
    v_mfma_f32_16x16x32_bf16 v[184:187], v[48:51], v[40:43], v[184:187]
    ds_read_b64_tr_b16 v[76:77], v130 offset:26624
    v_mfma_f32_16x16x32_bf16 v[188:191], v[48:51], v[44:47], v[188:191]
    ds_read_b64_tr_b16 v[78:79], v130 offset:27136
    s_waitcnt lgkmcnt(12)
    v_mfma_f32_16x16x32_bf16 v[192:195], v[52:55], v[40:43], v[192:195]
    ds_read_b64_tr_b16 v[80:81], v131 offset:26624
    v_mfma_f32_16x16x32_bf16 v[196:199], v[52:55], v[44:47], v[196:199]
    ds_read_b64_tr_b16 v[82:83], v131 offset:27136
    s_waitcnt lgkmcnt(12)
    v_mfma_f32_16x16x32_bf16 v[200:203], v[56:59], v[40:43], v[200:203]
    v_mfma_f32_16x16x32_bf16 v[204:207], v[56:59], v[44:47], v[204:207]
    s_waitcnt lgkmcnt(10)
    v_mfma_f32_16x16x32_bf16 v[208:211], v[60:63], v[40:43], v[208:211]
    v_mfma_f32_16x16x32_bf16 v[212:215], v[60:63], v[44:47], v[212:215]
    s_waitcnt lgkmcnt(8)
    v_mfma_f32_16x16x32_bf16 v[216:219], v[64:67], v[40:43], v[216:219]
    v_mfma_f32_16x16x32_bf16 v[220:223], v[64:67], v[44:47], v[220:223]
    s_waitcnt vmcnt(8) lgkmcnt(0)
    s_barrier
    v_mfma_f32_16x16x32_bf16 v[224:227], v[68:71], v[40:43], v[224:227]
    ds_read_b128 v[16:19], v12 offset:0
    ds_read_b128 v[20:23], v12 offset:2048
    ds_read_b128 v[24:27], v13 offset:0
    ds_read_b128 v[28:31], v13 offset:2048
    ds_read_b64_tr_b16 v[48:49], v128 offset:49152
    ds_read_b64_tr_b16 v[50:51], v128 offset:49664
    v_mfma_f32_16x16x32_bf16 v[228:231], v[68:71], v[44:47], v[228:231]
    ds_read_b64_tr_b16 v[52:53], v129 offset:49152
    ds_read_b64_tr_b16 v[54:55], v129 offset:49664
    s_mov_b32 s35, 6291456
    s_add_u32 m0, s57, 73728
    s_nop 0
    buffer_load_dwordx4 v3, s[16:19], s35 offen offset:0  lds
    v_mfma_f32_16x16x32_bf16 v[232:235], v[72:75], v[40:43], v[232:235]
    ds_read_b64_tr_b16 v[56:57], v130 offset:49152
    ds_read_b64_tr_b16 v[58:59], v130 offset:49664
    ds_read_b64_tr_b16 v[60:61], v131 offset:49152
    ds_read_b64_tr_b16 v[62:63], v131 offset:49664
    v_mfma_f32_16x16x32_bf16 v[236:239], v[72:75], v[44:47], v[236:239]
    s_add_u32 m0, s57, 74624
    s_nop 0
    buffer_load_dwordx4 v3, s[16:19], s35 offen offset:128  lds
    v_mfma_f32_16x16x32_bf16 v[240:243], v[76:79], v[40:43], v[240:243]
    ds_read_b64_tr_b16 v[64:65], v128 offset:50176
    v_mfma_f32_16x16x32_bf16 v[244:247], v[76:79], v[44:47], v[244:247]
    ds_read_b64_tr_b16 v[66:67], v128 offset:50688
    s_waitcnt lgkmcnt(13)
    ds_read_b64_tr_b16 v[68:69], v129 offset:50176
    ds_read_b64_tr_b16 v[70:71], v129 offset:50688
    s_add_u32 m0, s57, 75520
    s_nop 0
    buffer_load_dwordx4 v3, s[16:19], s35 offen offset:256  lds
    v_mfma_f32_16x16x32_bf16 v[248:251], v[80:83], v[40:43], v[248:251]
    v_mfma_f32_16x16x32_bf16 v[252:255], v[80:83], v[44:47], v[252:255]
    s_waitcnt lgkmcnt(13)
    ds_read_b64_tr_b16 v[72:73], v130 offset:50176
    ds_read_b64_tr_b16 v[74:75], v130 offset:50688
    s_waitcnt lgkmcnt(12)
    v_mfma_f32_16x16x32_bf16 v[160:163], v[48:51], v[16:19], v[160:163]
    ds_read_b64_tr_b16 v[76:77], v131 offset:50176
    v_mfma_f32_16x16x32_bf16 v[164:167], v[48:51], v[20:23], v[164:167]
    ds_read_b64_tr_b16 v[78:79], v131 offset:50688
    s_waitcnt lgkmcnt(12)
    v_mfma_f32_16x16x32_bf16 v[168:171], v[52:55], v[16:19], v[168:171]
    ds_read_b64_tr_b16 v[80:81], v128 offset:51200
    v_mfma_f32_16x16x32_bf16 v[172:175], v[52:55], v[20:23], v[172:175]
    ds_read_b64_tr_b16 v[82:83], v128 offset:51712
    s_waitcnt lgkmcnt(12)
    v_mfma_f32_16x16x32_bf16 v[176:179], v[56:59], v[16:19], v[176:179]
    ds_read_b64_tr_b16 v[48:49], v129 offset:51200
    v_mfma_f32_16x16x32_bf16 v[180:183], v[56:59], v[20:23], v[180:183]
    ds_read_b64_tr_b16 v[50:51], v129 offset:51712
    s_waitcnt lgkmcnt(12)
    v_mfma_f32_16x16x32_bf16 v[184:187], v[60:63], v[16:19], v[184:187]
    ds_read_b64_tr_b16 v[52:53], v130 offset:51200
    v_mfma_f32_16x16x32_bf16 v[188:191], v[60:63], v[20:23], v[188:191]
    ds_read_b64_tr_b16 v[54:55], v130 offset:51712
    s_waitcnt lgkmcnt(12)
    v_mfma_f32_16x16x32_bf16 v[192:195], v[64:67], v[16:19], v[192:195]
    ds_read_b64_tr_b16 v[56:57], v131 offset:51200
    v_mfma_f32_16x16x32_bf16 v[196:199], v[64:67], v[20:23], v[196:199]
    ds_read_b64_tr_b16 v[58:59], v131 offset:51712
    s_waitcnt lgkmcnt(12)
    v_mfma_f32_16x16x32_bf16 v[200:203], v[68:71], v[16:19], v[200:203]
    v_mfma_f32_16x16x32_bf16 v[204:207], v[68:71], v[20:23], v[204:207]
    s_waitcnt lgkmcnt(10)
    v_mfma_f32_16x16x32_bf16 v[208:211], v[72:75], v[16:19], v[208:211]
    v_mfma_f32_16x16x32_bf16 v[212:215], v[72:75], v[20:23], v[212:215]
    s_waitcnt lgkmcnt(8)
    v_mfma_f32_16x16x32_bf16 v[216:219], v[76:79], v[16:19], v[216:219]
    v_mfma_f32_16x16x32_bf16 v[220:223], v[76:79], v[20:23], v[220:223]
    s_waitcnt vmcnt(11) lgkmcnt(0)
    s_barrier
    v_mfma_f32_16x16x32_bf16 v[224:227], v[80:83], v[16:19], v[224:227]
    ds_read_b64_tr_b16 v[60:61], v124 offset:0
    ds_read_b64_tr_b16 v[62:63], v124 offset:512
    ds_read_b64_tr_b16 v[64:65], v125 offset:0
    ds_read_b64_tr_b16 v[66:67], v125 offset:512
    v_mfma_f32_16x16x32_bf16 v[228:231], v[80:83], v[20:23], v[228:231]
    s_mov_b32 s35, 6684672
    s_add_u32 m0, s57, 98304
    s_nop 0
    buffer_load_dwordx4 v3, s[16:19], s35 offen offset:0  lds
    v_mfma_f32_16x16x32_bf16 v[232:235], v[48:51], v[16:19], v[232:235]
    ds_read_b64_tr_b16 v[68:69], v126 offset:0
    ds_read_b64_tr_b16 v[70:71], v126 offset:512
    ds_read_b64_tr_b16 v[72:73], v127 offset:0
    ds_read_b64_tr_b16 v[74:75], v127 offset:512
    v_mfma_f32_16x16x32_bf16 v[236:239], v[48:51], v[20:23], v[236:239]
    s_add_u32 m0, s57, 99200
    s_nop 0
    buffer_load_dwordx4 v3, s[16:19], s35 offen offset:128  lds
    v_mfma_f32_16x16x32_bf16 v[240:243], v[52:55], v[16:19], v[240:243]
    ds_read_b64_tr_b16 v[76:77], v124 offset:1024
    ds_read_b64_tr_b16 v[78:79], v124 offset:1536
    ds_read_b64_tr_b16 v[80:81], v125 offset:1024
    ds_read_b64_tr_b16 v[82:83], v125 offset:1536
    v_mfma_f32_16x16x32_bf16 v[244:247], v[52:55], v[20:23], v[244:247]
    s_add_u32 m0, s57, 100096
    s_nop 0
    buffer_load_dwordx4 v3, s[16:19], s35 offen offset:256  lds
    v_mfma_f32_16x16x32_bf16 v[248:251], v[56:59], v[16:19], v[248:251]
    ds_read_b64_tr_b16 v[48:49], v126 offset:1024
    ds_read_b64_tr_b16 v[50:51], v126 offset:1536
    s_add_u32 m0, s56, -1024
    v_mfma_f32_16x16x32_bf16 v[252:255], v[56:59], v[20:23], v[252:255]
    s_nop 0
    buffer_load_dwordx4 v4, s[20:23], s39 offen offset:1024  lds
    s_waitcnt lgkmcnt(12)
    v_mfma_f32_16x16x32_bf16 v[160:163], v[60:63], v[24:27], v[160:163]
    ds_read_b64_tr_b16 v[52:53], v127 offset:1024
    ds_read_b64_tr_b16 v[54:55], v127 offset:1536
    s_add_u32 m0, s56, 0
    v_mfma_f32_16x16x32_bf16 v[164:167], v[60:63], v[28:31], v[164:167]
    s_nop 0
    buffer_load_dwordx4 v5, s[20:23], s39 offen offset:1024  lds
    s_waitcnt lgkmcnt(12)
    v_mfma_f32_16x16x32_bf16 v[168:171], v[64:67], v[24:27], v[168:171]
    ds_read_b64_tr_b16 v[56:57], v124 offset:2048
    v_mfma_f32_16x16x32_bf16 v[172:175], v[64:67], v[28:31], v[172:175]
    ds_read_b64_tr_b16 v[58:59], v124 offset:2560
    s_waitcnt lgkmcnt(12)
    v_mfma_f32_16x16x32_bf16 v[176:179], v[68:71], v[24:27], v[176:179]
    ds_read_b64_tr_b16 v[60:61], v125 offset:2048
    v_mfma_f32_16x16x32_bf16 v[180:183], v[68:71], v[28:31], v[180:183]
    ds_read_b64_tr_b16 v[62:63], v125 offset:2560
    s_waitcnt lgkmcnt(12)
    v_mfma_f32_16x16x32_bf16 v[184:187], v[72:75], v[24:27], v[184:187]
    ds_read_b64_tr_b16 v[64:65], v126 offset:2048
    v_mfma_f32_16x16x32_bf16 v[188:191], v[72:75], v[28:31], v[188:191]
    ds_read_b64_tr_b16 v[66:67], v126 offset:2560
    s_waitcnt lgkmcnt(12)
    v_mfma_f32_16x16x32_bf16 v[192:195], v[76:79], v[24:27], v[192:195]
    ds_read_b64_tr_b16 v[68:69], v127 offset:2048
    v_mfma_f32_16x16x32_bf16 v[196:199], v[76:79], v[28:31], v[196:199]
    ds_read_b64_tr_b16 v[70:71], v127 offset:2560
    s_waitcnt lgkmcnt(12)
    v_mfma_f32_16x16x32_bf16 v[200:203], v[80:83], v[24:27], v[200:203]
    v_mfma_f32_16x16x32_bf16 v[204:207], v[80:83], v[28:31], v[204:207]
    s_waitcnt lgkmcnt(10)
    v_mfma_f32_16x16x32_bf16 v[208:211], v[48:51], v[24:27], v[208:211]
    v_mfma_f32_16x16x32_bf16 v[212:215], v[48:51], v[28:31], v[212:215]
    s_waitcnt lgkmcnt(8)
    v_mfma_f32_16x16x32_bf16 v[216:219], v[52:55], v[24:27], v[216:219]
    v_mfma_f32_16x16x32_bf16 v[220:223], v[52:55], v[28:31], v[220:223]
    s_waitcnt vmcnt(8) lgkmcnt(0)
    s_barrier
    v_mfma_f32_16x16x32_bf16 v[224:227], v[56:59], v[24:27], v[224:227]
    ds_read_b128 v[32:35], v12 offset:16384
    ds_read_b128 v[36:39], v12 offset:18432
    ds_read_b128 v[40:43], v13 offset:16384
    ds_read_b128 v[44:47], v13 offset:18432
    ds_read_b64_tr_b16 v[72:73], v124 offset:24576
    ds_read_b64_tr_b16 v[74:75], v124 offset:25088
    v_mfma_f32_16x16x32_bf16 v[228:231], v[56:59], v[28:31], v[228:231]
    ds_read_b64_tr_b16 v[76:77], v125 offset:24576
    ds_read_b64_tr_b16 v[78:79], v125 offset:25088
    s_mov_b32 s35, 7077888
    s_add_u32 m0, s57, 0
    s_nop 0
    buffer_load_dwordx4 v3, s[16:19], s35 offen offset:0  lds
    v_mfma_f32_16x16x32_bf16 v[232:235], v[60:63], v[24:27], v[232:235]
    ds_read_b64_tr_b16 v[80:81], v126 offset:24576
    ds_read_b64_tr_b16 v[82:83], v126 offset:25088
    ds_read_b64_tr_b16 v[48:49], v127 offset:24576
    ds_read_b64_tr_b16 v[50:51], v127 offset:25088
    v_mfma_f32_16x16x32_bf16 v[236:239], v[60:63], v[28:31], v[236:239]
    s_add_u32 m0, s57, 896
    s_nop 0
    buffer_load_dwordx4 v3, s[16:19], s35 offen offset:128  lds
    v_mfma_f32_16x16x32_bf16 v[240:243], v[64:67], v[24:27], v[240:243]
    ds_read_b64_tr_b16 v[52:53], v124 offset:25600
    v_mfma_f32_16x16x32_bf16 v[244:247], v[64:67], v[28:31], v[244:247]
    ds_read_b64_tr_b16 v[54:55], v124 offset:26112
    s_waitcnt lgkmcnt(13)
    ds_read_b64_tr_b16 v[56:57], v125 offset:25600
    ds_read_b64_tr_b16 v[58:59], v125 offset:26112
    s_add_u32 m0, s57, 1792
    s_nop 0
    buffer_load_dwordx4 v3, s[16:19], s35 offen offset:256  lds
    v_mfma_f32_16x16x32_bf16 v[248:251], v[68:71], v[24:27], v[248:251]
    v_mfma_f32_16x16x32_bf16 v[252:255], v[68:71], v[28:31], v[252:255]
    s_waitcnt lgkmcnt(13)
    ds_read_b64_tr_b16 v[60:61], v126 offset:25600
    ds_read_b64_tr_b16 v[62:63], v126 offset:26112
    s_waitcnt lgkmcnt(12)
    v_mfma_f32_16x16x32_bf16 v[160:163], v[72:75], v[32:35], v[160:163]
    ds_read_b64_tr_b16 v[64:65], v127 offset:25600
    v_mfma_f32_16x16x32_bf16 v[164:167], v[72:75], v[36:39], v[164:167]
    ds_read_b64_tr_b16 v[66:67], v127 offset:26112
    s_waitcnt lgkmcnt(12)
    v_mfma_f32_16x16x32_bf16 v[168:171], v[76:79], v[32:35], v[168:171]
    ds_read_b64_tr_b16 v[68:69], v124 offset:26624
    v_mfma_f32_16x16x32_bf16 v[172:175], v[76:79], v[36:39], v[172:175]
    ds_read_b64_tr_b16 v[70:71], v124 offset:27136
    s_waitcnt lgkmcnt(12)
    v_mfma_f32_16x16x32_bf16 v[176:179], v[80:83], v[32:35], v[176:179]
    ds_read_b64_tr_b16 v[72:73], v125 offset:26624
    v_mfma_f32_16x16x32_bf16 v[180:183], v[80:83], v[36:39], v[180:183]
    ds_read_b64_tr_b16 v[74:75], v125 offset:27136
    s_waitcnt lgkmcnt(12)
    v_mfma_f32_16x16x32_bf16 v[184:187], v[48:51], v[32:35], v[184:187]
    ds_read_b64_tr_b16 v[76:77], v126 offset:26624
    v_mfma_f32_16x16x32_bf16 v[188:191], v[48:51], v[36:39], v[188:191]
    ds_read_b64_tr_b16 v[78:79], v126 offset:27136
    s_waitcnt lgkmcnt(12)
    v_mfma_f32_16x16x32_bf16 v[192:195], v[52:55], v[32:35], v[192:195]
    ds_read_b64_tr_b16 v[80:81], v127 offset:26624
    v_mfma_f32_16x16x32_bf16 v[196:199], v[52:55], v[36:39], v[196:199]
    ds_read_b64_tr_b16 v[82:83], v127 offset:27136
    s_waitcnt lgkmcnt(12)
    v_mfma_f32_16x16x32_bf16 v[200:203], v[56:59], v[32:35], v[200:203]
    v_mfma_f32_16x16x32_bf16 v[204:207], v[56:59], v[36:39], v[204:207]
    s_waitcnt lgkmcnt(10)
    v_mfma_f32_16x16x32_bf16 v[208:211], v[60:63], v[32:35], v[208:211]
    v_mfma_f32_16x16x32_bf16 v[212:215], v[60:63], v[36:39], v[212:215]
    s_waitcnt lgkmcnt(8)
    v_mfma_f32_16x16x32_bf16 v[216:219], v[64:67], v[32:35], v[216:219]
    v_mfma_f32_16x16x32_bf16 v[220:223], v[64:67], v[36:39], v[220:223]
    s_waitcnt vmcnt(11) lgkmcnt(0)
    s_barrier
    v_mfma_f32_16x16x32_bf16 v[224:227], v[68:71], v[32:35], v[224:227]
    ds_read_b64_tr_b16 v[48:49], v128 offset:0
    ds_read_b64_tr_b16 v[50:51], v128 offset:512
    ds_read_b64_tr_b16 v[52:53], v129 offset:0
    ds_read_b64_tr_b16 v[54:55], v129 offset:512
    v_mfma_f32_16x16x32_bf16 v[228:231], v[68:71], v[36:39], v[228:231]
    s_mov_b32 s35, 7471104
    s_add_u32 m0, s57, 24576
    s_nop 0
    buffer_load_dwordx4 v3, s[16:19], s35 offen offset:0  lds
    v_mfma_f32_16x16x32_bf16 v[232:235], v[72:75], v[32:35], v[232:235]
    ds_read_b64_tr_b16 v[56:57], v130 offset:0
    ds_read_b64_tr_b16 v[58:59], v130 offset:512
    ds_read_b64_tr_b16 v[60:61], v131 offset:0
    ds_read_b64_tr_b16 v[62:63], v131 offset:512
    v_mfma_f32_16x16x32_bf16 v[236:239], v[72:75], v[36:39], v[236:239]
    s_add_u32 m0, s57, 25472
    s_nop 0
    buffer_load_dwordx4 v3, s[16:19], s35 offen offset:128  lds
    v_mfma_f32_16x16x32_bf16 v[240:243], v[76:79], v[32:35], v[240:243]
    ds_read_b64_tr_b16 v[64:65], v128 offset:1024
    ds_read_b64_tr_b16 v[66:67], v128 offset:1536
    ds_read_b64_tr_b16 v[68:69], v129 offset:1024
    ds_read_b64_tr_b16 v[70:71], v129 offset:1536
    v_mfma_f32_16x16x32_bf16 v[244:247], v[76:79], v[36:39], v[244:247]
    s_add_u32 m0, s57, 26368
    s_nop 0
    buffer_load_dwordx4 v3, s[16:19], s35 offen offset:256  lds
    v_mfma_f32_16x16x32_bf16 v[248:251], v[80:83], v[32:35], v[248:251]
    ds_read_b64_tr_b16 v[72:73], v130 offset:1024
    ds_read_b64_tr_b16 v[74:75], v130 offset:1536
    s_add_u32 m0, s56, 15232
    v_mfma_f32_16x16x32_bf16 v[252:255], v[80:83], v[36:39], v[252:255]
    s_nop 0
    buffer_load_dwordx4 v4, s[20:23], s39 offen offset:1152  lds
    s_waitcnt lgkmcnt(12)
    v_mfma_f32_16x16x32_bf16 v[160:163], v[48:51], v[40:43], v[160:163]
    ds_read_b64_tr_b16 v[76:77], v131 offset:1024
    ds_read_b64_tr_b16 v[78:79], v131 offset:1536
    s_add_u32 m0, s56, 16256
    v_mfma_f32_16x16x32_bf16 v[164:167], v[48:51], v[44:47], v[164:167]
    s_nop 0
    buffer_load_dwordx4 v5, s[20:23], s39 offen offset:1152  lds
    s_waitcnt lgkmcnt(12)
    v_mfma_f32_16x16x32_bf16 v[168:171], v[52:55], v[40:43], v[168:171]
    ds_read_b64_tr_b16 v[80:81], v128 offset:2048
    v_mfma_f32_16x16x32_bf16 v[172:175], v[52:55], v[44:47], v[172:175]
    ds_read_b64_tr_b16 v[82:83], v128 offset:2560
    s_waitcnt lgkmcnt(12)
    v_mfma_f32_16x16x32_bf16 v[176:179], v[56:59], v[40:43], v[176:179]
    ds_read_b64_tr_b16 v[48:49], v129 offset:2048
    v_mfma_f32_16x16x32_bf16 v[180:183], v[56:59], v[44:47], v[180:183]
    ds_read_b64_tr_b16 v[50:51], v129 offset:2560
    s_waitcnt lgkmcnt(12)
    v_mfma_f32_16x16x32_bf16 v[184:187], v[60:63], v[40:43], v[184:187]
    ds_read_b64_tr_b16 v[52:53], v130 offset:2048
    v_mfma_f32_16x16x32_bf16 v[188:191], v[60:63], v[44:47], v[188:191]
    ds_read_b64_tr_b16 v[54:55], v130 offset:2560
    s_waitcnt lgkmcnt(12)
    v_mfma_f32_16x16x32_bf16 v[192:195], v[64:67], v[40:43], v[192:195]
    ds_read_b64_tr_b16 v[56:57], v131 offset:2048
    v_mfma_f32_16x16x32_bf16 v[196:199], v[64:67], v[44:47], v[196:199]
    ds_read_b64_tr_b16 v[58:59], v131 offset:2560
    s_waitcnt lgkmcnt(12)
    v_mfma_f32_16x16x32_bf16 v[200:203], v[68:71], v[40:43], v[200:203]
    v_mfma_f32_16x16x32_bf16 v[204:207], v[68:71], v[44:47], v[204:207]
    s_waitcnt lgkmcnt(10)
    v_mfma_f32_16x16x32_bf16 v[208:211], v[72:75], v[40:43], v[208:211]
    v_mfma_f32_16x16x32_bf16 v[212:215], v[72:75], v[44:47], v[212:215]
    s_waitcnt lgkmcnt(8)
    v_mfma_f32_16x16x32_bf16 v[216:219], v[76:79], v[40:43], v[216:219]
    v_mfma_f32_16x16x32_bf16 v[220:223], v[76:79], v[44:47], v[220:223]
    s_waitcnt vmcnt(8) lgkmcnt(0)
    s_barrier
    v_mfma_f32_16x16x32_bf16 v[224:227], v[80:83], v[40:43], v[224:227]
    ds_read_b128 v[16:19], v12 offset:0
    ds_read_b128 v[20:23], v12 offset:2048
    ds_read_b128 v[24:27], v13 offset:0
    ds_read_b128 v[28:31], v13 offset:2048
    ds_read_b64_tr_b16 v[60:61], v128 offset:24576
    ds_read_b64_tr_b16 v[62:63], v128 offset:25088
    v_mfma_f32_16x16x32_bf16 v[228:231], v[80:83], v[44:47], v[228:231]
    ds_read_b64_tr_b16 v[64:65], v129 offset:24576
    ds_read_b64_tr_b16 v[66:67], v129 offset:25088
    s_add_u32 m0, s29, 49152
    s_nop 0
    buffer_load_dwordx4 v1, s[8:11], s31 offen offset:0 sc1 nt lds
    v_mfma_f32_16x16x32_bf16 v[232:235], v[48:51], v[40:43], v[232:235]
    ds_read_b64_tr_b16 v[68:69], v130 offset:24576
    ds_read_b64_tr_b16 v[70:71], v130 offset:25088
    ds_read_b64_tr_b16 v[72:73], v131 offset:24576
    ds_read_b64_tr_b16 v[74:75], v131 offset:25088
    v_mfma_f32_16x16x32_bf16 v[236:239], v[48:51], v[44:47], v[236:239]
    s_add_u32 m0, s29, 50048
    s_nop 0
    buffer_load_dwordx4 v1, s[8:11], s31 offen offset:128 sc1 nt lds
    v_mfma_f32_16x16x32_bf16 v[240:243], v[52:55], v[40:43], v[240:243]
    ds_read_b64_tr_b16 v[76:77], v128 offset:25600
    v_mfma_f32_16x16x32_bf16 v[244:247], v[52:55], v[44:47], v[244:247]
    ds_read_b64_tr_b16 v[78:79], v128 offset:26112
    s_waitcnt lgkmcnt(13)
    ds_read_b64_tr_b16 v[80:81], v129 offset:25600
    ds_read_b64_tr_b16 v[82:83], v129 offset:26112
    s_add_u32 m0, s29, 50944
    s_nop 0
    buffer_load_dwordx4 v1, s[8:11], s31 offen offset:256 sc1 nt lds
    s_add_u32 s31, s31, 12288
    s_cmp_eq_u32 s31, 393216
    s_cselect_b32 s31, 0, s31
    s_cmp_eq_u32 s31, s99
    s_cselect_b32 s31, s59, s31
    v_mfma_f32_16x16x32_bf16 v[248:251], v[56:59], v[40:43], v[248:251]
    v_mfma_f32_16x16x32_bf16 v[252:255], v[56:59], v[44:47], v[252:255]
    s_waitcnt lgkmcnt(13)
    ds_read_b64_tr_b16 v[48:49], v130 offset:25600
    ds_read_b64_tr_b16 v[50:51], v130 offset:26112
    s_waitcnt lgkmcnt(12)
    v_mfma_f32_16x16x32_bf16 v[160:163], v[60:63], v[16:19], v[160:163]
    ds_read_b64_tr_b16 v[52:53], v131 offset:25600
    v_mfma_f32_16x16x32_bf16 v[164:167], v[60:63], v[20:23], v[164:167]
    ds_read_b64_tr_b16 v[54:55], v131 offset:26112
    s_waitcnt lgkmcnt(12)
    v_mfma_f32_16x16x32_bf16 v[168:171], v[64:67], v[16:19], v[168:171]
    ds_read_b64_tr_b16 v[56:57], v128 offset:26624
    v_mfma_f32_16x16x32_bf16 v[172:175], v[64:67], v[20:23], v[172:175]
    ds_read_b64_tr_b16 v[58:59], v128 offset:27136
    s_waitcnt lgkmcnt(12)
    v_mfma_f32_16x16x32_bf16 v[176:179], v[68:71], v[16:19], v[176:179]
    ds_read_b64_tr_b16 v[60:61], v129 offset:26624
    v_mfma_f32_16x16x32_bf16 v[180:183], v[68:71], v[20:23], v[180:183]
    ds_read_b64_tr_b16 v[62:63], v129 offset:27136
    s_waitcnt lgkmcnt(12)
    v_mfma_f32_16x16x32_bf16 v[184:187], v[72:75], v[16:19], v[184:187]
    ds_read_b64_tr_b16 v[64:65], v130 offset:26624
    v_mfma_f32_16x16x32_bf16 v[188:191], v[72:75], v[20:23], v[188:191]
    ds_read_b64_tr_b16 v[66:67], v130 offset:27136
    s_waitcnt lgkmcnt(12)
    v_mfma_f32_16x16x32_bf16 v[192:195], v[76:79], v[16:19], v[192:195]
    ds_read_b64_tr_b16 v[68:69], v131 offset:26624
    v_mfma_f32_16x16x32_bf16 v[196:199], v[76:79], v[20:23], v[196:199]
    ds_read_b64_tr_b16 v[70:71], v131 offset:27136
    s_waitcnt lgkmcnt(12)
    v_mfma_f32_16x16x32_bf16 v[200:203], v[80:83], v[16:19], v[200:203]
    v_mfma_f32_16x16x32_bf16 v[204:207], v[80:83], v[20:23], v[204:207]
    s_waitcnt lgkmcnt(10)
    v_mfma_f32_16x16x32_bf16 v[208:211], v[48:51], v[16:19], v[208:211]
    v_mfma_f32_16x16x32_bf16 v[212:215], v[48:51], v[20:23], v[212:215]
    s_waitcnt lgkmcnt(8)
    v_mfma_f32_16x16x32_bf16 v[216:219], v[52:55], v[16:19], v[216:219]
    v_mfma_f32_16x16x32_bf16 v[220:223], v[52:55], v[20:23], v[220:223]
    s_waitcnt vmcnt(11) lgkmcnt(0)
    s_barrier
    v_mfma_f32_16x16x32_bf16 v[224:227], v[56:59], v[16:19], v[224:227]
    ds_read_b64_tr_b16 v[72:73], v128 offset:49152
    ds_read_b64_tr_b16 v[74:75], v128 offset:49664
    ds_read_b64_tr_b16 v[76:77], v129 offset:49152
    ds_read_b64_tr_b16 v[78:79], v129 offset:49664
    v_mfma_f32_16x16x32_bf16 v[228:231], v[56:59], v[20:23], v[228:231]
    s_add_u32 m0, s29, 73728
    s_nop 0
    buffer_load_dwordx4 v2, s[12:15], s32 offen offset:0 sc1 nt lds
    v_mfma_f32_16x16x32_bf16 v[232:235], v[60:63], v[16:19], v[232:235]
    ds_read_b64_tr_b16 v[80:81], v130 offset:49152
    ds_read_b64_tr_b16 v[82:83], v130 offset:49664
    ds_read_b64_tr_b16 v[48:49], v131 offset:49152
    ds_read_b64_tr_b16 v[50:51], v131 offset:49664
    v_mfma_f32_16x16x32_bf16 v[236:239], v[60:63], v[20:23], v[236:239]
    s_add_u32 m0, s29, 74624
    s_nop 0
    buffer_load_dwordx4 v2, s[12:15], s32 offen offset:128 sc1 nt lds
    v_mfma_f32_16x16x32_bf16 v[240:243], v[64:67], v[16:19], v[240:243]
    ds_read_b64_tr_b16 v[52:53], v128 offset:50176
    ds_read_b64_tr_b16 v[54:55], v128 offset:50688
    ds_read_b64_tr_b16 v[56:57], v129 offset:50176
    ds_read_b64_tr_b16 v[58:59], v129 offset:50688
    s_add_u32 m0, s29, 75520
    s_nop 0
    v_mfma_f32_16x16x32_bf16 v[244:247], v[64:67], v[20:23], v[244:247]
    buffer_load_dwordx4 v2, s[12:15], s32 offen offset:256 sc1 nt lds
    s_add_u32 s32, s32, 12288
    s_cmp_eq_u32 s32, 393216
    s_cselect_b32 s32, 0, s32
    s_cmp_eq_u32 s32, s99
    s_cselect_b32 s32, s59, s32
    v_mfma_f32_16x16x32_bf16 v[248:251], v[68:71], v[16:19], v[248:251]
    ds_read_b64_tr_b16 v[60:61], v130 offset:50176
    v_mfma_f32_16x16x32_bf16 v[252:255], v[68:71], v[20:23], v[252:255]
    ds_read_b64_tr_b16 v[62:63], v130 offset:50688
    s_waitcnt lgkmcnt(12)
    v_mfma_f32_16x16x32_bf16 v[160:163], v[72:75], v[24:27], v[160:163]
    ds_read_b64_tr_b16 v[64:65], v131 offset:50176
    v_mfma_f32_16x16x32_bf16 v[164:167], v[72:75], v[28:31], v[164:167]
    ds_read_b64_tr_b16 v[66:67], v131 offset:50688
    s_waitcnt lgkmcnt(12)
    v_mfma_f32_16x16x32_bf16 v[168:171], v[76:79], v[24:27], v[168:171]
    ds_read_b64_tr_b16 v[68:69], v128 offset:51200
    v_mfma_f32_16x16x32_bf16 v[172:175], v[76:79], v[28:31], v[172:175]
    ds_read_b64_tr_b16 v[70:71], v128 offset:51712
    s_waitcnt lgkmcnt(12)
    v_mfma_f32_16x16x32_bf16 v[176:179], v[80:83], v[24:27], v[176:179]
    ds_read_b64_tr_b16 v[72:73], v129 offset:51200
    v_mfma_f32_16x16x32_bf16 v[180:183], v[80:83], v[28:31], v[180:183]
    ds_read_b64_tr_b16 v[74:75], v129 offset:51712
    s_waitcnt lgkmcnt(12)
    v_mfma_f32_16x16x32_bf16 v[184:187], v[48:51], v[24:27], v[184:187]
    ds_read_b64_tr_b16 v[76:77], v130 offset:51200
    v_mfma_f32_16x16x32_bf16 v[188:191], v[48:51], v[28:31], v[188:191]
    ds_read_b64_tr_b16 v[78:79], v130 offset:51712
    s_waitcnt lgkmcnt(12)
    v_mfma_f32_16x16x32_bf16 v[192:195], v[52:55], v[24:27], v[192:195]
    ds_read_b64_tr_b16 v[80:81], v131 offset:51200
    v_mfma_f32_16x16x32_bf16 v[196:199], v[52:55], v[28:31], v[196:199]
    ds_read_b64_tr_b16 v[82:83], v131 offset:51712
    s_waitcnt lgkmcnt(12)
    v_mfma_f32_16x16x32_bf16 v[200:203], v[56:59], v[24:27], v[200:203]
    v_mfma_f32_16x16x32_bf16 v[204:207], v[56:59], v[28:31], v[204:207]
    s_waitcnt lgkmcnt(10)
    v_mfma_f32_16x16x32_bf16 v[208:211], v[60:63], v[24:27], v[208:211]
    v_mfma_f32_16x16x32_bf16 v[212:215], v[60:63], v[28:31], v[212:215]
    s_waitcnt lgkmcnt(8)
    v_mfma_f32_16x16x32_bf16 v[216:219], v[64:67], v[24:27], v[216:219]
    v_mfma_f32_16x16x32_bf16 v[220:223], v[64:67], v[28:31], v[220:223]
    s_waitcnt vmcnt(6) lgkmcnt(0)
    s_barrier
    v_mfma_f32_16x16x32_bf16 v[224:227], v[68:71], v[24:27], v[224:227]
    ds_read_b128 v[32:35], v12 offset:16384
    ds_read_b128 v[36:39], v12 offset:18432
    ds_read_b128 v[40:43], v13 offset:16384
    ds_read_b128 v[44:47], v13 offset:18432
    ds_read_b64_tr_b16 v[48:49], v124 offset:0
    ds_read_b64_tr_b16 v[50:51], v124 offset:512
    v_mfma_f32_16x16x32_bf16 v[228:231], v[68:71], v[28:31], v[228:231]
    ds_read_b64_tr_b16 v[52:53], v125 offset:0
    ds_read_b64_tr_b16 v[54:55], v125 offset:512
    s_add_u32 m0, s29, 98304
    s_nop 0
    buffer_load_dwordx4 v2, s[12:15], s32 offen offset:0 sc1 nt lds
    v_mfma_f32_16x16x32_bf16 v[232:235], v[72:75], v[24:27], v[232:235]
    ds_read_b64_tr_b16 v[56:57], v126 offset:0
    ds_read_b64_tr_b16 v[58:59], v126 offset:512
    ds_read_b64_tr_b16 v[60:61], v127 offset:0
    ds_read_b64_tr_b16 v[62:63], v127 offset:512
    v_mfma_f32_16x16x32_bf16 v[236:239], v[72:75], v[28:31], v[236:239]
    s_add_u32 m0, s29, 99200
    s_nop 0
    buffer_load_dwordx4 v2, s[12:15], s32 offen offset:128 sc1 nt lds
    v_mfma_f32_16x16x32_bf16 v[240:243], v[76:79], v[24:27], v[240:243]
    ds_read_b64_tr_b16 v[64:65], v124 offset:1024
    v_mfma_f32_16x16x32_bf16 v[244:247], v[76:79], v[28:31], v[244:247]
    ds_read_b64_tr_b16 v[66:67], v124 offset:1536
    s_waitcnt lgkmcnt(13)
    ds_read_b64_tr_b16 v[68:69], v125 offset:1024
    ds_read_b64_tr_b16 v[70:71], v125 offset:1536
    s_add_u32 m0, s29, 100096
    s_nop 0
    buffer_load_dwordx4 v2, s[12:15], s32 offen offset:256 sc1 nt lds
    s_add_u32 s32, s32, 12288
    s_cmp_eq_u32 s32, 393216
    s_cselect_b32 s32, 0, s32
    s_cmp_eq_u32 s32, s99
    s_cselect_b32 s32, s59, s32
    v_mfma_f32_16x16x32_bf16 v[248:251], v[80:83], v[24:27], v[248:251]
    v_mfma_f32_16x16x32_bf16 v[252:255], v[80:83], v[28:31], v[252:255]
    s_waitcnt lgkmcnt(13)
    ds_read_b64_tr_b16 v[72:73], v126 offset:1024
    ds_read_b64_tr_b16 v[74:75], v126 offset:1536
    s_waitcnt lgkmcnt(12)
    v_mfma_f32_16x16x32_bf16 v[160:163], v[48:51], v[32:35], v[160:163]
    ds_read_b64_tr_b16 v[76:77], v127 offset:1024
    v_mfma_f32_16x16x32_bf16 v[164:167], v[48:51], v[36:39], v[164:167]
    ds_read_b64_tr_b16 v[78:79], v127 offset:1536
    s_waitcnt lgkmcnt(12)
    v_mfma_f32_16x16x32_bf16 v[168:171], v[52:55], v[32:35], v[168:171]
    ds_read_b64_tr_b16 v[80:81], v124 offset:2048
    v_mfma_f32_16x16x32_bf16 v[172:175], v[52:55], v[36:39], v[172:175]
    ds_read_b64_tr_b16 v[82:83], v124 offset:2560
    s_waitcnt lgkmcnt(12)
    v_mfma_f32_16x16x32_bf16 v[176:179], v[56:59], v[32:35], v[176:179]
    ds_read_b64_tr_b16 v[48:49], v125 offset:2048
    v_mfma_f32_16x16x32_bf16 v[180:183], v[56:59], v[36:39], v[180:183]
    ds_read_b64_tr_b16 v[50:51], v125 offset:2560
    s_waitcnt lgkmcnt(12)
    v_mfma_f32_16x16x32_bf16 v[184:187], v[60:63], v[32:35], v[184:187]
    ds_read_b64_tr_b16 v[52:53], v126 offset:2048
    v_mfma_f32_16x16x32_bf16 v[188:191], v[60:63], v[36:39], v[188:191]
    ds_read_b64_tr_b16 v[54:55], v126 offset:2560
    s_waitcnt lgkmcnt(12)
    v_mfma_f32_16x16x32_bf16 v[192:195], v[64:67], v[32:35], v[192:195]
    ds_read_b64_tr_b16 v[56:57], v127 offset:2048
    v_mfma_f32_16x16x32_bf16 v[196:199], v[64:67], v[36:39], v[196:199]
    ds_read_b64_tr_b16 v[58:59], v127 offset:2560
    s_waitcnt lgkmcnt(12)
    v_mfma_f32_16x16x32_bf16 v[200:203], v[68:71], v[32:35], v[200:203]
    v_mfma_f32_16x16x32_bf16 v[204:207], v[68:71], v[36:39], v[204:207]
    s_waitcnt lgkmcnt(10)
    v_mfma_f32_16x16x32_bf16 v[208:211], v[72:75], v[32:35], v[208:211]
    v_mfma_f32_16x16x32_bf16 v[212:215], v[72:75], v[36:39], v[212:215]
    s_waitcnt lgkmcnt(8)
    v_mfma_f32_16x16x32_bf16 v[216:219], v[76:79], v[32:35], v[216:219]
    v_mfma_f32_16x16x32_bf16 v[220:223], v[76:79], v[36:39], v[220:223]
    s_waitcnt vmcnt(9) lgkmcnt(0)
    s_barrier
    v_mfma_f32_16x16x32_bf16 v[224:227], v[80:83], v[32:35], v[224:227]
    ds_read_b64_tr_b16 v[60:61], v124 offset:24576
    ds_read_b64_tr_b16 v[62:63], v124 offset:25088
    v_mfma_f32_16x16x32_bf16 v[228:231], v[80:83], v[36:39], v[228:231]
    ds_read_b64_tr_b16 v[64:65], v125 offset:24576
    ds_read_b64_tr_b16 v[66:67], v125 offset:25088
    v_mfma_f32_16x16x32_bf16 v[232:235], v[48:51], v[32:35], v[232:235]
    ds_read_b64_tr_b16 v[68:69], v126 offset:24576
    ds_read_b64_tr_b16 v[70:71], v126 offset:25088
    v_mfma_f32_16x16x32_bf16 v[236:239], v[48:51], v[36:39], v[236:239]
    ds_read_b64_tr_b16 v[72:73], v127 offset:24576
    ds_read_b64_tr_b16 v[74:75], v127 offset:25088
    v_mfma_f32_16x16x32_bf16 v[240:243], v[52:55], v[32:35], v[240:243]
    ds_read_b64_tr_b16 v[76:77], v124 offset:25600
    ds_read_b64_tr_b16 v[78:79], v124 offset:26112
    v_mfma_f32_16x16x32_bf16 v[244:247], v[52:55], v[36:39], v[244:247]
    ds_read_b64_tr_b16 v[80:81], v125 offset:25600
    ds_read_b64_tr_b16 v[82:83], v125 offset:26112
    v_mfma_f32_16x16x32_bf16 v[248:251], v[56:59], v[32:35], v[248:251]
    ds_read_b64_tr_b16 v[48:49], v126 offset:25600
    v_mfma_f32_16x16x32_bf16 v[252:255], v[56:59], v[36:39], v[252:255]
    ds_read_b64_tr_b16 v[50:51], v126 offset:26112
    s_waitcnt lgkmcnt(12)
    v_mfma_f32_16x16x32_bf16 v[160:163], v[60:63], v[40:43], v[160:163]
    ds_read_b64_tr_b16 v[52:53], v127 offset:25600
    v_mfma_f32_16x16x32_bf16 v[164:167], v[60:63], v[44:47], v[164:167]
    ds_read_b64_tr_b16 v[54:55], v127 offset:26112
    s_waitcnt lgkmcnt(12)
    v_mfma_f32_16x16x32_bf16 v[168:171], v[64:67], v[40:43], v[168:171]
    ds_read_b64_tr_b16 v[56:57], v124 offset:26624
    v_mfma_f32_16x16x32_bf16 v[172:175], v[64:67], v[44:47], v[172:175]
    ds_read_b64_tr_b16 v[58:59], v124 offset:27136
    s_waitcnt lgkmcnt(12)
    v_mfma_f32_16x16x32_bf16 v[176:179], v[68:71], v[40:43], v[176:179]
    ds_read_b64_tr_b16 v[60:61], v125 offset:26624
    v_mfma_f32_16x16x32_bf16 v[180:183], v[68:71], v[44:47], v[180:183]
    ds_read_b64_tr_b16 v[62:63], v125 offset:27136
    s_waitcnt lgkmcnt(12)
    v_mfma_f32_16x16x32_bf16 v[184:187], v[72:75], v[40:43], v[184:187]
    ds_read_b64_tr_b16 v[64:65], v126 offset:26624
    v_mfma_f32_16x16x32_bf16 v[188:191], v[72:75], v[44:47], v[188:191]
    ds_read_b64_tr_b16 v[66:67], v126 offset:27136
    s_waitcnt lgkmcnt(12)
    v_mfma_f32_16x16x32_bf16 v[192:195], v[76:79], v[40:43], v[192:195]
    ds_read_b64_tr_b16 v[68:69], v127 offset:26624
    v_mfma_f32_16x16x32_bf16 v[196:199], v[76:79], v[44:47], v[196:199]
    ds_read_b64_tr_b16 v[70:71], v127 offset:27136
    s_waitcnt lgkmcnt(12)
    v_mfma_f32_16x16x32_bf16 v[200:203], v[80:83], v[40:43], v[200:203]
    v_mfma_f32_16x16x32_bf16 v[204:207], v[80:83], v[44:47], v[204:207]
    s_waitcnt lgkmcnt(10)
    v_mfma_f32_16x16x32_bf16 v[208:211], v[48:51], v[40:43], v[208:211]
    v_mfma_f32_16x16x32_bf16 v[212:215], v[48:51], v[44:47], v[212:215]
    s_waitcnt lgkmcnt(8)
    v_mfma_f32_16x16x32_bf16 v[216:219], v[52:55], v[40:43], v[216:219]
    v_mfma_f32_16x16x32_bf16 v[220:223], v[52:55], v[44:47], v[220:223]
    s_waitcnt lgkmcnt(6)
    v_mfma_f32_16x16x32_bf16 v[224:227], v[56:59], v[40:43], v[224:227]
    v_mfma_f32_16x16x32_bf16 v[228:231], v[56:59], v[44:47], v[228:231]
    s_waitcnt lgkmcnt(4)
    v_mfma_f32_16x16x32_bf16 v[232:235], v[60:63], v[40:43], v[232:235]
    v_mfma_f32_16x16x32_bf16 v[236:239], v[60:63], v[44:47], v[236:239]
    s_waitcnt lgkmcnt(2)
    v_mfma_f32_16x16x32_bf16 v[240:243], v[64:67], v[40:43], v[240:243]
    v_mfma_f32_16x16x32_bf16 v[244:247], v[64:67], v[44:47], v[244:247]
    s_waitcnt lgkmcnt(0)
    v_mfma_f32_16x16x32_bf16 v[248:251], v[68:71], v[40:43], v[248:251]
    v_mfma_f32_16x16x32_bf16 v[252:255], v[68:71], v[44:47], v[252:255]
    s_barrier
    v_lshlrev_b32 v3, 4, v0
    v_add_u32 v3, s29, v3
    v_add_u32 v4, 73728, v3
    s_waitcnt vmcnt(9)
    ds_write_b128 v3, v[88:91] offset:0
    ds_write_b128 v3, v[92:95] offset:1024
    ds_write_b128 v3, v[96:99] offset:2048
    ds_write_b128 v3, v[100:103] offset:24576
    ds_write_b128 v3, v[104:107] offset:25600
    ds_write_b128 v3, v[108:111] offset:26624
    ds_write_b128 v4, v[112:115] offset:49152
    ds_write_b128 v4, v[116:119] offset:50176
    ds_write_b128 v4, v[120:123] offset:51200
    v_cvt_pk_bf16_f32 v16, v160, v161
    v_cvt_pk_bf16_f32 v17, v162, v163
    v_cvt_pk_bf16_f32 v20, v164, v165
    v_cvt_pk_bf16_f32 v21, v166, v167
    v_cvt_pk_bf16_f32 v18, v168, v169
    v_cvt_pk_bf16_f32 v19, v170, v171
    v_cvt_pk_bf16_f32 v22, v172, v173
    v_cvt_pk_bf16_f32 v23, v174, v175
    v_cvt_pk_bf16_f32 v24, v176, v177
    v_cvt_pk_bf16_f32 v25, v178, v179
    v_cvt_pk_bf16_f32 v28, v180, v181
    v_cvt_pk_bf16_f32 v29, v182, v183
    v_cvt_pk_bf16_f32 v26, v184, v185
    v_cvt_pk_bf16_f32 v27, v186, v187
    v_cvt_pk_bf16_f32 v30, v188, v189
    v_cvt_pk_bf16_f32 v31, v190, v191
    v_cvt_pk_bf16_f32 v32, v192, v193
    v_cvt_pk_bf16_f32 v33, v194, v195
    v_cvt_pk_bf16_f32 v36, v196, v197
    v_cvt_pk_bf16_f32 v37, v198, v199
    v_cvt_pk_bf16_f32 v34, v200, v201
    v_cvt_pk_bf16_f32 v35, v202, v203
    v_cvt_pk_bf16_f32 v38, v204, v205
    v_cvt_pk_bf16_f32 v39, v206, v207
    v_cvt_pk_bf16_f32 v40, v208, v209
    v_cvt_pk_bf16_f32 v41, v210, v211
    v_cvt_pk_bf16_f32 v44, v212, v213
    v_cvt_pk_bf16_f32 v45, v214, v215
    v_cvt_pk_bf16_f32 v42, v216, v217
    v_cvt_pk_bf16_f32 v43, v218, v219
    v_cvt_pk_bf16_f32 v46, v220, v221
    v_cvt_pk_bf16_f32 v47, v222, v223
    v_cvt_pk_bf16_f32 v48, v224, v225
    v_cvt_pk_bf16_f32 v49, v226, v227
    v_cvt_pk_bf16_f32 v52, v228, v229
    v_cvt_pk_bf16_f32 v53, v230, v231
    v_cvt_pk_bf16_f32 v50, v232, v233
    v_cvt_pk_bf16_f32 v51, v234, v235
    v_cvt_pk_bf16_f32 v54, v236, v237
    v_cvt_pk_bf16_f32 v55, v238, v239
    v_cvt_pk_bf16_f32 v56, v240, v241
    v_cvt_pk_bf16_f32 v57, v242, v243
    v_cvt_pk_bf16_f32 v60, v244, v245
    v_cvt_pk_bf16_f32 v61, v246, v247
    v_cvt_pk_bf16_f32 v58, v248, v249
    v_cvt_pk_bf16_f32 v59, v250, v251
    v_cvt_pk_bf16_f32 v62, v252, v253
    v_cvt_pk_bf16_f32 v63, v254, v255
    v_mov_b32 v160, 0
    v_mov_b32 v161, 0
    v_mov_b32 v162, 0
    v_mov_b32 v163, 0
    v_mov_b32 v164, 0
    v_mov_b32 v165, 0
    v_mov_b32 v166, 0
    v_mov_b32 v167, 0
    v_mov_b32 v168, 0
    v_mov_b32 v169, 0
    v_mov_b32 v170, 0
    v_mov_b32 v171, 0
    v_mov_b32 v172, 0
    v_mov_b32 v173, 0
    v_mov_b32 v174, 0
    v_mov_b32 v175, 0
    v_mov_b32 v176, 0
    v_mov_b32 v177, 0
    v_mov_b32 v178, 0
    v_mov_b32 v179, 0
    v_mov_b32 v180, 0
    v_mov_b32 v181, 0
    v_mov_b32 v182, 0
    v_mov_b32 v183, 0
    v_mov_b32 v184, 0
    v_mov_b32 v185, 0
    v_mov_b32 v186, 0
    v_mov_b32 v187, 0
    v_mov_b32 v188, 0
    v_mov_b32 v189, 0
    v_mov_b32 v190, 0
    v_mov_b32 v191, 0
    v_mov_b32 v192, 0
    v_mov_b32 v193, 0
    v_mov_b32 v194, 0
    v_mov_b32 v195, 0
    v_mov_b32 v196, 0
    v_mov_b32 v197, 0
    v_mov_b32 v198, 0
    v_mov_b32 v199, 0
    v_mov_b32 v200, 0
    v_mov_b32 v201, 0
    v_mov_b32 v202, 0
    v_mov_b32 v203, 0
    v_mov_b32 v204, 0
    v_mov_b32 v205, 0
    v_mov_b32 v206, 0
    v_mov_b32 v207, 0
    v_mov_b32 v208, 0
    v_mov_b32 v209, 0
    v_mov_b32 v210, 0
    v_mov_b32 v211, 0
    v_mov_b32 v212, 0
    v_mov_b32 v213, 0
    v_mov_b32 v214, 0
    v_mov_b32 v215, 0
    v_mov_b32 v216, 0
    v_mov_b32 v217, 0
    v_mov_b32 v218, 0
    v_mov_b32 v219, 0
    v_mov_b32 v220, 0
    v_mov_b32 v221, 0
    v_mov_b32 v222, 0
    v_mov_b32 v223, 0
    v_mov_b32 v224, 0
    v_mov_b32 v225, 0
    v_mov_b32 v226, 0
    v_mov_b32 v227, 0
    v_mov_b32 v228, 0
    v_mov_b32 v229, 0
    v_mov_b32 v230, 0
    v_mov_b32 v231, 0
    v_mov_b32 v232, 0
    v_mov_b32 v233, 0
    v_mov_b32 v234, 0
    v_mov_b32 v235, 0
    v_mov_b32 v236, 0
    v_mov_b32 v237, 0
    v_mov_b32 v238, 0
    v_mov_b32 v239, 0
    v_mov_b32 v240, 0
    v_mov_b32 v241, 0
    v_mov_b32 v242, 0
    v_mov_b32 v243, 0
    v_mov_b32 v244, 0
    v_mov_b32 v245, 0
    v_mov_b32 v246, 0
    v_mov_b32 v247, 0
    v_mov_b32 v248, 0
    v_mov_b32 v249, 0
    v_mov_b32 v250, 0
    v_mov_b32 v251, 0
    v_mov_b32 v252, 0
    v_mov_b32 v253, 0
    v_mov_b32 v254, 0
    v_mov_b32 v255, 0
    v_permlane32_swap_b32 v16, v18
    v_permlane32_swap_b32 v17, v19
    v_permlane32_swap_b32 v20, v22
    v_permlane32_swap_b32 v21, v23
    v_permlane32_swap_b32 v24, v26
    v_permlane32_swap_b32 v25, v27
    v_permlane32_swap_b32 v28, v30
    v_permlane32_swap_b32 v29, v31
    v_permlane32_swap_b32 v32, v34
    v_permlane32_swap_b32 v33, v35
    v_permlane32_swap_b32 v36, v38
    v_permlane32_swap_b32 v37, v39
    v_permlane32_swap_b32 v40, v42
    v_permlane32_swap_b32 v41, v43
    v_permlane32_swap_b32 v44, v46
    v_permlane32_swap_b32 v45, v47
    v_permlane32_swap_b32 v48, v50
    v_permlane32_swap_b32 v49, v51
    v_permlane32_swap_b32 v52, v54
    v_permlane32_swap_b32 v53, v55
    v_permlane32_swap_b32 v56, v58
    v_permlane32_swap_b32 v57, v59
    v_permlane32_swap_b32 v60, v62
    v_permlane32_swap_b32 v61, v63
    v_permlane16_swap_b32 v16, v18
    v_permlane16_swap_b32 v17, v19
    v_permlane16_swap_b32 v20, v22
    v_permlane16_swap_b32 v21, v23
    v_permlane16_swap_b32 v24, v26
    v_permlane16_swap_b32 v25, v27
    v_permlane16_swap_b32 v28, v30
    v_permlane16_swap_b32 v29, v31
    v_permlane16_swap_b32 v32, v34
    v_permlane16_swap_b32 v33, v35
    v_permlane16_swap_b32 v36, v38
    v_permlane16_swap_b32 v37, v39
    v_permlane16_swap_b32 v40, v42
    v_permlane16_swap_b32 v41, v43
    v_permlane16_swap_b32 v44, v46
    v_permlane16_swap_b32 v45, v47
    v_permlane16_swap_b32 v48, v50
    v_permlane16_swap_b32 v49, v51
    v_permlane16_swap_b32 v52, v54
    v_permlane16_swap_b32 v53, v55
    v_permlane16_swap_b32 v56, v58
    v_permlane16_swap_b32 v57, v59
    v_permlane16_swap_b32 v60, v62
    v_permlane16_swap_b32 v61, v63
    v_mov_b32 v12, 0xff800000
    v_mov_b32 v15, 0xff800000
    v_mov_b32 v13, 0
    v_mov_b32 v156, 0xff800000
    v_mov_b32 v159, 0xff800000
    v_mov_b32 v157, 0
    s_mov_b32 s58, 0
    s_mov_b32 s33, 0
    s_mov_b32 s16, s100
    s_and_b32 s17, s101, 0xffff
    s_mov_b32 s18, 491520
    s_mov_b32 s19, 0x00020000
    s_mul_i32 s39, s89, 61440
    s_mul_i32 s35, s92, 7680
    s_add_u32 s39, s39, s35
    v_min_u32 v5, 59, v0
    v_lshlrev_b32 v5, 7, v5
    s_waitcnt vmcnt(9) lgkmcnt(0)
    s_barrier
    ds_read_b128 v[112:115], v6 offset:0
    ds_read_b128 v[116:119], v6 offset:6144
    ds_read_b128 v[120:123], v7 offset:0
    ds_read_b128 v[124:127], v7 offset:6144
    ds_read_b128 v[128:131], v6 offset:1024
    ds_read_b128 v[132:135], v6 offset:7168
    ds_read_b128 v[136:139], v7 offset:1024
    s_waitcnt lgkmcnt(6)
    v_mfma_f32_16x16x32_bf16 v[64:67], v[112:115], v[16:19], 0
    ds_read_b128 v[140:143], v7 offset:7168
    v_mfma_f32_16x16x32_bf16 v[72:75], v[112:115], v[20:23], 0
    s_waitcnt lgkmcnt(6)
    v_mfma_f32_16x16x32_bf16 v[68:71], v[116:119], v[16:19], 0
    ds_read_b128 v[144:147], v6 offset:2048
    v_mfma_f32_16x16x32_bf16 v[76:79], v[116:119], v[20:23], 0
    s_waitcnt lgkmcnt(6)
    v_mfma_f32_16x16x32_bf16 v[64:67], v[120:123], v[24:27], v[64:67]
    ds_read_b128 v[112:115], v6 offset:8192
    v_mfma_f32_16x16x32_bf16 v[72:75], v[120:123], v[28:31], v[72:75]
    s_waitcnt lgkmcnt(6)
    v_mfma_f32_16x16x32_bf16 v[68:71], v[124:127], v[24:27], v[68:71]
    ds_read_b128 v[116:119], v7 offset:2048
    v_mfma_f32_16x16x32_bf16 v[76:79], v[124:127], v[28:31], v[76:79]
    s_waitcnt lgkmcnt(6)
    v_mfma_f32_16x16x32_bf16 v[64:67], v[128:131], v[32:35], v[64:67]
    ds_read_b128 v[120:123], v7 offset:8192
    v_mfma_f32_16x16x32_bf16 v[72:75], v[128:131], v[36:39], v[72:75]
    s_waitcnt lgkmcnt(6)
    v_mfma_f32_16x16x32_bf16 v[68:71], v[132:135], v[32:35], v[68:71]
    v_mfma_f32_16x16x32_bf16 v[76:79], v[132:135], v[36:39], v[76:79]
    s_waitcnt lgkmcnt(5)
    v_mfma_f32_16x16x32_bf16 v[64:67], v[136:139], v[40:43], v[64:67]
    v_mfma_f32_16x16x32_bf16 v[72:75], v[136:139], v[44:47], v[72:75]
    s_waitcnt lgkmcnt(4)
    v_mfma_f32_16x16x32_bf16 v[68:71], v[140:143], v[40:43], v[68:71]
    v_mfma_f32_16x16x32_bf16 v[76:79], v[140:143], v[44:47], v[76:79]
    s_waitcnt lgkmcnt(3)
    v_mfma_f32_16x16x32_bf16 v[64:67], v[144:147], v[48:51], v[64:67]
    v_mfma_f32_16x16x32_bf16 v[72:75], v[144:147], v[52:55], v[72:75]
    s_waitcnt lgkmcnt(2)
    v_mfma_f32_16x16x32_bf16 v[68:71], v[112:115], v[48:51], v[68:71]
    v_mfma_f32_16x16x32_bf16 v[76:79], v[112:115], v[52:55], v[76:79]
    s_waitcnt lgkmcnt(1)
    v_mfma_f32_16x16x32_bf16 v[64:67], v[116:119], v[56:59], v[64:67]
    v_mfma_f32_16x16x32_bf16 v[72:75], v[116:119], v[60:63], v[72:75]
    s_waitcnt lgkmcnt(0)
    v_mfma_f32_16x16x32_bf16 v[68:71], v[120:123], v[56:59], v[68:71]
    v_mfma_f32_16x16x32_bf16 v[76:79], v[120:123], v[60:63], v[76:79]
    s_nop 7
    s_nop 3
    v_max3_f32 v152, v64, v65, v66
    v_max3_f32 v153, v72, v73, v74
    v_max3_f32 v152, v152, v67, v68
    s_nop 0
    v_max3_f32 v153, v153, v75, v76
    v_max3_f32 v152, v152, v69, v70
    v_max3_f32 v153, v153, v77, v78
    s_nop 0
    v_max_f32 v152, v152, v71
    v_max_f32 v153, v153, v79
    v_fma_f32 v154, v152, s34, -v15
    s_nop 0
    v_fma_f32 v155, v153, s34, -v159
    v_max_f32 v154, v154, v155
    v_cmp_lt_f32 vcc, 0, v154
    s_cbranch_vccnz L_rareA1
L_backA1:
    s_nop 0
    v_fma_f32 v64, v64, s34, -v12
    v_fma_f32 v65, v65, s34, -v12
    v_exp_f32 v64, v64
    s_nop 0
    v_exp_f32 v65, v65
    v_fma_f32 v66, v66, s34, -v12
    v_fma_f32 v67, v67, s34, -v12
    s_nop 0
    v_exp_f32 v66, v66
    v_exp_f32 v67, v67
    v_add_f32 v154, v64, v65
    s_nop 0
    v_cvt_pk_bf16_f32 v96, v64, v65
    v_add_f32 v13, v13, v154
    v_fma_f32 v68, v68, s34, -v12
    s_nop 0
    v_fma_f32 v69, v69, s34, -v12
    v_exp_f32 v68, v68
    v_exp_f32 v69, v69
    s_nop 0
    v_add_f32 v154, v66, v67
    v_cvt_pk_bf16_f32 v97, v66, v67
    v_add_f32 v13, v13, v154
    s_nop 0
    v_fma_f32 v70, v70, s34, -v12
    v_fma_f32 v71, v71, s34, -v12
    v_exp_f32 v70, v70
    s_nop 0
    s_mov_b32 s58, 0
    s_waitcnt vmcnt(12) lgkmcnt(0)
    s_barrier
    ds_read_b128 v[124:127], v6 offset:24576
    ds_read_b128 v[128:131], v6 offset:30720
    ds_read_b128 v[132:135], v7 offset:24576
    ds_read_b128 v[136:139], v7 offset:30720
    ds_read_b128 v[140:143], v6 offset:25600
    ds_read_b128 v[144:147], v6 offset:31744
    ds_read_b128 v[112:115], v7 offset:25600
    s_waitcnt lgkmcnt(6)
    v_mfma_f32_16x16x32_bf16 v[80:83], v[124:127], v[16:19], 0
    ds_read_b128 v[116:119], v7 offset:31744
    s_add_u32 m0, s29, 0
    s_nop 0
    buffer_load_dwordx4 v1, s[8:11], s31 offen offset:0 sc1 nt lds
    v_mfma_f32_16x16x32_bf16 v[88:91], v[124:127], v[20:23], 0
    v_exp_f32 v71, v71
    v_add_f32 v154, v68, v69
    v_cvt_pk_bf16_f32 v98, v68, v69
    v_add_f32 v13, v13, v154
    s_waitcnt lgkmcnt(6)
    v_mfma_f32_16x16x32_bf16 v[84:87], v[128:131], v[16:19], 0
    ds_read_b128 v[120:123], v6 offset:26624
    s_add_u32 m0, s29, 896
    s_nop 0
    buffer_load_dwordx4 v1, s[8:11], s31 offen offset:128 sc1 nt lds
    v_mfma_f32_16x16x32_bf16 v[92:95], v[128:131], v[20:23], 0
    v_fma_f32 v72, v72, s34, -v156
    v_fma_f32 v73, v73, s34, -v156
    v_exp_f32 v72, v72
    s_waitcnt lgkmcnt(6)
    v_mfma_f32_16x16x32_bf16 v[80:83], v[132:135], v[24:27], v[80:83]
    ds_read_b128 v[124:127], v6 offset:32768
    s_add_u32 m0, s29, 1792
    s_nop 0
    buffer_load_dwordx4 v1, s[8:11], s31 offen offset:256 sc1 nt lds
    s_add_u32 s31, s31, 12288
    s_cmp_eq_u32 s31, 393216
    v_mfma_f32_16x16x32_bf16 v[88:91], v[132:135], v[28:31], v[88:91]
    s_cselect_b32 s31, 0, s31
    s_cmp_eq_u32 s31, s99
    s_cselect_b32 s31, s59, s31
    v_exp_f32 v73, v73
    v_add_f32 v154, v70, v71
    v_cvt_pk_bf16_f32 v99, v70, v71
    s_waitcnt lgkmcnt(6)
    v_mfma_f32_16x16x32_bf16 v[84:87], v[136:139], v[24:27], v[84:87]
    ds_read_b128 v[128:131], v7 offset:26624
    s_mov_b32 m0, 147456
    s_nop 0
    buffer_load_dwordx4 v2, s[12:15], s59 offen lds
    v_mfma_f32_16x16x32_bf16 v[92:95], v[136:139], v[28:31], v[92:95]
    v_add_f32 v13, v13, v154
    v_fma_f32 v74, v74, s34, -v156
    v_fma_f32 v75, v75, s34, -v156
    s_waitcnt lgkmcnt(6)
    v_mfma_f32_16x16x32_bf16 v[80:83], v[140:143], v[32:35], v[80:83]
    ds_read_b128 v[132:135], v7 offset:32768
    s_mov_b32 m0, 147456
    s_nop 0
    buffer_load_dwordx4 v2, s[12:15], s59 offen lds
    v_mfma_f32_16x16x32_bf16 v[88:91], v[140:143], v[36:39], v[88:91]
    v_exp_f32 v74, v74
    v_exp_f32 v75, v75
    v_add_f32 v154, v72, v73
    v_cvt_pk_bf16_f32 v100, v72, v73
    s_waitcnt lgkmcnt(6)
    v_mfma_f32_16x16x32_bf16 v[84:87], v[144:147], v[32:35], v[84:87]
    s_mov_b32 m0, 147456
    s_nop 0
    buffer_load_dwordx4 v2, s[12:15], s59 offen lds
    v_mfma_f32_16x16x32_bf16 v[92:95], v[144:147], v[36:39], v[92:95]
    v_add_f32 v157, v157, v154
    v_fma_f32 v76, v76, s34, -v156
    v_fma_f32 v77, v77, s34, -v156
    s_waitcnt lgkmcnt(5)
    v_mfma_f32_16x16x32_bf16 v[80:83], v[112:115], v[40:43], v[80:83]
    v_exp_f32 v76, v76
    v_exp_f32 v77, v77
    v_mfma_f32_16x16x32_bf16 v[88:91], v[112:115], v[44:47], v[88:91]
    v_add_f32 v154, v74, v75
    s_waitcnt lgkmcnt(4)
    v_mfma_f32_16x16x32_bf16 v[84:87], v[116:119], v[40:43], v[84:87]
    v_cvt_pk_bf16_f32 v101, v74, v75
    v_add_f32 v157, v157, v154
    v_mfma_f32_16x16x32_bf16 v[92:95], v[116:119], v[44:47], v[92:95]
    v_fma_f32 v78, v78, s34, -v156
    v_fma_f32 v79, v79, s34, -v156
L_k1_loop:
    s_waitcnt vmcnt(12) lgkmcnt(0)
    s_barrier
    v_mfma_f32_16x16x32_bf16 v[80:83], v[120:123], v[48:51], v[80:83]
    ds_read_b64_tr_b16 v[136:137], v8 offset:49152
    ds_read_b64_tr_b16 v[138:139], v8 offset:55296
    ds_read_b64_tr_b16 v[140:141], v9 offset:49152
    ds_read_b64_tr_b16 v[142:143], v9 offset:55296
    s_add_u32 m0, s29, 24576
    v_mfma_f32_16x16x32_bf16 v[88:91], v[120:123], v[52:55], v[88:91]
    s_nop 0
    buffer_load_dwordx4 v1, s[8:11], s31 offen offset:0 sc1 nt lds
    v_exp_f32 v78, v78
    v_exp_f32 v79, v79
    v_add_f32 v154, v76, v77
    v_mfma_f32_16x16x32_bf16 v[84:87], v[124:127], v[48:51], v[84:87]
    ds_read_b64_tr_b16 v[144:145], v10 offset:49152
    ds_read_b64_tr_b16 v[146:147], v10 offset:55296
    ds_read_b64_tr_b16 v[112:113], v11 offset:49152
    ds_read_b64_tr_b16 v[114:115], v11 offset:55296
    s_add_u32 m0, s29, 25472
    v_mfma_f32_16x16x32_bf16 v[92:95], v[124:127], v[52:55], v[92:95]
    s_nop 0
    buffer_load_dwordx4 v1, s[8:11], s31 offen offset:128 sc1 nt lds
    v_cvt_pk_bf16_f32 v102, v76, v77
    v_add_f32 v157, v157, v154
    s_nop 0
    v_mfma_f32_16x16x32_bf16 v[80:83], v[128:131], v[56:59], v[80:83]
    ds_read_b64_tr_b16 v[116:117], v8 offset:50176
    ds_read_b64_tr_b16 v[118:119], v8 offset:56320
    ds_read_b64_tr_b16 v[120:121], v9 offset:50176
    ds_read_b64_tr_b16 v[122:123], v9 offset:56320
    s_add_u32 m0, s29, 26368
    s_nop 0
    buffer_load_dwordx4 v1, s[8:11], s31 offen offset:256 sc1 nt lds
    s_add_u32 s31, s31, 12288
    v_mfma_f32_16x16x32_bf16 v[88:91], v[128:131], v[60:63], v[88:91]
    s_cmp_eq_u32 s31, 393216
    s_cselect_b32 s31, 0, s31
    s_cmp_eq_u32 s31, s99
    s_cselect_b32 s31, s59, s31
    v_add_f32 v154, v78, v79
    v_cvt_pk_bf16_f32 v103, v78, v79
    v_add_f32 v157, v157, v154
    v_mfma_f32_16x16x32_bf16 v[84:87], v[132:135], v[56:59], v[84:87]
    ds_read_b64_tr_b16 v[124:125], v10 offset:50176
    v_mfma_f32_16x16x32_bf16 v[92:95], v[132:135], v[60:63], v[92:95]
    ds_read_b64_tr_b16 v[126:127], v10 offset:56320
    s_waitcnt lgkmcnt(12)
    v_mfma_f32_16x16x32_bf16 v[160:163], v[136:139], v[96:99], v[160:163]
    ds_read_b64_tr_b16 v[128:129], v11 offset:50176
    v_mfma_f32_16x16x32_bf16 v[164:167], v[136:139], v[100:103], v[164:167]
    ds_read_b64_tr_b16 v[130:131], v11 offset:56320
    s_waitcnt lgkmcnt(12)
    v_mfma_f32_16x16x32_bf16 v[168:171], v[140:143], v[96:99], v[168:171]
    ds_read_b64_tr_b16 v[132:133], v8 offset:51200
    ds_read_b64_tr_b16 v[134:135], v8 offset:57344
    v_max3_f32 v152, v80, v81, v82
    v_mfma_f32_16x16x32_bf16 v[172:175], v[140:143], v[100:103], v[172:175]
    v_max3_f32 v153, v88, v89, v90
    v_max3_f32 v152, v152, v83, v84
    s_waitcnt lgkmcnt(12)
    v_mfma_f32_16x16x32_bf16 v[176:179], v[144:147], v[96:99], v[176:179]
    ds_read_b64_tr_b16 v[136:137], v9 offset:51200
    ds_read_b64_tr_b16 v[138:139], v9 offset:57344
    v_max3_f32 v153, v153, v91, v92
    v_mfma_f32_16x16x32_bf16 v[180:183], v[144:147], v[100:103], v[180:183]
    v_max3_f32 v152, v152, v85, v86
    v_max3_f32 v153, v153, v93, v94
    s_waitcnt lgkmcnt(12)
    v_mfma_f32_16x16x32_bf16 v[184:187], v[112:115], v[96:99], v[184:187]
    ds_read_b64_tr_b16 v[140:141], v10 offset:51200
    ds_read_b64_tr_b16 v[142:143], v10 offset:57344
    v_max_f32 v152, v152, v87
    v_mfma_f32_16x16x32_bf16 v[188:191], v[112:115], v[100:103], v[188:191]
    v_max_f32 v153, v153, v95
    v_fma_f32 v154, v152, s34, -v15
    s_waitcnt lgkmcnt(12)
    v_mfma_f32_16x16x32_bf16 v[192:195], v[116:119], v[96:99], v[192:195]
    ds_read_b64_tr_b16 v[144:145], v11 offset:51200
    ds_read_b64_tr_b16 v[146:147], v11 offset:57344
    v_mfma_f32_16x16x32_bf16 v[196:199], v[116:119], v[100:103], v[196:199]
    v_fma_f32 v155, v153, s34, -v159
    v_max_f32 v154, v154, v155
    v_cmp_lt_f32 vcc, 0, v154
    s_cbranch_vccnz L_rareA2
L_backA2:
    s_waitcnt lgkmcnt(12)
    v_mfma_f32_16x16x32_bf16 v[200:203], v[120:123], v[96:99], v[200:203]
    v_fma_f32 v80, v80, s34, -v12
    v_fma_f32 v81, v81, s34, -v12
    v_mfma_f32_16x16x32_bf16 v[204:207], v[120:123], v[100:103], v[204:207]
    v_exp_f32 v80, v80
    s_waitcnt lgkmcnt(10)
    v_mfma_f32_16x16x32_bf16 v[208:211], v[124:127], v[96:99], v[208:211]
    v_exp_f32 v81, v81
    v_fma_f32 v82, v82, s34, -v12
    v_mfma_f32_16x16x32_bf16 v[212:215], v[124:127], v[100:103], v[212:215]
    v_fma_f32 v83, v83, s34, -v12
    s_waitcnt lgkmcnt(8)
    v_mfma_f32_16x16x32_bf16 v[216:219], v[128:131], v[96:99], v[216:219]
    v_exp_f32 v82, v82
    v_exp_f32 v83, v83
    v_mfma_f32_16x16x32_bf16 v[220:223], v[128:131], v[100:103], v[220:223]
    v_add_f32 v154, v80, v81
    s_waitcnt vmcnt(12) lgkmcnt(0)
    s_barrier
    v_mfma_f32_16x16x32_bf16 v[224:227], v[132:135], v[96:99], v[224:227]
    ds_read_b128 v[112:115], v6 offset:49152
    ds_read_b128 v[116:119], v6 offset:55296
    s_add_u32 m0, s29, 122880
    s_nop 0
    v_mfma_f32_16x16x32_bf16 v[228:231], v[132:135], v[100:103], v[228:231]
    buffer_load_dwordx4 v2, s[12:15], s32 offen offset:0 sc1 nt lds
    v_cvt_pk_bf16_f32 v104, v80, v81
    v_add_f32 v13, v13, v154
    v_fma_f32 v84, v84, s34, -v12
    v_mfma_f32_16x16x32_bf16 v[232:235], v[136:139], v[96:99], v[232:235]
    ds_read_b128 v[120:123], v7 offset:49152
    ds_read_b128 v[124:127], v7 offset:55296
    s_add_u32 m0, s29, 123776
    s_nop 0
    v_mfma_f32_16x16x32_bf16 v[236:239], v[136:139], v[100:103], v[236:239]
    buffer_load_dwordx4 v2, s[12:15], s32 offen offset:128 sc1 nt lds
    v_fma_f32 v85, v85, s34, -v12
    v_exp_f32 v84, v84
    v_exp_f32 v85, v85
    v_mfma_f32_16x16x32_bf16 v[240:243], v[140:143], v[96:99], v[240:243]
    ds_read_b128 v[128:131], v6 offset:50176
    ds_read_b128 v[132:135], v6 offset:56320
    s_add_u32 m0, s29, 124672
    s_nop 0
    buffer_load_dwordx4 v2, s[12:15], s32 offen offset:256 sc1 nt lds
    s_add_u32 s32, s32, 12288
    s_cmp_eq_u32 s32, 393216
    v_mfma_f32_16x16x32_bf16 v[244:247], v[140:143], v[100:103], v[244:247]
    s_cselect_b32 s32, 0, s32
    s_cmp_eq_u32 s32, s99
    s_cselect_b32 s32, s59, s32
    v_add_f32 v154, v82, v83
    v_cvt_pk_bf16_f32 v105, v82, v83
    v_add_f32 v13, v13, v154
    v_mfma_f32_16x16x32_bf16 v[248:251], v[144:147], v[96:99], v[248:251]
    ds_read_b128 v[136:139], v7 offset:50176
    v_fma_f32 v86, v86, s34, -v12
    v_mfma_f32_16x16x32_bf16 v[252:255], v[144:147], v[100:103], v[252:255]
    v_fma_f32 v87, v87, s34, -v12
    v_exp_f32 v86, v86
    s_cmp_lg_u32 s58, 0
    s_cbranch_scc1 L_rareB3
L_backB3:
    s_waitcnt lgkmcnt(6)
    v_mfma_f32_16x16x32_bf16 v[64:67], v[112:115], v[16:19], 0
    ds_read_b128 v[140:143], v7 offset:56320
    v_exp_f32 v87, v87
    v_add_f32 v154, v84, v85
    v_mfma_f32_16x16x32_bf16 v[72:75], v[112:115], v[20:23], 0
    v_cvt_pk_bf16_f32 v106, v84, v85
    v_add_f32 v13, v13, v154
    s_waitcnt lgkmcnt(6)
    v_mfma_f32_16x16x32_bf16 v[68:71], v[116:119], v[16:19], 0
    ds_read_b128 v[144:147], v6 offset:51200
    v_fma_f32 v88, v88, s34, -v156
    v_mfma_f32_16x16x32_bf16 v[76:79], v[116:119], v[20:23], 0
    v_fma_f32 v89, v89, s34, -v156
    v_exp_f32 v88, v88
    s_waitcnt lgkmcnt(6)
    v_mfma_f32_16x16x32_bf16 v[64:67], v[120:123], v[24:27], v[64:67]
    ds_read_b128 v[112:115], v6 offset:57344
    v_exp_f32 v89, v89
    v_mfma_f32_16x16x32_bf16 v[72:75], v[120:123], v[28:31], v[72:75]
    v_add_f32 v154, v86, v87
    v_cvt_pk_bf16_f32 v107, v86, v87
    s_waitcnt lgkmcnt(6)
    v_mfma_f32_16x16x32_bf16 v[68:71], v[124:127], v[24:27], v[68:71]
    ds_read_b128 v[116:119], v7 offset:51200
    v_add_f32 v13, v13, v154
    v_mfma_f32_16x16x32_bf16 v[76:79], v[124:127], v[28:31], v[76:79]
    v_fma_f32 v90, v90, s34, -v156
    v_fma_f32 v91, v91, s34, -v156
    s_waitcnt lgkmcnt(6)
    v_mfma_f32_16x16x32_bf16 v[64:67], v[128:131], v[32:35], v[64:67]
    ds_read_b128 v[120:123], v7 offset:57344
    v_exp_f32 v90, v90
    v_exp_f32 v91, v91
    v_mfma_f32_16x16x32_bf16 v[72:75], v[128:131], v[36:39], v[72:75]
    v_add_f32 v154, v88, v89
    v_cvt_pk_bf16_f32 v108, v88, v89
    s_waitcnt lgkmcnt(6)
    v_mfma_f32_16x16x32_bf16 v[68:71], v[132:135], v[32:35], v[68:71]
    v_add_f32 v157, v157, v154
    v_fma_f32 v92, v92, s34, -v156
    v_mfma_f32_16x16x32_bf16 v[76:79], v[132:135], v[36:39], v[76:79]
    v_fma_f32 v93, v93, s34, -v156
    s_waitcnt lgkmcnt(5)
    v_mfma_f32_16x16x32_bf16 v[64:67], v[136:139], v[40:43], v[64:67]
    v_exp_f32 v92, v92
    v_exp_f32 v93, v93
    v_mfma_f32_16x16x32_bf16 v[72:75], v[136:139], v[44:47], v[72:75]
    v_add_f32 v154, v90, v91
    s_waitcnt lgkmcnt(4)
    v_mfma_f32_16x16x32_bf16 v[68:71], v[140:143], v[40:43], v[68:71]
    v_cvt_pk_bf16_f32 v109, v90, v91
    v_add_f32 v157, v157, v154
    v_mfma_f32_16x16x32_bf16 v[76:79], v[140:143], v[44:47], v[76:79]
    v_fma_f32 v94, v94, s34, -v156
    v_fma_f32 v95, v95, s34, -v156
    s_waitcnt vmcnt(12) lgkmcnt(0)
    s_barrier
    v_mfma_f32_16x16x32_bf16 v[64:67], v[144:147], v[48:51], v[64:67]
    ds_read_b64_tr_b16 v[124:125], v8 offset:0
    ds_read_b64_tr_b16 v[126:127], v8 offset:6144
    ds_read_b64_tr_b16 v[128:129], v9 offset:0
    ds_read_b64_tr_b16 v[130:131], v9 offset:6144
    s_add_u32 m0, s29, 49152
    v_mfma_f32_16x16x32_bf16 v[72:75], v[144:147], v[52:55], v[72:75]
    s_nop 0
    buffer_load_dwordx4 v1, s[8:11], s31 offen offset:0 sc1 nt lds
    v_exp_f32 v94, v94
    v_exp_f32 v95, v95
    v_add_f32 v154, v92, v93
    v_mfma_f32_16x16x32_bf16 v[68:71], v[112:115], v[48:51], v[68:71]
    ds_read_b64_tr_b16 v[132:133], v10 offset:0
    ds_read_b64_tr_b16 v[134:135], v10 offset:6144
    ds_read_b64_tr_b16 v[136:137], v11 offset:0
    ds_read_b64_tr_b16 v[138:139], v11 offset:6144
    s_add_u32 m0, s29, 50048
    v_mfma_f32_16x16x32_bf16 v[76:79], v[112:115], v[52:55], v[76:79]
    s_nop 0
    buffer_load_dwordx4 v1, s[8:11], s31 offen offset:128 sc1 nt lds
    v_cvt_pk_bf16_f32 v110, v92, v93
    v_add_f32 v157, v157, v154
    s_nop 0
    v_mfma_f32_16x16x32_bf16 v[64:67], v[116:119], v[56:59], v[64:67]
    ds_read_b64_tr_b16 v[140:141], v8 offset:1024
    ds_read_b64_tr_b16 v[142:143], v8 offset:7168
    ds_read_b64_tr_b16 v[144:145], v9 offset:1024
    ds_read_b64_tr_b16 v[146:147], v9 offset:7168
    s_add_u32 m0, s29, 50944
    s_nop 0
    buffer_load_dwordx4 v1, s[8:11], s31 offen offset:256 sc1 nt lds
    s_add_u32 s31, s31, 12288
    v_mfma_f32_16x16x32_bf16 v[72:75], v[116:119], v[60:63], v[72:75]
    s_cmp_eq_u32 s31, 393216
    s_cselect_b32 s31, 0, s31
    s_cmp_eq_u32 s31, s99
    s_cselect_b32 s31, s59, s31
    v_add_f32 v154, v94, v95
    v_cvt_pk_bf16_f32 v111, v94, v95
    v_add_f32 v157, v157, v154
    v_mfma_f32_16x16x32_bf16 v[68:71], v[120:123], v[56:59], v[68:71]
    ds_read_b64_tr_b16 v[112:113], v10 offset:1024
    v_mfma_f32_16x16x32_bf16 v[76:79], v[120:123], v[60:63], v[76:79]
    ds_read_b64_tr_b16 v[114:115], v10 offset:7168
    s_waitcnt lgkmcnt(12)
    v_mfma_f32_16x16x32_bf16 v[160:163], v[124:127], v[104:107], v[160:163]
    ds_read_b64_tr_b16 v[116:117], v11 offset:1024
    v_mfma_f32_16x16x32_bf16 v[164:167], v[124:127], v[108:111], v[164:167]
    ds_read_b64_tr_b16 v[118:119], v11 offset:7168
    s_waitcnt lgkmcnt(12)
    v_mfma_f32_16x16x32_bf16 v[168:171], v[128:131], v[104:107], v[168:171]
    ds_read_b64_tr_b16 v[120:121], v8 offset:2048
    ds_read_b64_tr_b16 v[122:123], v8 offset:8192
    v_max3_f32 v152, v64, v65, v66
    v_mfma_f32_16x16x32_bf16 v[172:175], v[128:131], v[108:111], v[172:175]
    v_max3_f32 v153, v72, v73, v74
    v_max3_f32 v152, v152, v67, v68
    s_waitcnt lgkmcnt(12)
    v_mfma_f32_16x16x32_bf16 v[176:179], v[132:135], v[104:107], v[176:179]
    ds_read_b64_tr_b16 v[124:125], v9 offset:2048
    ds_read_b64_tr_b16 v[126:127], v9 offset:8192
    v_max3_f32 v153, v153, v75, v76
    v_mfma_f32_16x16x32_bf16 v[180:183], v[132:135], v[108:111], v[180:183]
    v_max3_f32 v152, v152, v69, v70
    v_max3_f32 v153, v153, v77, v78
    s_waitcnt lgkmcnt(12)
    v_mfma_f32_16x16x32_bf16 v[184:187], v[136:139], v[104:107], v[184:187]
    ds_read_b64_tr_b16 v[128:129], v10 offset:2048
    ds_read_b64_tr_b16 v[130:131], v10 offset:8192
    v_max_f32 v152, v152, v71
    v_mfma_f32_16x16x32_bf16 v[188:191], v[136:139], v[108:111], v[188:191]
    v_max_f32 v153, v153, v79
    v_fma_f32 v154, v152, s34, -v15
    s_waitcnt lgkmcnt(12)
    v_mfma_f32_16x16x32_bf16 v[192:195], v[140:143], v[104:107], v[192:195]
    ds_read_b64_tr_b16 v[132:133], v11 offset:2048
    ds_read_b64_tr_b16 v[134:135], v11 offset:8192
    v_mfma_f32_16x16x32_bf16 v[196:199], v[140:143], v[108:111], v[196:199]
    v_fma_f32 v155, v153, s34, -v159
    v_max_f32 v154, v154, v155
    v_cmp_lt_f32 vcc, 0, v154
    s_cbranch_vccnz L_rareA4
L_backA4:
    s_waitcnt lgkmcnt(12)
    v_mfma_f32_16x16x32_bf16 v[200:203], v[144:147], v[104:107], v[200:203]
    v_fma_f32 v64, v64, s34, -v12
    v_fma_f32 v65, v65, s34, -v12
    v_mfma_f32_16x16x32_bf16 v[204:207], v[144:147], v[108:111], v[204:207]
    v_exp_f32 v64, v64
    s_waitcnt lgkmcnt(10)
    v_mfma_f32_16x16x32_bf16 v[208:211], v[112:115], v[104:107], v[208:211]
    v_exp_f32 v65, v65
    v_fma_f32 v66, v66, s34, -v12
    v_mfma_f32_16x16x32_bf16 v[212:215], v[112:115], v[108:111], v[212:215]
    v_fma_f32 v67, v67, s34, -v12
    s_waitcnt lgkmcnt(8)
    v_mfma_f32_16x16x32_bf16 v[216:219], v[116:119], v[104:107], v[216:219]
    v_exp_f32 v66, v66
    v_exp_f32 v67, v67
    v_mfma_f32_16x16x32_bf16 v[220:223], v[116:119], v[108:111], v[220:223]
    v_add_f32 v154, v64, v65
    s_waitcnt vmcnt(12) lgkmcnt(0)
    s_barrier
    v_mfma_f32_16x16x32_bf16 v[224:227], v[120:123], v[104:107], v[224:227]
    ds_read_b128 v[136:139], v6 offset:0
    ds_read_b128 v[140:143], v6 offset:6144
    s_add_u32 m0, s29, 73728
    s_nop 0
    v_mfma_f32_16x16x32_bf16 v[228:231], v[120:123], v[108:111], v[228:231]
    buffer_load_dwordx4 v2, s[12:15], s32 offen offset:0 sc1 nt lds
    v_cvt_pk_bf16_f32 v96, v64, v65
    v_add_f32 v13, v13, v154
    v_fma_f32 v68, v68, s34, -v12
    v_mfma_f32_16x16x32_bf16 v[232:235], v[124:127], v[104:107], v[232:235]
    ds_read_b128 v[144:147], v7 offset:0
    ds_read_b128 v[112:115], v7 offset:6144
    s_add_u32 m0, s29, 74624
    s_nop 0
    v_mfma_f32_16x16x32_bf16 v[236:239], v[124:127], v[108:111], v[236:239]
    buffer_load_dwordx4 v2, s[12:15], s32 offen offset:128 sc1 nt lds
    v_fma_f32 v69, v69, s34, -v12
    v_exp_f32 v68, v68
    v_exp_f32 v69, v69
    v_mfma_f32_16x16x32_bf16 v[240:243], v[128:131], v[104:107], v[240:243]
    ds_read_b128 v[116:119], v6 offset:1024
    ds_read_b128 v[120:123], v6 offset:7168
    s_add_u32 m0, s29, 75520
    s_nop 0
    buffer_load_dwordx4 v2, s[12:15], s32 offen offset:256 sc1 nt lds
    s_add_u32 s32, s32, 12288
    s_cmp_eq_u32 s32, 393216
    v_mfma_f32_16x16x32_bf16 v[244:247], v[128:131], v[108:111], v[244:247]
    s_cselect_b32 s32, 0, s32
    s_cmp_eq_u32 s32, s99
    s_cselect_b32 s32, s59, s32
    v_add_f32 v154, v66, v67
    v_cvt_pk_bf16_f32 v97, v66, v67
    v_add_f32 v13, v13, v154
    v_mfma_f32_16x16x32_bf16 v[248:251], v[132:135], v[104:107], v[248:251]
    ds_read_b128 v[124:127], v7 offset:1024
    v_fma_f32 v70, v70, s34, -v12
    v_mfma_f32_16x16x32_bf16 v[252:255], v[132:135], v[108:111], v[252:255]
    v_fma_f32 v71, v71, s34, -v12
    v_exp_f32 v70, v70
    s_cmp_lg_u32 s58, 0
    s_cbranch_scc1 L_rareB5
L_backB5:
    s_waitcnt lgkmcnt(6)
    v_mfma_f32_16x16x32_bf16 v[80:83], v[136:139], v[16:19], 0
    ds_read_b128 v[128:131], v7 offset:7168
    v_exp_f32 v71, v71
    v_add_f32 v154, v68, v69
    v_mfma_f32_16x16x32_bf16 v[88:91], v[136:139], v[20:23], 0
    v_cvt_pk_bf16_f32 v98, v68, v69
    v_add_f32 v13, v13, v154
    s_waitcnt lgkmcnt(6)
    v_mfma_f32_16x16x32_bf16 v[84:87], v[140:143], v[16:19], 0
    ds_read_b128 v[132:135], v6 offset:2048
    v_fma_f32 v72, v72, s34, -v156
    v_mfma_f32_16x16x32_bf16 v[92:95], v[140:143], v[20:23], 0
    v_fma_f32 v73, v73, s34, -v156
    v_exp_f32 v72, v72
    s_waitcnt lgkmcnt(6)
    v_mfma_f32_16x16x32_bf16 v[80:83], v[144:147], v[24:27], v[80:83]
    ds_read_b128 v[136:139], v6 offset:8192
    v_exp_f32 v73, v73
    v_mfma_f32_16x16x32_bf16 v[88:91], v[144:147], v[28:31], v[88:91]
    v_add_f32 v154, v70, v71
    v_cvt_pk_bf16_f32 v99, v70, v71
    s_waitcnt lgkmcnt(6)
    v_mfma_f32_16x16x32_bf16 v[84:87], v[112:115], v[24:27], v[84:87]
    ds_read_b128 v[140:143], v7 offset:2048
    v_add_f32 v13, v13, v154
    v_mfma_f32_16x16x32_bf16 v[92:95], v[112:115], v[28:31], v[92:95]
    v_fma_f32 v74, v74, s34, -v156
    v_fma_f32 v75, v75, s34, -v156
    s_waitcnt lgkmcnt(6)
    v_mfma_f32_16x16x32_bf16 v[80:83], v[116:119], v[32:35], v[80:83]
    ds_read_b128 v[144:147], v7 offset:8192
    v_exp_f32 v74, v74
    v_exp_f32 v75, v75
    v_mfma_f32_16x16x32_bf16 v[88:91], v[116:119], v[36:39], v[88:91]
    v_add_f32 v154, v72, v73
    v_cvt_pk_bf16_f32 v100, v72, v73
    s_waitcnt lgkmcnt(6)
    v_mfma_f32_16x16x32_bf16 v[84:87], v[120:123], v[32:35], v[84:87]
    v_add_f32 v157, v157, v154
    v_fma_f32 v76, v76, s34, -v156
    v_mfma_f32_16x16x32_bf16 v[92:95], v[120:123], v[36:39], v[92:95]
    v_fma_f32 v77, v77, s34, -v156
    s_waitcnt lgkmcnt(5)
    v_mfma_f32_16x16x32_bf16 v[80:83], v[124:127], v[40:43], v[80:83]
    v_exp_f32 v76, v76
    v_exp_f32 v77, v77
    v_mfma_f32_16x16x32_bf16 v[88:91], v[124:127], v[44:47], v[88:91]
    v_add_f32 v154, v74, v75
    s_waitcnt lgkmcnt(4)
    v_mfma_f32_16x16x32_bf16 v[84:87], v[128:131], v[40:43], v[84:87]
    v_cvt_pk_bf16_f32 v101, v74, v75
    v_add_f32 v157, v157, v154
    v_mfma_f32_16x16x32_bf16 v[92:95], v[128:131], v[44:47], v[92:95]
    v_fma_f32 v78, v78, s34, -v156
    v_fma_f32 v79, v79, s34, -v156
    s_waitcnt vmcnt(12) lgkmcnt(0)
    s_barrier
    v_mfma_f32_16x16x32_bf16 v[80:83], v[132:135], v[48:51], v[80:83]
    ds_read_b64_tr_b16 v[112:113], v8 offset:24576
    ds_read_b64_tr_b16 v[114:115], v8 offset:30720
    ds_read_b64_tr_b16 v[116:117], v9 offset:24576
    ds_read_b64_tr_b16 v[118:119], v9 offset:30720
    s_add_u32 m0, s29, 0
    v_mfma_f32_16x16x32_bf16 v[88:91], v[132:135], v[52:55], v[88:91]
    s_nop 0
    buffer_load_dwordx4 v1, s[8:11], s31 offen offset:0 sc1 nt lds
    v_exp_f32 v78, v78
    v_exp_f32 v79, v79
    v_add_f32 v154, v76, v77
    v_mfma_f32_16x16x32_bf16 v[84:87], v[136:139], v[48:51], v[84:87]
    ds_read_b64_tr_b16 v[120:121], v10 offset:24576
    ds_read_b64_tr_b16 v[122:123], v10 offset:30720
    ds_read_b64_tr_b16 v[124:125], v11 offset:24576
    ds_read_b64_tr_b16 v[126:127], v11 offset:30720
    s_add_u32 m0, s29, 896
    v_mfma_f32_16x16x32_bf16 v[92:95], v[136:139], v[52:55], v[92:95]
    s_nop 0
    buffer_load_dwordx4 v1, s[8:11], s31 offen offset:128 sc1 nt lds
    v_cvt_pk_bf16_f32 v102, v76, v77
    v_add_f32 v157, v157, v154
    s_nop 0
    v_mfma_f32_16x16x32_bf16 v[80:83], v[140:143], v[56:59], v[80:83]
    ds_read_b64_tr_b16 v[128:129], v8 offset:25600
    ds_read_b64_tr_b16 v[130:131], v8 offset:31744
    ds_read_b64_tr_b16 v[132:133], v9 offset:25600
    ds_read_b64_tr_b16 v[134:135], v9 offset:31744
    s_add_u32 m0, s29, 1792
    s_nop 0
    buffer_load_dwordx4 v1, s[8:11], s31 offen offset:256 sc1 nt lds
    s_add_u32 s31, s31, 12288
    v_mfma_f32_16x16x32_bf16 v[88:91], v[140:143], v[60:63], v[88:91]
    s_cmp_eq_u32 s31, 393216
    s_cselect_b32 s31, 0, s31
    s_cmp_eq_u32 s31, s99
    s_cselect_b32 s31, s59, s31
    v_add_f32 v154, v78, v79
    v_cvt_pk_bf16_f32 v103, v78, v79
    v_add_f32 v157, v157, v154
    v_mfma_f32_16x16x32_bf16 v[84:87], v[144:147], v[56:59], v[84:87]
    ds_read_b64_tr_b16 v[136:137], v10 offset:25600
    v_mfma_f32_16x16x32_bf16 v[92:95], v[144:147], v[60:63], v[92:95]
    ds_read_b64_tr_b16 v[138:139], v10 offset:31744
    s_waitcnt lgkmcnt(12)
    v_mfma_f32_16x16x32_bf16 v[160:163], v[112:115], v[96:99], v[160:163]
    ds_read_b64_tr_b16 v[140:141], v11 offset:25600
    v_mfma_f32_16x16x32_bf16 v[164:167], v[112:115], v[100:103], v[164:167]
    ds_read_b64_tr_b16 v[142:143], v11 offset:31744
    s_waitcnt lgkmcnt(12)
    v_mfma_f32_16x16x32_bf16 v[168:171], v[116:119], v[96:99], v[168:171]
    ds_read_b64_tr_b16 v[144:145], v8 offset:26624
    ds_read_b64_tr_b16 v[146:147], v8 offset:32768
    v_max3_f32 v152, v80, v81, v82
    v_mfma_f32_16x16x32_bf16 v[172:175], v[116:119], v[100:103], v[172:175]
    v_max3_f32 v153, v88, v89, v90
    v_max3_f32 v152, v152, v83, v84
    s_waitcnt lgkmcnt(12)
    v_mfma_f32_16x16x32_bf16 v[176:179], v[120:123], v[96:99], v[176:179]
    ds_read_b64_tr_b16 v[112:113], v9 offset:26624
    ds_read_b64_tr_b16 v[114:115], v9 offset:32768
    v_max3_f32 v153, v153, v91, v92
    v_mfma_f32_16x16x32_bf16 v[180:183], v[120:123], v[100:103], v[180:183]
    v_max3_f32 v152, v152, v85, v86
    v_max3_f32 v153, v153, v93, v94
    s_waitcnt lgkmcnt(12)
    v_mfma_f32_16x16x32_bf16 v[184:187], v[124:127], v[96:99], v[184:187]
    ds_read_b64_tr_b16 v[116:117], v10 offset:26624
    ds_read_b64_tr_b16 v[118:119], v10 offset:32768
    v_max_f32 v152, v152, v87
    v_mfma_f32_16x16x32_bf16 v[188:191], v[124:127], v[100:103], v[188:191]
    v_max_f32 v153, v153, v95
    v_fma_f32 v154, v152, s34, -v15
    s_waitcnt lgkmcnt(12)
    v_mfma_f32_16x16x32_bf16 v[192:195], v[128:131], v[96:99], v[192:195]
    ds_read_b64_tr_b16 v[120:121], v11 offset:26624
    ds_read_b64_tr_b16 v[122:123], v11 offset:32768
    v_mfma_f32_16x16x32_bf16 v[196:199], v[128:131], v[100:103], v[196:199]
    v_fma_f32 v155, v153, s34, -v159
    v_max_f32 v154, v154, v155
    v_cmp_lt_f32 vcc, 0, v154
    s_cbranch_vccnz L_rareA6
L_backA6:
    s_waitcnt lgkmcnt(12)
    v_mfma_f32_16x16x32_bf16 v[200:203], v[132:135], v[96:99], v[200:203]
    v_fma_f32 v80, v80, s34, -v12
    v_fma_f32 v81, v81, s34, -v12
    v_mfma_f32_16x16x32_bf16 v[204:207], v[132:135], v[100:103], v[204:207]
    v_exp_f32 v80, v80
    s_waitcnt lgkmcnt(10)
    v_mfma_f32_16x16x32_bf16 v[208:211], v[136:139], v[96:99], v[208:211]
    v_exp_f32 v81, v81
    v_fma_f32 v82, v82, s34, -v12
    v_mfma_f32_16x16x32_bf16 v[212:215], v[136:139], v[100:103], v[212:215]
    v_fma_f32 v83, v83, s34, -v12
    s_waitcnt lgkmcnt(8)
    v_mfma_f32_16x16x32_bf16 v[216:219], v[140:143], v[96:99], v[216:219]
    v_exp_f32 v82, v82
    v_exp_f32 v83, v83
    v_mfma_f32_16x16x32_bf16 v[220:223], v[140:143], v[100:103], v[220:223]
    v_add_f32 v154, v80, v81
    s_waitcnt vmcnt(12) lgkmcnt(0)
    s_barrier
    v_mfma_f32_16x16x32_bf16 v[224:227], v[144:147], v[96:99], v[224:227]
    ds_read_b128 v[124:127], v6 offset:24576
    ds_read_b128 v[128:131], v6 offset:30720
    s_add_u32 m0, s29, 98304
    s_nop 0
    v_mfma_f32_16x16x32_bf16 v[228:231], v[144:147], v[100:103], v[228:231]
    buffer_load_dwordx4 v2, s[12:15], s32 offen offset:0 sc1 nt lds
    v_cvt_pk_bf16_f32 v104, v80, v81
    v_add_f32 v13, v13, v154
    v_fma_f32 v84, v84, s34, -v12
    v_mfma_f32_16x16x32_bf16 v[232:235], v[112:115], v[96:99], v[232:235]
    ds_read_b128 v[132:135], v7 offset:24576
    ds_read_b128 v[136:139], v7 offset:30720
    s_add_u32 m0, s29, 99200
    s_nop 0
    v_mfma_f32_16x16x32_bf16 v[236:239], v[112:115], v[100:103], v[236:239]
    buffer_load_dwordx4 v2, s[12:15], s32 offen offset:128 sc1 nt lds
    v_fma_f32 v85, v85, s34, -v12
    v_exp_f32 v84, v84
    v_exp_f32 v85, v85
    v_mfma_f32_16x16x32_bf16 v[240:243], v[116:119], v[96:99], v[240:243]
    ds_read_b128 v[140:143], v6 offset:25600
    ds_read_b128 v[144:147], v6 offset:31744
    s_add_u32 m0, s29, 100096
    s_nop 0
    buffer_load_dwordx4 v2, s[12:15], s32 offen offset:256 sc1 nt lds
    s_add_u32 s32, s32, 12288
    s_cmp_eq_u32 s32, 393216
    v_mfma_f32_16x16x32_bf16 v[244:247], v[116:119], v[100:103], v[244:247]
    s_cselect_b32 s32, 0, s32
    s_cmp_eq_u32 s32, s99
    s_cselect_b32 s32, s59, s32
    v_add_f32 v154, v82, v83
    v_cvt_pk_bf16_f32 v105, v82, v83
    v_add_f32 v13, v13, v154
    v_mfma_f32_16x16x32_bf16 v[248:251], v[120:123], v[96:99], v[248:251]
    ds_read_b128 v[112:115], v7 offset:25600
    v_fma_f32 v86, v86, s34, -v12
    v_mfma_f32_16x16x32_bf16 v[252:255], v[120:123], v[100:103], v[252:255]
    v_fma_f32 v87, v87, s34, -v12
    v_exp_f32 v86, v86
    s_cmp_lg_u32 s58, 0
    s_cbranch_scc1 L_rareB7
L_backB7:
    s_waitcnt lgkmcnt(6)
    v_mfma_f32_16x16x32_bf16 v[64:67], v[124:127], v[16:19], 0
    ds_read_b128 v[116:119], v7 offset:31744
    v_exp_f32 v87, v87
    v_add_f32 v154, v84, v85
    v_mfma_f32_16x16x32_bf16 v[72:75], v[124:127], v[20:23], 0
    v_cvt_pk_bf16_f32 v106, v84, v85
    v_add_f32 v13, v13, v154
    s_waitcnt lgkmcnt(6)
    v_mfma_f32_16x16x32_bf16 v[68:71], v[128:131], v[16:19], 0
    ds_read_b128 v[120:123], v6 offset:26624
    v_fma_f32 v88, v88, s34, -v156
    v_mfma_f32_16x16x32_bf16 v[76:79], v[128:131], v[20:23], 0
    v_fma_f32 v89, v89, s34, -v156
    v_exp_f32 v88, v88
    s_waitcnt lgkmcnt(6)
    v_mfma_f32_16x16x32_bf16 v[64:67], v[132:135], v[24:27], v[64:67]
    ds_read_b128 v[124:127], v6 offset:32768
    v_exp_f32 v89, v89
    v_mfma_f32_16x16x32_bf16 v[72:75], v[132:135], v[28:31], v[72:75]
    v_add_f32 v154, v86, v87
    v_cvt_pk_bf16_f32 v107, v86, v87
    s_waitcnt lgkmcnt(6)
    v_mfma_f32_16x16x32_bf16 v[68:71], v[136:139], v[24:27], v[68:71]
    ds_read_b128 v[128:131], v7 offset:26624
    v_add_f32 v13, v13, v154
    v_mfma_f32_16x16x32_bf16 v[76:79], v[136:139], v[28:31], v[76:79]
    v_fma_f32 v90, v90, s34, -v156
    v_fma_f32 v91, v91, s34, -v156
    s_waitcnt lgkmcnt(6)
    v_mfma_f32_16x16x32_bf16 v[64:67], v[140:143], v[32:35], v[64:67]
    ds_read_b128 v[132:135], v7 offset:32768
    v_exp_f32 v90, v90
    v_exp_f32 v91, v91
    v_mfma_f32_16x16x32_bf16 v[72:75], v[140:143], v[36:39], v[72:75]
    v_add_f32 v154, v88, v89
    v_cvt_pk_bf16_f32 v108, v88, v89
    s_waitcnt lgkmcnt(6)
    v_mfma_f32_16x16x32_bf16 v[68:71], v[144:147], v[32:35], v[68:71]
    v_add_f32 v157, v157, v154
    v_fma_f32 v92, v92, s34, -v156
    v_mfma_f32_16x16x32_bf16 v[76:79], v[144:147], v[36:39], v[76:79]
    v_fma_f32 v93, v93, s34, -v156
    s_waitcnt lgkmcnt(5)
    v_mfma_f32_16x16x32_bf16 v[64:67], v[112:115], v[40:43], v[64:67]
    v_exp_f32 v92, v92
    v_exp_f32 v93, v93
    v_mfma_f32_16x16x32_bf16 v[72:75], v[112:115], v[44:47], v[72:75]
    v_add_f32 v154, v90, v91
    s_waitcnt lgkmcnt(4)
    v_mfma_f32_16x16x32_bf16 v[68:71], v[116:119], v[40:43], v[68:71]
    v_cvt_pk_bf16_f32 v109, v90, v91
    v_add_f32 v157, v157, v154
    v_mfma_f32_16x16x32_bf16 v[76:79], v[116:119], v[44:47], v[76:79]
    v_fma_f32 v94, v94, s34, -v156
    v_fma_f32 v95, v95, s34, -v156
    s_waitcnt vmcnt(12) lgkmcnt(0)
    s_barrier
    v_mfma_f32_16x16x32_bf16 v[64:67], v[120:123], v[48:51], v[64:67]
    ds_read_b64_tr_b16 v[136:137], v8 offset:49152
    ds_read_b64_tr_b16 v[138:139], v8 offset:55296
    ds_read_b64_tr_b16 v[140:141], v9 offset:49152
    ds_read_b64_tr_b16 v[142:143], v9 offset:55296
    s_add_u32 m0, s29, 24576
    v_mfma_f32_16x16x32_bf16 v[72:75], v[120:123], v[52:55], v[72:75]
    s_nop 0
    buffer_load_dwordx4 v1, s[8:11], s31 offen offset:0 sc1 nt lds
    v_exp_f32 v94, v94
    v_exp_f32 v95, v95
    v_add_f32 v154, v92, v93
    v_mfma_f32_16x16x32_bf16 v[68:71], v[124:127], v[48:51], v[68:71]
    ds_read_b64_tr_b16 v[144:145], v10 offset:49152
    ds_read_b64_tr_b16 v[146:147], v10 offset:55296
    ds_read_b64_tr_b16 v[112:113], v11 offset:49152
    ds_read_b64_tr_b16 v[114:115], v11 offset:55296
    s_add_u32 m0, s29, 25472
    v_mfma_f32_16x16x32_bf16 v[76:79], v[124:127], v[52:55], v[76:79]
    s_nop 0
    buffer_load_dwordx4 v1, s[8:11], s31 offen offset:128 sc1 nt lds
    v_cvt_pk_bf16_f32 v110, v92, v93
    v_add_f32 v157, v157, v154
    s_nop 0
    v_mfma_f32_16x16x32_bf16 v[64:67], v[128:131], v[56:59], v[64:67]
    ds_read_b64_tr_b16 v[116:117], v8 offset:50176
    ds_read_b64_tr_b16 v[118:119], v8 offset:56320
    ds_read_b64_tr_b16 v[120:121], v9 offset:50176
    ds_read_b64_tr_b16 v[122:123], v9 offset:56320
    s_add_u32 m0, s29, 26368
    s_nop 0
    buffer_load_dwordx4 v1, s[8:11], s31 offen offset:256 sc1 nt lds
    s_add_u32 s31, s31, 12288
    v_mfma_f32_16x16x32_bf16 v[72:75], v[128:131], v[60:63], v[72:75]
    s_cmp_eq_u32 s31, 393216
    s_cselect_b32 s31, 0, s31
    s_cmp_eq_u32 s31, s99
    s_cselect_b32 s31, s59, s31
    v_add_f32 v154, v94, v95
    v_cvt_pk_bf16_f32 v111, v94, v95
    v_add_f32 v157, v157, v154
    v_mfma_f32_16x16x32_bf16 v[68:71], v[132:135], v[56:59], v[68:71]
    ds_read_b64_tr_b16 v[124:125], v10 offset:50176
    ds_read_b64_tr_b16 v[126:127], v10 offset:56320
    s_cmp_eq_u32 s33, 4
    v_mfma_f32_16x16x32_bf16 v[76:79], v[132:135], v[60:63], v[76:79]
    s_cselect_b32 s35, s39, s59
    buffer_load_dword v4, v5, s[16:19], s35 offen
    s_waitcnt lgkmcnt(12)
    v_mfma_f32_16x16x32_bf16 v[160:163], v[136:139], v[104:107], v[160:163]
    ds_read_b64_tr_b16 v[128:129], v11 offset:50176
    v_mfma_f32_16x16x32_bf16 v[164:167], v[136:139], v[108:111], v[164:167]
    ds_read_b64_tr_b16 v[130:131], v11 offset:56320
    s_waitcnt lgkmcnt(12)
    v_mfma_f32_16x16x32_bf16 v[168:171], v[140:143], v[104:107], v[168:171]
    ds_read_b64_tr_b16 v[132:133], v8 offset:51200
    ds_read_b64_tr_b16 v[134:135], v8 offset:57344
    v_max3_f32 v152, v64, v65, v66
    v_mfma_f32_16x16x32_bf16 v[172:175], v[140:143], v[108:111], v[172:175]
    v_max3_f32 v153, v72, v73, v74
    v_max3_f32 v152, v152, v67, v68
    s_waitcnt lgkmcnt(12)
    v_mfma_f32_16x16x32_bf16 v[176:179], v[144:147], v[104:107], v[176:179]
    ds_read_b64_tr_b16 v[136:137], v9 offset:51200
    ds_read_b64_tr_b16 v[138:139], v9 offset:57344
    v_max3_f32 v153, v153, v75, v76
    v_mfma_f32_16x16x32_bf16 v[180:183], v[144:147], v[108:111], v[180:183]
    v_max3_f32 v152, v152, v69, v70
    v_max3_f32 v153, v153, v77, v78
    s_waitcnt lgkmcnt(12)
    v_mfma_f32_16x16x32_bf16 v[184:187], v[112:115], v[104:107], v[184:187]
    ds_read_b64_tr_b16 v[140:141], v10 offset:51200
    ds_read_b64_tr_b16 v[142:143], v10 offset:57344
    v_max_f32 v152, v152, v71
    v_mfma_f32_16x16x32_bf16 v[188:191], v[112:115], v[108:111], v[188:191]
    v_max_f32 v153, v153, v79
    v_fma_f32 v154, v152, s34, -v15
    s_waitcnt lgkmcnt(12)
    v_mfma_f32_16x16x32_bf16 v[192:195], v[116:119], v[104:107], v[192:195]
    ds_read_b64_tr_b16 v[144:145], v11 offset:51200
    ds_read_b64_tr_b16 v[146:147], v11 offset:57344
    v_mfma_f32_16x16x32_bf16 v[196:199], v[116:119], v[108:111], v[196:199]
    v_fma_f32 v155, v153, s34, -v159
    v_max_f32 v154, v154, v155
    v_cmp_lt_f32 vcc, 0, v154
    s_cbranch_vccnz L_rareA8
L_backA8:
    s_waitcnt lgkmcnt(12)
    v_mfma_f32_16x16x32_bf16 v[200:203], v[120:123], v[104:107], v[200:203]
    v_fma_f32 v64, v64, s34, -v12
    v_fma_f32 v65, v65, s34, -v12
    v_mfma_f32_16x16x32_bf16 v[204:207], v[120:123], v[108:111], v[204:207]
    v_exp_f32 v64, v64
    s_waitcnt lgkmcnt(10)
    v_mfma_f32_16x16x32_bf16 v[208:211], v[124:127], v[104:107], v[208:211]
    v_exp_f32 v65, v65
    v_fma_f32 v66, v66, s34, -v12
    v_mfma_f32_16x16x32_bf16 v[212:215], v[124:127], v[108:111], v[212:215]
    v_fma_f32 v67, v67, s34, -v12
    s_waitcnt lgkmcnt(8)
    v_mfma_f32_16x16x32_bf16 v[216:219], v[128:131], v[104:107], v[216:219]
    v_exp_f32 v66, v66
    v_exp_f32 v67, v67
    v_mfma_f32_16x16x32_bf16 v[220:223], v[128:131], v[108:111], v[220:223]
    v_add_f32 v154, v64, v65
    s_waitcnt vmcnt(13) lgkmcnt(0)
    s_barrier
    v_mfma_f32_16x16x32_bf16 v[224:227], v[132:135], v[104:107], v[224:227]
    ds_read_b128 v[112:115], v6 offset:49152
    ds_read_b128 v[116:119], v6 offset:55296
    s_add_u32 m0, s29, 122880
    s_nop 0
    v_mfma_f32_16x16x32_bf16 v[228:231], v[132:135], v[108:111], v[228:231]
    buffer_load_dwordx4 v2, s[12:15], s32 offen offset:0 sc1 nt lds
    v_cvt_pk_bf16_f32 v96, v64, v65
    v_add_f32 v13, v13, v154
    v_fma_f32 v68, v68, s34, -v12
    v_mfma_f32_16x16x32_bf16 v[232:235], v[136:139], v[104:107], v[232:235]
    ds_read_b128 v[120:123], v7 offset:49152
    ds_read_b128 v[124:127], v7 offset:55296
    s_add_u32 m0, s29, 123776
    s_nop 0
    v_mfma_f32_16x16x32_bf16 v[236:239], v[136:139], v[108:111], v[236:239]
    buffer_load_dwordx4 v2, s[12:15], s32 offen offset:128 sc1 nt lds
    v_fma_f32 v69, v69, s34, -v12
    v_exp_f32 v68, v68
    v_exp_f32 v69, v69
    v_mfma_f32_16x16x32_bf16 v[240:243], v[140:143], v[104:107], v[240:243]
    ds_read_b128 v[128:131], v6 offset:50176
    ds_read_b128 v[132:135], v6 offset:56320
    s_add_u32 m0, s29, 124672
    s_nop 0
    buffer_load_dwordx4 v2, s[12:15], s32 offen offset:256 sc1 nt lds
    s_add_u32 s32, s32, 12288
    s_cmp_eq_u32 s32, 393216
    v_mfma_f32_16x16x32_bf16 v[244:247], v[140:143], v[108:111], v[244:247]
    s_cselect_b32 s32, 0, s32
    s_cmp_eq_u32 s32, s99
    s_cselect_b32 s32, s59, s32
    v_add_f32 v154, v66, v67
    v_cvt_pk_bf16_f32 v97, v66, v67
    v_add_f32 v13, v13, v154
    v_mfma_f32_16x16x32_bf16 v[248:251], v[144:147], v[104:107], v[248:251]
    ds_read_b128 v[136:139], v7 offset:50176
    v_fma_f32 v70, v70, s34, -v12
    v_mfma_f32_16x16x32_bf16 v[252:255], v[144:147], v[108:111], v[252:255]
    v_fma_f32 v71, v71, s34, -v12
    v_exp_f32 v70, v70
    s_cmp_lg_u32 s58, 0
    s_cbranch_scc1 L_rareB9
L_backB9:
    s_waitcnt lgkmcnt(6)
    v_mfma_f32_16x16x32_bf16 v[80:83], v[112:115], v[16:19], 0
    ds_read_b128 v[140:143], v7 offset:56320
    v_exp_f32 v71, v71
    v_add_f32 v154, v68, v69
    v_mfma_f32_16x16x32_bf16 v[88:91], v[112:115], v[20:23], 0
    v_cvt_pk_bf16_f32 v98, v68, v69
    v_add_f32 v13, v13, v154
    s_waitcnt lgkmcnt(6)
    v_mfma_f32_16x16x32_bf16 v[84:87], v[116:119], v[16:19], 0
    ds_read_b128 v[144:147], v6 offset:51200
    v_fma_f32 v72, v72, s34, -v156
    v_mfma_f32_16x16x32_bf16 v[92:95], v[116:119], v[20:23], 0
    v_fma_f32 v73, v73, s34, -v156
    v_exp_f32 v72, v72
    s_waitcnt lgkmcnt(6)
    v_mfma_f32_16x16x32_bf16 v[80:83], v[120:123], v[24:27], v[80:83]
    ds_read_b128 v[112:115], v6 offset:57344
    v_exp_f32 v73, v73
    v_mfma_f32_16x16x32_bf16 v[88:91], v[120:123], v[28:31], v[88:91]
    v_add_f32 v154, v70, v71
    v_cvt_pk_bf16_f32 v99, v70, v71
    s_waitcnt lgkmcnt(6)
    v_mfma_f32_16x16x32_bf16 v[84:87], v[124:127], v[24:27], v[84:87]
    ds_read_b128 v[116:119], v7 offset:51200
    v_add_f32 v13, v13, v154
    v_mfma_f32_16x16x32_bf16 v[92:95], v[124:127], v[28:31], v[92:95]
    v_fma_f32 v74, v74, s34, -v156
    v_fma_f32 v75, v75, s34, -v156
    s_waitcnt lgkmcnt(6)
    v_mfma_f32_16x16x32_bf16 v[80:83], v[128:131], v[32:35], v[80:83]
    ds_read_b128 v[120:123], v7 offset:57344
    v_exp_f32 v74, v74
    v_exp_f32 v75, v75
    v_mfma_f32_16x16x32_bf16 v[88:91], v[128:131], v[36:39], v[88:91]
    v_add_f32 v154, v72, v73
    v_cvt_pk_bf16_f32 v100, v72, v73
    s_waitcnt lgkmcnt(6)
    v_mfma_f32_16x16x32_bf16 v[84:87], v[132:135], v[32:35], v[84:87]
    v_add_f32 v157, v157, v154
    v_fma_f32 v76, v76, s34, -v156
    v_mfma_f32_16x16x32_bf16 v[92:95], v[132:135], v[36:39], v[92:95]
    v_fma_f32 v77, v77, s34, -v156
    s_waitcnt lgkmcnt(5)
    v_mfma_f32_16x16x32_bf16 v[80:83], v[136:139], v[40:43], v[80:83]
    v_exp_f32 v76, v76
    v_exp_f32 v77, v77
    v_mfma_f32_16x16x32_bf16 v[88:91], v[136:139], v[44:47], v[88:91]
    v_add_f32 v154, v74, v75
    s_waitcnt lgkmcnt(4)
    v_mfma_f32_16x16x32_bf16 v[84:87], v[140:143], v[40:43], v[84:87]
    v_cvt_pk_bf16_f32 v101, v74, v75
    v_add_f32 v157, v157, v154
    v_mfma_f32_16x16x32_bf16 v[92:95], v[140:143], v[44:47], v[92:95]
    v_fma_f32 v78, v78, s34, -v156
    v_fma_f32 v79, v79, s34, -v156
    s_waitcnt vmcnt(13) lgkmcnt(0)
    s_barrier
    v_mfma_f32_16x16x32_bf16 v[80:83], v[144:147], v[48:51], v[80:83]
    ds_read_b64_tr_b16 v[124:125], v8 offset:0
    ds_read_b64_tr_b16 v[126:127], v8 offset:6144
    ds_read_b64_tr_b16 v[128:129], v9 offset:0
    ds_read_b64_tr_b16 v[130:131], v9 offset:6144
    s_add_u32 m0, s29, 49152
    v_mfma_f32_16x16x32_bf16 v[88:91], v[144:147], v[52:55], v[88:91]
    s_nop 0
    buffer_load_dwordx4 v1, s[8:11], s31 offen offset:0 sc1 nt lds
    v_exp_f32 v78, v78
    v_exp_f32 v79, v79
    v_add_f32 v154, v76, v77
    v_mfma_f32_16x16x32_bf16 v[84:87], v[112:115], v[48:51], v[84:87]
    ds_read_b64_tr_b16 v[132:133], v10 offset:0
    ds_read_b64_tr_b16 v[134:135], v10 offset:6144
    ds_read_b64_tr_b16 v[136:137], v11 offset:0
    ds_read_b64_tr_b16 v[138:139], v11 offset:6144
    s_add_u32 m0, s29, 50048
    v_mfma_f32_16x16x32_bf16 v[92:95], v[112:115], v[52:55], v[92:95]
    s_nop 0
    buffer_load_dwordx4 v1, s[8:11], s31 offen offset:128 sc1 nt lds
    v_cvt_pk_bf16_f32 v102, v76, v77
    v_add_f32 v157, v157, v154
    s_nop 0
    v_mfma_f32_16x16x32_bf16 v[80:83], v[116:119], v[56:59], v[80:83]
    ds_read_b64_tr_b16 v[140:141], v8 offset:1024
    ds_read_b64_tr_b16 v[142:143], v8 offset:7168
    ds_read_b64_tr_b16 v[144:145], v9 offset:1024
    ds_read_b64_tr_b16 v[146:147], v9 offset:7168
    s_add_u32 m0, s29, 50944
    s_nop 0
    buffer_load_dwordx4 v1, s[8:11], s31 offen offset:256 sc1 nt lds
    s_add_u32 s31, s31, 12288
    v_mfma_f32_16x16x32_bf16 v[88:91], v[116:119], v[60:63], v[88:91]
    s_cmp_eq_u32 s31, 393216
    s_cselect_b32 s31, 0, s31
    s_cmp_eq_u32 s31, s99
    s_cselect_b32 s31, s59, s31
    v_add_f32 v154, v78, v79
    v_cvt_pk_bf16_f32 v103, v78, v79
    v_add_f32 v157, v157, v154
    v_mfma_f32_16x16x32_bf16 v[84:87], v[120:123], v[56:59], v[84:87]
    ds_read_b64_tr_b16 v[112:113], v10 offset:1024
    v_mfma_f32_16x16x32_bf16 v[92:95], v[120:123], v[60:63], v[92:95]
    ds_read_b64_tr_b16 v[114:115], v10 offset:7168
    s_waitcnt lgkmcnt(12)
    v_mfma_f32_16x16x32_bf16 v[160:163], v[124:127], v[96:99], v[160:163]
    ds_read_b64_tr_b16 v[116:117], v11 offset:1024
    v_mfma_f32_16x16x32_bf16 v[164:167], v[124:127], v[100:103], v[164:167]
    ds_read_b64_tr_b16 v[118:119], v11 offset:7168
    s_waitcnt lgkmcnt(12)
    v_mfma_f32_16x16x32_bf16 v[168:171], v[128:131], v[96:99], v[168:171]
    ds_read_b64_tr_b16 v[120:121], v8 offset:2048
    ds_read_b64_tr_b16 v[122:123], v8 offset:8192
    v_max3_f32 v152, v80, v81, v82
    v_mfma_f32_16x16x32_bf16 v[172:175], v[128:131], v[100:103], v[172:175]
    v_max3_f32 v153, v88, v89, v90
    v_max3_f32 v152, v152, v83, v84
    s_waitcnt lgkmcnt(12)
    v_mfma_f32_16x16x32_bf16 v[176:179], v[132:135], v[96:99], v[176:179]
    ds_read_b64_tr_b16 v[124:125], v9 offset:2048
    ds_read_b64_tr_b16 v[126:127], v9 offset:8192
    v_max3_f32 v153, v153, v91, v92
    v_mfma_f32_16x16x32_bf16 v[180:183], v[132:135], v[100:103], v[180:183]
    v_max3_f32 v152, v152, v85, v86
    v_max3_f32 v153, v153, v93, v94
    s_waitcnt lgkmcnt(12)
    v_mfma_f32_16x16x32_bf16 v[184:187], v[136:139], v[96:99], v[184:187]
    ds_read_b64_tr_b16 v[128:129], v10 offset:2048
    ds_read_b64_tr_b16 v[130:131], v10 offset:8192
    v_max_f32 v152, v152, v87
    v_mfma_f32_16x16x32_bf16 v[188:191], v[136:139], v[100:103], v[188:191]
    v_max_f32 v153, v153, v95
    v_fma_f32 v154, v152, s34, -v15
    s_waitcnt lgkmcnt(12)
    v_mfma_f32_16x16x32_bf16 v[192:195], v[140:143], v[96:99], v[192:195]
    ds_read_b64_tr_b16 v[132:133], v11 offset:2048
    ds_read_b64_tr_b16 v[134:135], v11 offset:8192
    v_mfma_f32_16x16x32_bf16 v[196:199], v[140:143], v[100:103], v[196:199]
    v_fma_f32 v155, v153, s34, -v159
    v_max_f32 v154, v154, v155
    v_cmp_lt_f32 vcc, 0, v154
    s_cbranch_vccnz L_rareA10
L_backA10:
    s_waitcnt lgkmcnt(12)
    v_mfma_f32_16x16x32_bf16 v[200:203], v[144:147], v[96:99], v[200:203]
    v_fma_f32 v80, v80, s34, -v12
    v_fma_f32 v81, v81, s34, -v12
    v_mfma_f32_16x16x32_bf16 v[204:207], v[144:147], v[100:103], v[204:207]
    v_exp_f32 v80, v80
    s_waitcnt lgkmcnt(10)
    v_mfma_f32_16x16x32_bf16 v[208:211], v[112:115], v[96:99], v[208:211]
    v_exp_f32 v81, v81
    v_fma_f32 v82, v82, s34, -v12
    v_mfma_f32_16x16x32_bf16 v[212:215], v[112:115], v[100:103], v[212:215]
    v_fma_f32 v83, v83, s34, -v12
    s_waitcnt lgkmcnt(8)
    v_mfma_f32_16x16x32_bf16 v[216:219], v[116:119], v[96:99], v[216:219]
    v_exp_f32 v82, v82
    v_exp_f32 v83, v83
    v_mfma_f32_16x16x32_bf16 v[220:223], v[116:119], v[100:103], v[220:223]
    v_add_f32 v154, v80, v81
    s_waitcnt vmcnt(13) lgkmcnt(0)
    s_barrier
    v_mfma_f32_16x16x32_bf16 v[224:227], v[120:123], v[96:99], v[224:227]
    ds_read_b128 v[136:139], v6 offset:0
    ds_read_b128 v[140:143], v6 offset:6144
    s_add_u32 m0, s29, 73728
    s_nop 0
    v_mfma_f32_16x16x32_bf16 v[228:231], v[120:123], v[100:103], v[228:231]
    buffer_load_dwordx4 v2, s[12:15], s32 offen offset:0 sc1 nt lds
    v_cvt_pk_bf16_f32 v104, v80, v81
    v_add_f32 v13, v13, v154
    v_fma_f32 v84, v84, s34, -v12
    v_mfma_f32_16x16x32_bf16 v[232:235], v[124:127], v[96:99], v[232:235]
    ds_read_b128 v[144:147], v7 offset:0
    ds_read_b128 v[112:115], v7 offset:6144
    s_add_u32 m0, s29, 74624
    s_nop 0
    v_mfma_f32_16x16x32_bf16 v[236:239], v[124:127], v[100:103], v[236:239]
    buffer_load_dwordx4 v2, s[12:15], s32 offen offset:128 sc1 nt lds
    v_fma_f32 v85, v85, s34, -v12
    v_exp_f32 v84, v84
    v_exp_f32 v85, v85
    v_mfma_f32_16x16x32_bf16 v[240:243], v[128:131], v[96:99], v[240:243]
    ds_read_b128 v[116:119], v6 offset:1024
    ds_read_b128 v[120:123], v6 offset:7168
    s_add_u32 m0, s29, 75520
    s_nop 0
    buffer_load_dwordx4 v2, s[12:15], s32 offen offset:256 sc1 nt lds
    s_add_u32 s32, s32, 12288
    s_cmp_eq_u32 s32, 393216
    v_mfma_f32_16x16x32_bf16 v[244:247], v[128:131], v[100:103], v[244:247]
    s_cselect_b32 s32, 0, s32
    s_cmp_eq_u32 s32, s99
    s_cselect_b32 s32, s59, s32
    v_add_f32 v154, v82, v83
    v_cvt_pk_bf16_f32 v105, v82, v83
    v_add_f32 v13, v13, v154
    v_mfma_f32_16x16x32_bf16 v[248:251], v[132:135], v[96:99], v[248:251]
    ds_read_b128 v[124:127], v7 offset:1024
    v_fma_f32 v86, v86, s34, -v12
    v_mfma_f32_16x16x32_bf16 v[252:255], v[132:135], v[100:103], v[252:255]
    v_fma_f32 v87, v87, s34, -v12
    v_exp_f32 v86, v86
    s_cmp_lg_u32 s58, 0
    s_cbranch_scc1 L_rareB11
L_backB11:
    s_waitcnt lgkmcnt(6)
    v_mfma_f32_16x16x32_bf16 v[64:67], v[136:139], v[16:19], 0
    ds_read_b128 v[128:131], v7 offset:7168
    v_exp_f32 v87, v87
    v_add_f32 v154, v84, v85
    v_mfma_f32_16x16x32_bf16 v[72:75], v[136:139], v[20:23], 0
    v_cvt_pk_bf16_f32 v106, v84, v85
    v_add_f32 v13, v13, v154
    s_waitcnt lgkmcnt(6)
    v_mfma_f32_16x16x32_bf16 v[68:71], v[140:143], v[16:19], 0
    ds_read_b128 v[132:135], v6 offset:2048
    v_fma_f32 v88, v88, s34, -v156
    v_mfma_f32_16x16x32_bf16 v[76:79], v[140:143], v[20:23], 0
    v_fma_f32 v89, v89, s34, -v156
    v_exp_f32 v88, v88
    s_waitcnt lgkmcnt(6)
    v_mfma_f32_16x16x32_bf16 v[64:67], v[144:147], v[24:27], v[64:67]
    ds_read_b128 v[136:139], v6 offset:8192
    v_exp_f32 v89, v89
    v_mfma_f32_16x16x32_bf16 v[72:75], v[144:147], v[28:31], v[72:75]
    v_add_f32 v154, v86, v87
    v_cvt_pk_bf16_f32 v107, v86, v87
    s_waitcnt lgkmcnt(6)
    v_mfma_f32_16x16x32_bf16 v[68:71], v[112:115], v[24:27], v[68:71]
    ds_read_b128 v[140:143], v7 offset:2048
    v_add_f32 v13, v13, v154
    v_mfma_f32_16x16x32_bf16 v[76:79], v[112:115], v[28:31], v[76:79]
    v_fma_f32 v90, v90, s34, -v156
    v_fma_f32 v91, v91, s34, -v156
    s_waitcnt lgkmcnt(6)
    v_mfma_f32_16x16x32_bf16 v[64:67], v[116:119], v[32:35], v[64:67]
    ds_read_b128 v[144:147], v7 offset:8192
    v_exp_f32 v90, v90
    v_exp_f32 v91, v91
    v_mfma_f32_16x16x32_bf16 v[72:75], v[116:119], v[36:39], v[72:75]
    v_add_f32 v154, v88, v89
    v_cvt_pk_bf16_f32 v108, v88, v89
    s_waitcnt lgkmcnt(6)
    v_mfma_f32_16x16x32_bf16 v[68:71], v[120:123], v[32:35], v[68:71]
    v_add_f32 v157, v157, v154
    v_fma_f32 v92, v92, s34, -v156
    v_mfma_f32_16x16x32_bf16 v[76:79], v[120:123], v[36:39], v[76:79]
    v_fma_f32 v93, v93, s34, -v156
    s_waitcnt lgkmcnt(5)
    v_mfma_f32_16x16x32_bf16 v[64:67], v[124:127], v[40:43], v[64:67]
    v_exp_f32 v92, v92
    v_exp_f32 v93, v93
    v_mfma_f32_16x16x32_bf16 v[72:75], v[124:127], v[44:47], v[72:75]
    v_add_f32 v154, v90, v91
    s_waitcnt lgkmcnt(4)
    v_mfma_f32_16x16x32_bf16 v[68:71], v[128:131], v[40:43], v[68:71]
    v_cvt_pk_bf16_f32 v109, v90, v91
    v_add_f32 v157, v157, v154
    v_mfma_f32_16x16x32_bf16 v[76:79], v[128:131], v[44:47], v[76:79]
    v_fma_f32 v94, v94, s34, -v156
    v_fma_f32 v95, v95, s34, -v156
    s_waitcnt vmcnt(13) lgkmcnt(0)
    s_barrier
    v_mfma_f32_16x16x32_bf16 v[64:67], v[132:135], v[48:51], v[64:67]
    ds_read_b64_tr_b16 v[112:113], v8 offset:24576
    ds_read_b64_tr_b16 v[114:115], v8 offset:30720
    ds_read_b64_tr_b16 v[116:117], v9 offset:24576
    ds_read_b64_tr_b16 v[118:119], v9 offset:30720
    s_add_u32 m0, s29, 0
    v_mfma_f32_16x16x32_bf16 v[72:75], v[132:135], v[52:55], v[72:75]
    s_nop 0
    buffer_load_dwordx4 v1, s[8:11], s31 offen offset:0 sc1 nt lds
    v_exp_f32 v94, v94
    v_exp_f32 v95, v95
    v_add_f32 v154, v92, v93
    v_mfma_f32_16x16x32_bf16 v[68:71], v[136:139], v[48:51], v[68:71]
    ds_read_b64_tr_b16 v[120:121], v10 offset:24576
    ds_read_b64_tr_b16 v[122:123], v10 offset:30720
    ds_read_b64_tr_b16 v[124:125], v11 offset:24576
    ds_read_b64_tr_b16 v[126:127], v11 offset:30720
    s_add_u32 m0, s29, 896
    v_mfma_f32_16x16x32_bf16 v[76:79], v[136:139], v[52:55], v[76:79]
    s_nop 0
    buffer_load_dwordx4 v1, s[8:11], s31 offen offset:128 sc1 nt lds
    v_cvt_pk_bf16_f32 v110, v92, v93
    v_add_f32 v157, v157, v154
    s_nop 0
    v_mfma_f32_16x16x32_bf16 v[64:67], v[140:143], v[56:59], v[64:67]
    ds_read_b64_tr_b16 v[128:129], v8 offset:25600
    ds_read_b64_tr_b16 v[130:131], v8 offset:31744
    ds_read_b64_tr_b16 v[132:133], v9 offset:25600
    ds_read_b64_tr_b16 v[134:135], v9 offset:31744
    s_add_u32 m0, s29, 1792
    s_nop 0
    buffer_load_dwordx4 v1, s[8:11], s31 offen offset:256 sc1 nt lds
    s_add_u32 s31, s31, 12288
    v_mfma_f32_16x16x32_bf16 v[72:75], v[140:143], v[60:63], v[72:75]
    s_cmp_eq_u32 s31, 393216
    s_cselect_b32 s31, 0, s31
    s_cmp_eq_u32 s31, s99
    s_cselect_b32 s31, s59, s31
    v_add_f32 v154, v94, v95
    v_cvt_pk_bf16_f32 v111, v94, v95
    v_add_f32 v157, v157, v154
    v_mfma_f32_16x16x32_bf16 v[68:71], v[144:147], v[56:59], v[68:71]
    ds_read_b64_tr_b16 v[136:137], v10 offset:25600
    v_mfma_f32_16x16x32_bf16 v[76:79], v[144:147], v[60:63], v[76:79]
    ds_read_b64_tr_b16 v[138:139], v10 offset:31744
    s_waitcnt lgkmcnt(12)
    v_mfma_f32_16x16x32_bf16 v[160:163], v[112:115], v[104:107], v[160:163]
    ds_read_b64_tr_b16 v[140:141], v11 offset:25600
    v_mfma_f32_16x16x32_bf16 v[164:167], v[112:115], v[108:111], v[164:167]
    ds_read_b64_tr_b16 v[142:143], v11 offset:31744
    s_waitcnt lgkmcnt(12)
    v_mfma_f32_16x16x32_bf16 v[168:171], v[116:119], v[104:107], v[168:171]
    ds_read_b64_tr_b16 v[144:145], v8 offset:26624
    ds_read_b64_tr_b16 v[146:147], v8 offset:32768
    v_max3_f32 v152, v64, v65, v66
    v_mfma_f32_16x16x32_bf16 v[172:175], v[116:119], v[108:111], v[172:175]
    v_max3_f32 v153, v72, v73, v74
    v_max3_f32 v152, v152, v67, v68
    s_waitcnt lgkmcnt(12)
    v_mfma_f32_16x16x32_bf16 v[176:179], v[120:123], v[104:107], v[176:179]
    ds_read_b64_tr_b16 v[112:113], v9 offset:26624
    ds_read_b64_tr_b16 v[114:115], v9 offset:32768
    v_max3_f32 v153, v153, v75, v76
    v_mfma_f32_16x16x32_bf16 v[180:183], v[120:123], v[108:111], v[180:183]
    v_max3_f32 v152, v152, v69, v70
    v_max3_f32 v153, v153, v77, v78
    s_waitcnt lgkmcnt(12)
    v_mfma_f32_16x16x32_bf16 v[184:187], v[124:127], v[104:107], v[184:187]
    ds_read_b64_tr_b16 v[116:117], v10 offset:26624
    ds_read_b64_tr_b16 v[118:119], v10 offset:32768
    v_max_f32 v152, v152, v71
    v_mfma_f32_16x16x32_bf16 v[188:191], v[124:127], v[108:111], v[188:191]
    v_max_f32 v153, v153, v79
    v_fma_f32 v154, v152, s34, -v15
    s_waitcnt lgkmcnt(12)
    v_mfma_f32_16x16x32_bf16 v[192:195], v[128:131], v[104:107], v[192:195]
    ds_read_b64_tr_b16 v[120:121], v11 offset:26624
    ds_read_b64_tr_b16 v[122:123], v11 offset:32768
    v_mfma_f32_16x16x32_bf16 v[196:199], v[128:131], v[108:111], v[196:199]
    v_fma_f32 v155, v153, s34, -v159
    v_max_f32 v154, v154, v155
    v_cmp_lt_f32 vcc, 0, v154
    s_cbranch_vccnz L_rareA12
L_backA12:
    s_waitcnt lgkmcnt(12)
    v_mfma_f32_16x16x32_bf16 v[200:203], v[132:135], v[104:107], v[200:203]
    v_fma_f32 v64, v64, s34, -v12
    v_fma_f32 v65, v65, s34, -v12
    v_mfma_f32_16x16x32_bf16 v[204:207], v[132:135], v[108:111], v[204:207]
    v_exp_f32 v64, v64
    s_waitcnt lgkmcnt(10)
    v_mfma_f32_16x16x32_bf16 v[208:211], v[136:139], v[104:107], v[208:211]
    v_exp_f32 v65, v65
    v_fma_f32 v66, v66, s34, -v12
    v_mfma_f32_16x16x32_bf16 v[212:215], v[136:139], v[108:111], v[212:215]
    v_fma_f32 v67, v67, s34, -v12
    s_waitcnt lgkmcnt(8)
    v_mfma_f32_16x16x32_bf16 v[216:219], v[140:143], v[104:107], v[216:219]
    v_exp_f32 v66, v66
    v_exp_f32 v67, v67
    v_mfma_f32_16x16x32_bf16 v[220:223], v[140:143], v[108:111], v[220:223]
    v_add_f32 v154, v64, v65
    s_waitcnt vmcnt(12) lgkmcnt(0)
    s_barrier
    v_mfma_f32_16x16x32_bf16 v[224:227], v[144:147], v[104:107], v[224:227]
    ds_read_b128 v[124:127], v6 offset:24576
    ds_read_b128 v[128:131], v6 offset:30720
    s_add_u32 m0, s29, 98304
    s_nop 0
    v_mfma_f32_16x16x32_bf16 v[228:231], v[144:147], v[108:111], v[228:231]
    buffer_load_dwordx4 v2, s[12:15], s32 offen offset:0 sc1 nt lds
    v_cvt_pk_bf16_f32 v96, v64, v65
    v_add_f32 v13, v13, v154
    v_fma_f32 v68, v68, s34, -v12
    v_mfma_f32_16x16x32_bf16 v[232:235], v[112:115], v[104:107], v[232:235]
    ds_read_b128 v[132:135], v7 offset:24576
    ds_read_b128 v[136:139], v7 offset:30720
    s_add_u32 m0, s29, 99200
    s_nop 0
    v_mfma_f32_16x16x32_bf16 v[236:239], v[112:115], v[108:111], v[236:239]
    buffer_load_dwordx4 v2, s[12:15], s32 offen offset:128 sc1 nt lds
    v_fma_f32 v69, v69, s34, -v12
    v_exp_f32 v68, v68
    v_exp_f32 v69, v69
    v_mfma_f32_16x16x32_bf16 v[240:243], v[116:119], v[104:107], v[240:243]
    ds_read_b128 v[140:143], v6 offset:25600
    ds_read_b128 v[144:147], v6 offset:31744
    s_add_u32 m0, s29, 100096
    s_nop 0
    buffer_load_dwordx4 v2, s[12:15], s32 offen offset:256 sc1 nt lds
    s_add_u32 s32, s32, 12288
    s_cmp_eq_u32 s32, 393216
    v_mfma_f32_16x16x32_bf16 v[244:247], v[116:119], v[108:111], v[244:247]
    s_cselect_b32 s32, 0, s32
    s_cmp_eq_u32 s32, s99
    s_cselect_b32 s32, s59, s32
    v_add_f32 v154, v66, v67
    v_cvt_pk_bf16_f32 v97, v66, v67
    v_add_f32 v13, v13, v154
    v_mfma_f32_16x16x32_bf16 v[248:251], v[120:123], v[104:107], v[248:251]
    ds_read_b128 v[112:115], v7 offset:25600
    v_fma_f32 v70, v70, s34, -v12
    v_mfma_f32_16x16x32_bf16 v[252:255], v[120:123], v[108:111], v[252:255]
    v_fma_f32 v71, v71, s34, -v12
    v_exp_f32 v70, v70
    s_cmp_lg_u32 s58, 0
    s_cbranch_scc1 L_rareB13
L_backB13:
    s_waitcnt lgkmcnt(6)
    v_mfma_f32_16x16x32_bf16 v[80:83], v[124:127], v[16:19], 0
    ds_read_b128 v[116:119], v7 offset:31744
    v_exp_f32 v71, v71
    v_add_f32 v154, v68, v69
    v_mfma_f32_16x16x32_bf16 v[88:91], v[124:127], v[20:23], 0
    v_cvt_pk_bf16_f32 v98, v68, v69
    v_add_f32 v13, v13, v154
    s_waitcnt lgkmcnt(6)
    v_mfma_f32_16x16x32_bf16 v[84:87], v[128:131], v[16:19], 0
    ds_read_b128 v[120:123], v6 offset:26624
    v_fma_f32 v72, v72, s34, -v156
    v_mfma_f32_16x16x32_bf16 v[92:95], v[128:131], v[20:23], 0
    v_fma_f32 v73, v73, s34, -v156
    v_exp_f32 v72, v72
    s_waitcnt lgkmcnt(6)
    v_mfma_f32_16x16x32_bf16 v[80:83], v[132:135], v[24:27], v[80:83]
    ds_read_b128 v[124:127], v6 offset:32768
    v_exp_f32 v73, v73
    v_mfma_f32_16x16x32_bf16 v[88:91], v[132:135], v[28:31], v[88:91]
    v_add_f32 v154, v70, v71
    v_cvt_pk_bf16_f32 v99, v70, v71
    s_waitcnt lgkmcnt(6)
    v_mfma_f32_16x16x32_bf16 v[84:87], v[136:139], v[24:27], v[84:87]
    ds_read_b128 v[128:131], v7 offset:26624
    v_add_f32 v13, v13, v154
    v_mfma_f32_16x16x32_bf16 v[92:95], v[136:139], v[28:31], v[92:95]
    v_fma_f32 v74, v74, s34, -v156
    v_fma_f32 v75, v75, s34, -v156
    s_waitcnt lgkmcnt(6)
    v_mfma_f32_16x16x32_bf16 v[80:83], v[140:143], v[32:35], v[80:83]
    ds_read_b128 v[132:135], v7 offset:32768
    v_exp_f32 v74, v74
    v_exp_f32 v75, v75
    v_mfma_f32_16x16x32_bf16 v[88:91], v[140:143], v[36:39], v[88:91]
    v_add_f32 v154, v72, v73
    v_cvt_pk_bf16_f32 v100, v72, v73
    s_waitcnt lgkmcnt(6)
    v_mfma_f32_16x16x32_bf16 v[84:87], v[144:147], v[32:35], v[84:87]
    v_add_f32 v157, v157, v154
    v_fma_f32 v76, v76, s34, -v156
    v_mfma_f32_16x16x32_bf16 v[92:95], v[144:147], v[36:39], v[92:95]
    v_fma_f32 v77, v77, s34, -v156
    s_waitcnt lgkmcnt(5)
    v_mfma_f32_16x16x32_bf16 v[80:83], v[112:115], v[40:43], v[80:83]
    v_exp_f32 v76, v76
    v_exp_f32 v77, v77
    v_mfma_f32_16x16x32_bf16 v[88:91], v[112:115], v[44:47], v[88:91]
    v_add_f32 v154, v74, v75
    s_waitcnt lgkmcnt(4)
    v_mfma_f32_16x16x32_bf16 v[84:87], v[116:119], v[40:43], v[84:87]
    v_cvt_pk_bf16_f32 v101, v74, v75
    v_add_f32 v157, v157, v154
    v_fma_f32 v78, v78, s34, -v156
    v_mfma_f32_16x16x32_bf16 v[92:95], v[116:119], v[44:47], v[92:95]
    v_fma_f32 v79, v79, s34, -v156
    s_add_u32 s33, s33, 1
    s_cmp_lt_u32 s33, 5
    s_cbranch_scc1 L_k1_loop
    s_waitcnt vmcnt(12) lgkmcnt(0)
    s_barrier
    v_mfma_f32_16x16x32_bf16 v[80:83], v[120:123], v[48:51], v[80:83]
    ds_read_b64_tr_b16 v[136:137], v8 offset:49152
    ds_read_b64_tr_b16 v[138:139], v8 offset:55296
    ds_read_b64_tr_b16 v[140:141], v9 offset:49152
    ds_read_b64_tr_b16 v[142:143], v9 offset:55296
    v_mfma_f32_16x16x32_bf16 v[88:91], v[120:123], v[52:55], v[88:91]
    v_exp_f32 v78, v78
    v_exp_f32 v79, v79
    v_add_f32 v154, v76, v77
    v_mfma_f32_16x16x32_bf16 v[84:87], v[124:127], v[48:51], v[84:87]
    ds_read_b64_tr_b16 v[144:145], v10 offset:49152
    ds_read_b64_tr_b16 v[146:147], v10 offset:55296
    ds_read_b64_tr_b16 v[112:113], v11 offset:49152
    ds_read_b64_tr_b16 v[114:115], v11 offset:55296
    v_mfma_f32_16x16x32_bf16 v[92:95], v[124:127], v[52:55], v[92:95]
    v_cvt_pk_bf16_f32 v102, v76, v77
    v_add_f32 v157, v157, v154
    s_nop 0
    v_mfma_f32_16x16x32_bf16 v[80:83], v[128:131], v[56:59], v[80:83]
    ds_read_b64_tr_b16 v[116:117], v8 offset:50176
    ds_read_b64_tr_b16 v[118:119], v8 offset:56320
    ds_read_b64_tr_b16 v[120:121], v9 offset:50176
    ds_read_b64_tr_b16 v[122:123], v9 offset:56320
    v_mfma_f32_16x16x32_bf16 v[88:91], v[128:131], v[60:63], v[88:91]
    v_add_f32 v154, v78, v79
    v_cvt_pk_bf16_f32 v103, v78, v79
    v_add_f32 v157, v157, v154
    v_mfma_f32_16x16x32_bf16 v[84:87], v[132:135], v[56:59], v[84:87]
    ds_read_b64_tr_b16 v[124:125], v10 offset:50176
    v_mfma_f32_16x16x32_bf16 v[92:95], v[132:135], v[60:63], v[92:95]
    ds_read_b64_tr_b16 v[126:127], v10 offset:56320
    s_waitcnt lgkmcnt(12)
    v_mfma_f32_16x16x32_bf16 v[160:163], v[136:139], v[96:99], v[160:163]
    ds_read_b64_tr_b16 v[128:129], v11 offset:50176
    v_mfma_f32_16x16x32_bf16 v[164:167], v[136:139], v[100:103], v[164:167]
    ds_read_b64_tr_b16 v[130:131], v11 offset:56320
    s_waitcnt lgkmcnt(12)
    v_mfma_f32_16x16x32_bf16 v[168:171], v[140:143], v[96:99], v[168:171]
    ds_read_b64_tr_b16 v[132:133], v8 offset:51200
    ds_read_b64_tr_b16 v[134:135], v8 offset:57344
    v_max3_f32 v152, v80, v81, v82
    v_mfma_f32_16x16x32_bf16 v[172:175], v[140:143], v[100:103], v[172:175]
    v_max3_f32 v153, v88, v89, v90
    v_max3_f32 v152, v152, v83, v84
    s_waitcnt lgkmcnt(12)
    v_mfma_f32_16x16x32_bf16 v[176:179], v[144:147], v[96:99], v[176:179]
    ds_read_b64_tr_b16 v[136:137], v9 offset:51200
    ds_read_b64_tr_b16 v[138:139], v9 offset:57344
    v_max3_f32 v153, v153, v91, v92
    v_mfma_f32_16x16x32_bf16 v[180:183], v[144:147], v[100:103], v[180:183]
    v_max3_f32 v152, v152, v85, v86
    v_max3_f32 v153, v153, v93, v94
    s_waitcnt lgkmcnt(12)
    v_mfma_f32_16x16x32_bf16 v[184:187], v[112:115], v[96:99], v[184:187]
    ds_read_b64_tr_b16 v[140:141], v10 offset:51200
    ds_read_b64_tr_b16 v[142:143], v10 offset:57344
    v_max_f32 v152, v152, v87
    v_mfma_f32_16x16x32_bf16 v[188:191], v[112:115], v[100:103], v[188:191]
    v_max_f32 v153, v153, v95
    v_fma_f32 v154, v152, s34, -v15
    s_waitcnt lgkmcnt(12)
    v_mfma_f32_16x16x32_bf16 v[192:195], v[116:119], v[96:99], v[192:195]
    ds_read_b64_tr_b16 v[144:145], v11 offset:51200
    ds_read_b64_tr_b16 v[146:147], v11 offset:57344
    v_mfma_f32_16x16x32_bf16 v[196:199], v[116:119], v[100:103], v[196:199]
    v_fma_f32 v155, v153, s34, -v159
    v_max_f32 v154, v154, v155
    v_cmp_lt_f32 vcc, 0, v154
    s_cbranch_vccnz L_rareA14
L_backA14:
    s_waitcnt lgkmcnt(12)
    v_mfma_f32_16x16x32_bf16 v[200:203], v[120:123], v[96:99], v[200:203]
    v_fma_f32 v80, v80, s34, -v12
    v_fma_f32 v81, v81, s34, -v12
    v_mfma_f32_16x16x32_bf16 v[204:207], v[120:123], v[100:103], v[204:207]
    v_exp_f32 v80, v80
    s_waitcnt lgkmcnt(10)
    v_mfma_f32_16x16x32_bf16 v[208:211], v[124:127], v[96:99], v[208:211]
    v_exp_f32 v81, v81
    v_fma_f32 v82, v82, s34, -v12
    v_mfma_f32_16x16x32_bf16 v[212:215], v[124:127], v[100:103], v[212:215]
    v_fma_f32 v83, v83, s34, -v12
    s_waitcnt lgkmcnt(8)
    v_mfma_f32_16x16x32_bf16 v[216:219], v[128:131], v[96:99], v[216:219]
    v_exp_f32 v82, v82
    v_exp_f32 v83, v83
    v_mfma_f32_16x16x32_bf16 v[220:223], v[128:131], v[100:103], v[220:223]
    v_add_f32 v154, v80, v81
    s_waitcnt lgkmcnt(6)
    v_mfma_f32_16x16x32_bf16 v[224:227], v[132:135], v[96:99], v[224:227]
    v_cvt_pk_bf16_f32 v104, v80, v81
    v_add_f32 v13, v13, v154
    v_mfma_f32_16x16x32_bf16 v[228:231], v[132:135], v[100:103], v[228:231]
    v_fma_f32 v84, v84, s34, -v12
    s_waitcnt lgkmcnt(4)
    v_mfma_f32_16x16x32_bf16 v[232:235], v[136:139], v[96:99], v[232:235]
    v_fma_f32 v85, v85, s34, -v12
    v_exp_f32 v84, v84
    v_mfma_f32_16x16x32_bf16 v[236:239], v[136:139], v[100:103], v[236:239]
    v_exp_f32 v85, v85
    s_waitcnt lgkmcnt(2)
    v_mfma_f32_16x16x32_bf16 v[240:243], v[140:143], v[96:99], v[240:243]
    v_add_f32 v154, v82, v83
    v_cvt_pk_bf16_f32 v105, v82, v83
    v_mfma_f32_16x16x32_bf16 v[244:247], v[140:143], v[100:103], v[244:247]
    v_add_f32 v13, v13, v154
    s_waitcnt lgkmcnt(0)
    v_mfma_f32_16x16x32_bf16 v[248:251], v[144:147], v[96:99], v[248:251]
    v_fma_f32 v86, v86, s34, -v12
    v_fma_f32 v87, v87, s34, -v12
    v_mfma_f32_16x16x32_bf16 v[252:255], v[144:147], v[100:103], v[252:255]
    v_exp_f32 v86, v86
    s_cmp_lg_u32 s58, 0
    s_cbranch_scc1 L_rareB15
L_backB15:
    v_exp_f32 v87, v87
    v_add_f32 v154, v84, v85
    v_cvt_pk_bf16_f32 v106, v84, v85
    v_add_f32 v13, v13, v154
    v_fma_f32 v88, v88, s34, -v156
    v_fma_f32 v89, v89, s34, -v156
    v_exp_f32 v88, v88
    v_exp_f32 v89, v89
    v_add_f32 v154, v86, v87
    v_cvt_pk_bf16_f32 v107, v86, v87
    v_add_f32 v13, v13, v154
    v_fma_f32 v90, v90, s34, -v156
    v_fma_f32 v91, v91, s34, -v156
    v_exp_f32 v90, v90
    v_exp_f32 v91, v91
    v_add_f32 v154, v88, v89
    v_cvt_pk_bf16_f32 v108, v88, v89
    v_add_f32 v157, v157, v154
    v_fma_f32 v92, v92, s34, -v156
    v_fma_f32 v93, v93, s34, -v156
    v_exp_f32 v92, v92
    v_exp_f32 v93, v93
    v_add_f32 v154, v90, v91
    v_cvt_pk_bf16_f32 v109, v90, v91
    v_add_f32 v157, v157, v154
    v_fma_f32 v94, v94, s34, -v156
    v_fma_f32 v95, v95, s34, -v156
    v_exp_f32 v94, v94
    v_exp_f32 v95, v95
    v_add_f32 v154, v92, v93
    v_cvt_pk_bf16_f32 v110, v92, v93
    v_add_f32 v157, v157, v154
    s_nop 0
    v_add_f32 v154, v94, v95
    v_cvt_pk_bf16_f32 v111, v94, v95
    v_add_f32 v157, v157, v154
    s_waitcnt vmcnt(0)
    s_mul_i32 s47, s28, 20480
    s_mul_i32 s48, s93, 640
    s_add_u32 s47, s47, s48
    v_add_u32 v16, 0, v0
    v_mul_u32_u24 v17, 3277, v16
    v_lshrrev_b32 v17, 16, v17
    v_mul_u32_u24 v18, 20, v17
    v_sub_u32 v18, v16, v18
    v_bfe_u32 v19, v17, 2, 1
    v_lshlrev_b32 v19, 1, v19
    v_xor_b32 v18, v19, v18
    v_mul_u32_u24 v17, 1280, v17
    v_lshl_add_u32 v17, v18, 4, v17
    v_add_u32 v1, s47, v17
    v_add_u32 v16, 64, v0
    v_mul_u32_u24 v17, 3277, v16
    v_lshrrev_b32 v17, 16, v17
    v_mul_u32_u24 v18, 20, v17
    v_sub_u32 v18, v16, v18
    v_bfe_u32 v19, v17, 2, 1
    v_lshlrev_b32 v19, 1, v19
    v_xor_b32 v18, v19, v18
    v_mul_u32_u24 v17, 1280, v17
    v_lshl_add_u32 v17, v18, 4, v17
    v_add_u32 v2, s47, v17
    v_add_u32 v16, 128, v0
    v_mul_u32_u24 v17, 3277, v16
    v_lshrrev_b32 v17, 16, v17
    v_mul_u32_u24 v18, 20, v17
    v_sub_u32 v18, v16, v18
    v_bfe_u32 v19, v17, 2, 1
    v_lshlrev_b32 v19, 1, v19
    v_xor_b32 v18, v19, v18
    v_mul_u32_u24 v17, 1280, v17
    v_lshl_add_u32 v17, v18, 4, v17
    v_add_u32 v3, s47, v17
    v_add_u32 v16, 192, v0
    v_mul_u32_u24 v17, 3277, v16
    v_lshrrev_b32 v17, 16, v17
    v_mul_u32_u24 v18, 20, v17
    v_sub_u32 v18, v16, v18
    v_bfe_u32 v19, v17, 2, 1
    v_lshlrev_b32 v19, 1, v19
    v_xor_b32 v18, v19, v18
    v_mul_u32_u24 v17, 1280, v17
    v_lshl_add_u32 v17, v18, 4, v17
    v_add_u32 v4, s47, v17
    v_add_u32 v16, 256, v0
    v_mul_u32_u24 v17, 3277, v16
    v_lshrrev_b32 v17, 16, v17
    v_mul_u32_u24 v18, 20, v17
    v_sub_u32 v18, v16, v18
    v_bfe_u32 v19, v17, 2, 1
    v_lshlrev_b32 v19, 1, v19
    v_xor_b32 v18, v19, v18
    v_mul_u32_u24 v17, 1280, v17
    v_lshl_add_u32 v17, v18, 4, v17
    v_add_u32 v5, s47, v17
    s_mul_i32 s29, s92, 5120
    s_mul_i32 s37, s93, 245760
    s_sub_u32 s38, 245760, s37
    v_lshrrev_b32 v16, 2, v0
    v_bfe_u32 v18, v0, 4, 1
    s_lshl_b32 s47, s93, 6
    v_add_u32 v16, s47, v16
    v_mul_u32_u24 v16, 320, v16
    v_and_b32 v17, 3, v0
    v_lshl_add_u32 v16, v17, 3, v16
    v_lshlrev_b32 v18, 5, v18
    v_add_u32 v148, v16, v18
    v_sub_u32 v149, v16, v18
    v_add_u32 v150, 81920, v148
    v_add_u32 v151, 81920, v149
    s_waitcnt vmcnt(0) lgkmcnt(0)
    s_barrier
    ds_read_b64_tr_b16 v[112:113], v8 offset:0
    ds_read_b64_tr_b16 v[114:115], v8 offset:6144
    ds_read_b64_tr_b16 v[116:117], v9 offset:0
    ds_read_b64_tr_b16 v[118:119], v9 offset:6144
    ds_read_b64_tr_b16 v[120:121], v10 offset:0
    ds_read_b64_tr_b16 v[122:123], v10 offset:6144
    ds_read_b64_tr_b16 v[124:125], v11 offset:0
    ds_read_b64_tr_b16 v[126:127], v11 offset:6144
    ds_read_b64_tr_b16 v[128:129], v8 offset:1024
    ds_read_b64_tr_b16 v[130:131], v8 offset:7168
    ds_read_b64_tr_b16 v[132:133], v9 offset:1024
    ds_read_b64_tr_b16 v[134:135], v9 offset:7168
    ds_read_b64_tr_b16 v[136:137], v10 offset:1024
    ds_read_b64_tr_b16 v[138:139], v10 offset:7168
    s_waitcnt lgkmcnt(12)
    v_mfma_f32_16x16x32_bf16 v[160:163], v[112:115], v[104:107], v[160:163]
    ds_read_b64_tr_b16 v[140:141], v11 offset:1024
    ds_read_b64_tr_b16 v[142:143], v11 offset:7168
    s_add_u32 s31, s37, 0
    v_mfma_f32_16x16x32_bf16 v[164:167], v[112:115], v[108:111], v[164:167]
    s_add_u32 m0, s29, 0
    s_nop 0
    buffer_load_dwordx4 v1, s[16:19], s31 offen lds
    s_waitcnt lgkmcnt(12)
    v_mfma_f32_16x16x32_bf16 v[168:171], v[116:119], v[104:107], v[168:171]
    ds_read_b64_tr_b16 v[144:145], v8 offset:2048
    ds_read_b64_tr_b16 v[146:147], v8 offset:8192
    s_add_u32 m0, s29, 1024
    v_mfma_f32_16x16x32_bf16 v[172:175], v[116:119], v[108:111], v[172:175]
    s_nop 0
    buffer_load_dwordx4 v2, s[16:19], s31 offen lds
    s_waitcnt lgkmcnt(12)
    v_mfma_f32_16x16x32_bf16 v[176:179], v[120:123], v[104:107], v[176:179]
    ds_read_b64_tr_b16 v[112:113], v9 offset:2048
    ds_read_b64_tr_b16 v[114:115], v9 offset:8192
    s_add_u32 m0, s29, 2048
    v_mfma_f32_16x16x32_bf16 v[180:183], v[120:123], v[108:111], v[180:183]
    s_nop 0
    buffer_load_dwordx4 v3, s[16:19], s31 offen lds
    s_waitcnt lgkmcnt(12)
    v_mfma_f32_16x16x32_bf16 v[184:187], v[124:127], v[104:107], v[184:187]
    ds_read_b64_tr_b16 v[116:117], v10 offset:2048
    ds_read_b64_tr_b16 v[118:119], v10 offset:8192
    s_add_u32 m0, s29, 3072
    v_mfma_f32_16x16x32_bf16 v[188:191], v[124:127], v[108:111], v[188:191]
    s_nop 0
    buffer_load_dwordx4 v4, s[16:19], s31 offen lds
    s_waitcnt lgkmcnt(12)
    v_mfma_f32_16x16x32_bf16 v[192:195], v[128:131], v[104:107], v[192:195]
    ds_read_b64_tr_b16 v[120:121], v11 offset:2048
    ds_read_b64_tr_b16 v[122:123], v11 offset:8192
    s_add_u32 m0, s29, 4096
    v_mfma_f32_16x16x32_bf16 v[196:199], v[128:131], v[108:111], v[196:199]
    s_nop 0
    buffer_load_dwordx4 v5, s[16:19], s31 offen lds
    s_waitcnt lgkmcnt(12)
    v_mfma_f32_16x16x32_bf16 v[200:203], v[132:135], v[104:107], v[200:203]
    v_mfma_f32_16x16x32_bf16 v[204:207], v[132:135], v[108:111], v[204:207]
    s_waitcnt lgkmcnt(10)
    v_mfma_f32_16x16x32_bf16 v[208:211], v[136:139], v[104:107], v[208:211]
    v_mfma_f32_16x16x32_bf16 v[212:215], v[136:139], v[108:111], v[212:215]
    s_waitcnt lgkmcnt(8)
    v_mfma_f32_16x16x32_bf16 v[216:219], v[140:143], v[104:107], v[216:219]
    v_mfma_f32_16x16x32_bf16 v[220:223], v[140:143], v[108:111], v[220:223]
    s_waitcnt lgkmcnt(6)
    v_mfma_f32_16x16x32_bf16 v[224:227], v[144:147], v[104:107], v[224:227]
    v_mfma_f32_16x16x32_bf16 v[228:231], v[144:147], v[108:111], v[228:231]
    s_waitcnt lgkmcnt(4)
    v_mfma_f32_16x16x32_bf16 v[232:235], v[112:115], v[104:107], v[232:235]
    v_mfma_f32_16x16x32_bf16 v[236:239], v[112:115], v[108:111], v[236:239]
    s_waitcnt lgkmcnt(2)
    v_mfma_f32_16x16x32_bf16 v[240:243], v[116:119], v[104:107], v[240:243]
    v_mfma_f32_16x16x32_bf16 v[244:247], v[116:119], v[108:111], v[244:247]
    s_waitcnt lgkmcnt(0)
    v_mfma_f32_16x16x32_bf16 v[248:251], v[120:123], v[104:107], v[248:251]
    v_mfma_f32_16x16x32_bf16 v[252:255], v[120:123], v[108:111], v[252:255]
    s_nop 7
    s_nop 3
    s_branch L_k1_epi
L_rareA1:
    s_getpc_b64 s[94:95]
    s_branch L_newmax
    s_branch L_backA1
L_rareA2:
    s_getpc_b64 s[94:95]
    s_branch L_newmax
    s_branch L_backA2
L_rareB3:
    s_getpc_b64 s[94:95]
    s_branch L_rescale
    s_branch L_backB3
L_rareA4:
    s_getpc_b64 s[94:95]
    s_branch L_newmax
    s_branch L_backA4
L_rareB5:
    s_getpc_b64 s[94:95]
    s_branch L_rescale
    s_branch L_backB5
L_rareA6:
    s_getpc_b64 s[94:95]
    s_branch L_newmax
    s_branch L_backA6
L_rareB7:
    s_getpc_b64 s[94:95]
    s_branch L_rescale
    s_branch L_backB7
L_rareA8:
    s_getpc_b64 s[94:95]
    s_branch L_newmax
    s_branch L_backA8
L_rareB9:
    s_getpc_b64 s[94:95]
    s_branch L_rescale
    s_branch L_backB9
L_rareA10:
    s_getpc_b64 s[94:95]
    s_branch L_newmax
    s_branch L_backA10
L_rareB11:
    s_getpc_b64 s[94:95]
    s_branch L_rescale
    s_branch L_backB11
L_rareA12:
    s_getpc_b64 s[94:95]
    s_branch L_newmax
    s_branch L_backA12
L_rareB13:
    s_getpc_b64 s[94:95]
    s_branch L_rescale
    s_branch L_backB13
L_rareA14:
    s_getpc_b64 s[94:95]
    s_branch L_newmax
    s_branch L_backA14
L_rareB15:
    s_getpc_b64 s[94:95]
    s_branch L_rescale
    s_branch L_backB15
L_rescale:
    s_nop 7
    s_nop 3
    v_mul_f32 v160, v160, v14
    v_mul_f32 v161, v161, v14
    v_mul_f32 v162, v162, v14
    v_mul_f32 v163, v163, v14
    v_mul_f32 v164, v164, v158
    v_mul_f32 v165, v165, v158
    v_mul_f32 v166, v166, v158
    v_mul_f32 v167, v167, v158
    v_mul_f32 v168, v168, v14
    v_mul_f32 v169, v169, v14
    v_mul_f32 v170, v170, v14
    v_mul_f32 v171, v171, v14
    v_mul_f32 v172, v172, v158
    v_mul_f32 v173, v173, v158
    v_mul_f32 v174, v174, v158
    v_mul_f32 v175, v175, v158
    v_mul_f32 v176, v176, v14
    v_mul_f32 v177, v177, v14
    v_mul_f32 v178, v178, v14
    v_mul_f32 v179, v179, v14
    v_mul_f32 v180, v180, v158
    v_mul_f32 v181, v181, v158
    v_mul_f32 v182, v182, v158
    v_mul_f32 v183, v183, v158
    v_mul_f32 v184, v184, v14
    v_mul_f32 v185, v185, v14
    v_mul_f32 v186, v186, v14
    v_mul_f32 v187, v187, v14
    v_mul_f32 v188, v188, v158
    v_mul_f32 v189, v189, v158
    v_mul_f32 v190, v190, v158
    v_mul_f32 v191, v191, v158
    v_mul_f32 v192, v192, v14
    v_mul_f32 v193, v193, v14
    v_mul_f32 v194, v194, v14
    v_mul_f32 v195, v195, v14
    v_mul_f32 v196, v196, v158
    v_mul_f32 v197, v197, v158
    v_mul_f32 v198, v198, v158
    v_mul_f32 v199, v199, v158
    v_mul_f32 v200, v200, v14
    v_mul_f32 v201, v201, v14
    v_mul_f32 v202, v202, v14
    v_mul_f32 v203, v203, v14
    v_mul_f32 v204, v204, v158
    v_mul_f32 v205, v205, v158
    v_mul_f32 v206, v206, v158
    v_mul_f32 v207, v207, v158
    v_mul_f32 v208, v208, v14
    v_mul_f32 v209, v209, v14
    v_mul_f32 v210, v210, v14
    v_mul_f32 v211, v211, v14
    v_mul_f32 v212, v212, v158
    v_mul_f32 v213, v213, v158
    v_mul_f32 v214, v214, v158
    v_mul_f32 v215, v215, v158
    v_mul_f32 v216, v216, v14
    v_mul_f32 v217, v217, v14
    v_mul_f32 v218, v218, v14
    v_mul_f32 v219, v219, v14
    v_mul_f32 v220, v220, v158
    v_mul_f32 v221, v221, v158
    v_mul_f32 v222, v222, v158
    v_mul_f32 v223, v223, v158
    v_mul_f32 v224, v224, v14
    v_mul_f32 v225, v225, v14
    v_mul_f32 v226, v226, v14
    v_mul_f32 v227, v227, v14
    v_mul_f32 v228, v228, v158
    v_mul_f32 v229, v229, v158
    v_mul_f32 v230, v230, v158
    v_mul_f32 v231, v231, v158
    v_mul_f32 v232, v232, v14
    v_mul_f32 v233, v233, v14
    v_mul_f32 v234, v234, v14
    v_mul_f32 v235, v235, v14
    v_mul_f32 v236, v236, v158
    v_mul_f32 v237, v237, v158
    v_mul_f32 v238, v238, v158
    v_mul_f32 v239, v239, v158
    v_mul_f32 v240, v240, v14
    v_mul_f32 v241, v241, v14
    v_mul_f32 v242, v242, v14
    v_mul_f32 v243, v243, v14
    v_mul_f32 v244, v244, v158
    v_mul_f32 v245, v245, v158
    v_mul_f32 v246, v246, v158
    v_mul_f32 v247, v247, v158
    v_mul_f32 v248, v248, v14
    v_mul_f32 v249, v249, v14
    v_mul_f32 v250, v250, v14
    v_mul_f32 v251, v251, v14
    v_mul_f32 v252, v252, v158
    v_mul_f32 v253, v253, v158
    v_mul_f32 v254, v254, v158
    v_mul_f32 v255, v255, v158
    s_mov_b32 s58, 0
L_ret:
    s_add_u32 s94, s94, 4
    s_addc_u32 s95, s95, 0
    s_setpc_b64 s[94:95]
L_newmax:
    v_mov_b32 v154, v152
    v_mov_b32 v155, v153
    s_nop 1
    v_permlane32_swap_b32 v152, v154
    v_permlane32_swap_b32 v153, v155
    s_nop 1
    v_max_f32 v152, v152, v154
    v_max_f32 v153, v153, v155
    v_mov_b32 v154, v152
    v_mov_b32 v155, v153
    s_nop 1
    v_permlane16_swap_b32 v152, v154
    v_permlane16_swap_b32 v153, v155
    s_nop 1
    v_max_f32 v152, v152, v154
    v_max_f32 v153, v153, v155
    v_mul_f32 v152, s34, v152
    v_max_f32 v152, v152, v12
    v_sub_f32 v14, v12, v152
    v_exp_f32 v14, v14
    v_mov_b32 v12, v152
    v_add_f32 v15, 0x41000000, v152
    v_mul_f32 v13, v13, v14
    v_mul_f32 v153, s34, v153
    v_max_f32 v153, v153, v156
    v_sub_f32 v158, v156, v153
    v_exp_f32 v158, v158
    v_mov_b32 v156, v153
    v_add_f32 v159, 0x41000000, v153
    v_mul_f32 v157, v157, v158
    s_mov_b32 s58, 1
    s_branch L_ret
L_k1_epi:
    v_mov_b32 v152, v13
    v_mov_b32 v153, v157
    s_nop 1
    v_permlane32_swap_b32 v13, v152
    v_permlane32_swap_b32 v157, v153
    s_nop 1
    v_add_f32 v13, v13, v152
    v_add_f32 v157, v157, v153
    v_mov_b32 v152, v13
    v_mov_b32 v153, v157
    s_nop 1
    v_permlane16_swap_b32 v13, v152
    v_permlane16_swap_b32 v157, v153
    s_nop 1
    v_add_f32 v13, v13, v152
    v_add_f32 v157, v157, v153
    v_rcp_f32 v13, v13
    v_rcp_f32 v157, v157
    v_lshlrev_b32 v10, 4, v0
    s_load_dwordx2 s[44:45], s[0:1], 80
    s_mul_i32 s47, s92, 12288
    s_add_u32 s47, s47, 65536
    v_add_u32 v11, s47, v10
    s_xor_b32 s48, s92, 4
    s_mul_i32 s48, s48, 12288
    s_add_u32 s48, s48, 65536
    v_add_u32 v12, s48, v10
    s_barrier
    v_mul_f32 v160, v160, v13
    v_mul_f32 v161, v161, v13
    v_mul_f32 v162, v162, v13
    v_mul_f32 v163, v163, v13
    v_mul_f32 v168, v168, v13
    v_mul_f32 v169, v169, v13
    v_mul_f32 v170, v170, v13
    v_mul_f32 v171, v171, v13
    v_cvt_pk_bf16_f32 v52, v160, v161
    v_cvt_pk_bf16_f32 v53, v162, v163
    v_cvt_pk_bf16_f32 v54, v168, v169
    v_cvt_pk_bf16_f32 v55, v170, v171
    ds_write_b128 v11, v[52:55] offset:0
    v_mul_f32 v164, v164, v157
    v_mul_f32 v165, v165, v157
    v_mul_f32 v166, v166, v157
    v_mul_f32 v167, v167, v157
    v_mul_f32 v172, v172, v157
    v_mul_f32 v173, v173, v157
    v_mul_f32 v174, v174, v157
    v_mul_f32 v175, v175, v157
    v_cvt_pk_bf16_f32 v56, v164, v165
    v_cvt_pk_bf16_f32 v57, v166, v167
    v_cvt_pk_bf16_f32 v58, v172, v173
    v_cvt_pk_bf16_f32 v59, v174, v175
    ds_write_b128 v11, v[56:59] offset:1024
    v_mul_f32 v176, v176, v13
    v_mul_f32 v177, v177, v13
    v_mul_f32 v178, v178, v13
    v_mul_f32 v179, v179, v13
    v_mul_f32 v184, v184, v13
    v_mul_f32 v185, v185, v13
    v_mul_f32 v186, v186, v13
    v_mul_f32 v187, v187, v13
    v_cvt_pk_bf16_f32 v60, v176, v177
    v_cvt_pk_bf16_f32 v61, v178, v179
    v_cvt_pk_bf16_f32 v62, v184, v185
    v_cvt_pk_bf16_f32 v63, v186, v187
    ds_write_b128 v11, v[60:63] offset:2048
    v_mul_f32 v180, v180, v157
    v_mul_f32 v181, v181, v157
    v_mul_f32 v182, v182, v157
    v_mul_f32 v183, v183, v157
    v_mul_f32 v188, v188, v157
    v_mul_f32 v189, v189, v157
    v_mul_f32 v190, v190, v157
    v_mul_f32 v191, v191, v157
    v_cvt_pk_bf16_f32 v64, v180, v181
    v_cvt_pk_bf16_f32 v65, v182, v183
    v_cvt_pk_bf16_f32 v66, v188, v189
    v_cvt_pk_bf16_f32 v67, v190, v191
    ds_write_b128 v11, v[64:67] offset:3072
    v_mul_f32 v192, v192, v13
    v_mul_f32 v193, v193, v13
    v_mul_f32 v194, v194, v13
    v_mul_f32 v195, v195, v13
    v_mul_f32 v200, v200, v13
    v_mul_f32 v201, v201, v13
    v_mul_f32 v202, v202, v13
    v_mul_f32 v203, v203, v13
    v_cvt_pk_bf16_f32 v68, v192, v193
    v_cvt_pk_bf16_f32 v69, v194, v195
    v_cvt_pk_bf16_f32 v70, v200, v201
    v_cvt_pk_bf16_f32 v71, v202, v203
    ds_write_b128 v11, v[68:71] offset:4096
    v_mul_f32 v196, v196, v157
    v_mul_f32 v197, v197, v157
    v_mul_f32 v198, v198, v157
    v_mul_f32 v199, v199, v157
    v_mul_f32 v204, v204, v157
    v_mul_f32 v205, v205, v157
    v_mul_f32 v206, v206, v157
    v_mul_f32 v207, v207, v157
    v_cvt_pk_bf16_f32 v72, v196, v197
    v_cvt_pk_bf16_f32 v73, v198, v199
    v_cvt_pk_bf16_f32 v74, v204, v205
    v_cvt_pk_bf16_f32 v75, v206, v207
    ds_write_b128 v11, v[72:75] offset:5120
    v_mul_f32 v208, v208, v13
    v_mul_f32 v209, v209, v13
    v_mul_f32 v210, v210, v13
    v_mul_f32 v211, v211, v13
    v_mul_f32 v216, v216, v13
    v_mul_f32 v217, v217, v13
    v_mul_f32 v218, v218, v13
    v_mul_f32 v219, v219, v13
    v_cvt_pk_bf16_f32 v76, v208, v209
    v_cvt_pk_bf16_f32 v77, v210, v211
    v_cvt_pk_bf16_f32 v78, v216, v217
    v_cvt_pk_bf16_f32 v79, v218, v219
    ds_write_b128 v11, v[76:79] offset:6144
    v_mul_f32 v212, v212, v157
    v_mul_f32 v213, v213, v157
    v_mul_f32 v214, v214, v157
    v_mul_f32 v215, v215, v157
    v_mul_f32 v220, v220, v157
    v_mul_f32 v221, v221, v157
    v_mul_f32 v222, v222, v157
    v_mul_f32 v223, v223, v157
    v_cvt_pk_bf16_f32 v80, v212, v213
    v_cvt_pk_bf16_f32 v81, v214, v215
    v_cvt_pk_bf16_f32 v82, v220, v221
    v_cvt_pk_bf16_f32 v83, v222, v223
    ds_write_b128 v11, v[80:83] offset:7168
    v_mul_f32 v224, v224, v13
    v_mul_f32 v225, v225, v13
    v_mul_f32 v226, v226, v13
    v_mul_f32 v227, v227, v13
    v_mul_f32 v232, v232, v13
    v_mul_f32 v233, v233, v13
    v_mul_f32 v234, v234, v13
    v_mul_f32 v235, v235, v13
    v_cvt_pk_bf16_f32 v84, v224, v225
    v_cvt_pk_bf16_f32 v85, v226, v227
    v_cvt_pk_bf16_f32 v86, v232, v233
    v_cvt_pk_bf16_f32 v87, v234, v235
    ds_write_b128 v11, v[84:87] offset:8192
    v_mul_f32 v228, v228, v157
    v_mul_f32 v229, v229, v157
    v_mul_f32 v230, v230, v157
    v_mul_f32 v231, v231, v157
    v_mul_f32 v236, v236, v157
    v_mul_f32 v237, v237, v157
    v_mul_f32 v238, v238, v157
    v_mul_f32 v239, v239, v157
    v_cvt_pk_bf16_f32 v88, v228, v229
    v_cvt_pk_bf16_f32 v89, v230, v231
    v_cvt_pk_bf16_f32 v90, v236, v237
    v_cvt_pk_bf16_f32 v91, v238, v239
    ds_write_b128 v11, v[88:91] offset:9216
    v_mul_f32 v240, v240, v13
    v_mul_f32 v241, v241, v13
    v_mul_f32 v242, v242, v13
    v_mul_f32 v243, v243, v13
    v_mul_f32 v248, v248, v13
    v_mul_f32 v249, v249, v13
    v_mul_f32 v250, v250, v13
    v_mul_f32 v251, v251, v13
    v_cvt_pk_bf16_f32 v92, v240, v241
    v_cvt_pk_bf16_f32 v93, v242, v243
    v_cvt_pk_bf16_f32 v94, v248, v249
    v_cvt_pk_bf16_f32 v95, v250, v251
    ds_write_b128 v11, v[92:95] offset:10240
    v_mul_f32 v244, v244, v157
    v_mul_f32 v245, v245, v157
    v_mul_f32 v246, v246, v157
    v_mul_f32 v247, v247, v157
    v_mul_f32 v252, v252, v157
    v_mul_f32 v253, v253, v157
    v_mul_f32 v254, v254, v157
    v_mul_f32 v255, v255, v157
    v_cvt_pk_bf16_f32 v96, v244, v245
    v_cvt_pk_bf16_f32 v97, v246, v247
    v_cvt_pk_bf16_f32 v98, v252, v253
    v_cvt_pk_bf16_f32 v99, v254, v255
    ds_write_b128 v11, v[96:99] offset:11264
    s_mul_i32 s49, s88, 163840
    s_mul_i32 s48, s92, 20480
    s_add_u32 s49, s49, s48
    s_waitcnt lgkmcnt(0)
    s_mov_b32 s8, s44
    s_and_b32 s9, s45, 0xffff
    s_mov_b32 s10, 2621440
    s_mov_b32 s11, 0x00020000
    s_barrier
    ds_read_b128 v[100:103], v12 offset:0
    ds_read_b128 v[104:107], v12 offset:1024
    ds_read_b128 v[108:111], v12 offset:2048
    ds_read_b128 v[112:115], v12 offset:3072
    ds_read_b128 v[116:119], v12 offset:4096
    ds_read_b128 v[120:123], v12 offset:5120
    ds_read_b128 v[124:127], v12 offset:6144
    ds_read_b128 v[128:131], v12 offset:7168
    ds_read_b128 v[132:135], v12 offset:8192
    ds_read_b128 v[136:139], v12 offset:9216
    ds_read_b128 v[140:143], v12 offset:10240
    ds_read_b128 v[144:147], v12 offset:11264
    s_waitcnt vmcnt(0) lgkmcnt(0)
    s_barrier
    v_mov_b32 v11, 1
    s_cmp_eq_u32 s92, 7
    s_cselect_b32 s45, 0, s59
    s_lshl_b32 s47, s88, 8
    s_add_u32 s46, s45, s47
    s_add_u32 s31, s37, 81920
    s_add_u32 m0, s29, 40960
    s_nop 0
    buffer_load_dwordx4 v1, s[16:19], s31 offen lds
    s_add_u32 m0, s29, 41984
    s_nop 0
    buffer_load_dwordx4 v2, s[16:19], s31 offen lds
    s_add_u32 m0, s29, 43008
    s_nop 0
    buffer_load_dwordx4 v3, s[16:19], s31 offen lds
    s_add_u32 m0, s29, 44032
    s_nop 0
    buffer_load_dwordx4 v4, s[16:19], s31 offen lds
    s_add_u32 m0, s29, 45056
    s_nop 0
    buffer_load_dwordx4 v5, s[16:19], s31 offen lds
    ds_read_b64_tr_b16 v[16:17], v148 offset:0
    ds_read_b64_tr_b16 v[18:19], v148 offset:5120
    ds_read_b64_tr_b16 v[20:21], v149 offset:32
    ds_read_b64_tr_b16 v[22:23], v149 offset:5152
    ds_read_b64_tr_b16 v[24:25], v148 offset:64
    ds_read_b64_tr_b16 v[26:27], v148 offset:5184
    ds_read_b64_tr_b16 v[28:29], v149 offset:96
    ds_read_b64_tr_b16 v[30:31], v149 offset:5216
    ds_read_b64_tr_b16 v[32:33], v148 offset:128
    ds_read_b64_tr_b16 v[34:35], v148 offset:5248
    ds_read_b64_tr_b16 v[36:37], v149 offset:160
    ds_read_b64_tr_b16 v[38:39], v149 offset:5280
    ds_read_b64_tr_b16 v[40:41], v148 offset:192
    ds_read_b64_tr_b16 v[42:43], v148 offset:5312
    s_waitcnt lgkmcnt(12)
    v_mfma_f32_16x16x32_bf16 v[176:179], v[16:19], v[52:55], 0
    ds_read_b64_tr_b16 v[44:45], v149 offset:224
    ds_read_b64_tr_b16 v[46:47], v149 offset:5344
    s_add_u32 s31, s37, 163840
    v_mfma_f32_16x16x32_bf16 v[180:183], v[16:19], v[56:59], 0
    s_add_u32 m0, s29, 81920
    s_nop 0
    buffer_load_dwordx4 v1, s[16:19], s31 offen lds
    s_waitcnt lgkmcnt(12)
    v_mfma_f32_16x16x32_bf16 v[184:187], v[20:23], v[52:55], 0
    ds_read_b64_tr_b16 v[48:49], v148 offset:256
    ds_read_b64_tr_b16 v[50:51], v148 offset:5376
    s_add_u32 m0, s29, 82944
    v_mfma_f32_16x16x32_bf16 v[188:191], v[20:23], v[56:59], 0
    s_nop 0
    buffer_load_dwordx4 v2, s[16:19], s31 offen lds
    s_waitcnt lgkmcnt(12)
    v_mfma_f32_16x16x32_bf16 v[192:195], v[24:27], v[52:55], 0
    ds_read_b64_tr_b16 v[16:17], v149 offset:288
    ds_read_b64_tr_b16 v[18:19], v149 offset:5408
    s_add_u32 m0, s29, 83968
    v_mfma_f32_16x16x32_bf16 v[196:199], v[24:27], v[56:59], 0
    s_nop 0
    buffer_load_dwordx4 v3, s[16:19], s31 offen lds
    s_waitcnt lgkmcnt(12)
    v_mfma_f32_16x16x32_bf16 v[200:203], v[28:31], v[52:55], 0
    ds_read_b64_tr_b16 v[20:21], v148 offset:10240
    ds_read_b64_tr_b16 v[22:23], v148 offset:15360
    s_add_u32 m0, s29, 84992
    v_mfma_f32_16x16x32_bf16 v[204:207], v[28:31], v[56:59], 0
    s_nop 0
    buffer_load_dwordx4 v4, s[16:19], s31 offen lds
    s_waitcnt lgkmcnt(12)
    v_mfma_f32_16x16x32_bf16 v[208:211], v[32:35], v[52:55], 0
    ds_read_b64_tr_b16 v[24:25], v149 offset:10272
    ds_read_b64_tr_b16 v[26:27], v149 offset:15392
    s_add_u32 m0, s29, 86016
    v_mfma_f32_16x16x32_bf16 v[212:215], v[32:35], v[56:59], 0
    s_nop 0
    buffer_load_dwordx4 v5, s[16:19], s31 offen lds
    s_waitcnt lgkmcnt(12)
    v_mfma_f32_16x16x32_bf16 v[216:219], v[36:39], v[52:55], 0
    ds_read_b64_tr_b16 v[28:29], v148 offset:10304
    ds_read_b64_tr_b16 v[30:31], v148 offset:15424
    s_add_u32 s31, s38, 0
    v_mfma_f32_16x16x32_bf16 v[220:223], v[36:39], v[56:59], 0
    s_add_u32 m0, s29, 122880
    s_nop 0
    buffer_load_dwordx4 v1, s[16:19], s31 offen lds
    s_waitcnt lgkmcnt(12)
    v_mfma_f32_16x16x32_bf16 v[224:227], v[40:43], v[52:55], 0
    ds_read_b64_tr_b16 v[32:33], v149 offset:10336
    ds_read_b64_tr_b16 v[34:35], v149 offset:15456
    s_add_u32 m0, s29, 123904
    v_mfma_f32_16x16x32_bf16 v[228:231], v[40:43], v[56:59], 0
    s_nop 0
    buffer_load_dwordx4 v2, s[16:19], s31 offen lds
    s_waitcnt lgkmcnt(12)
    v_mfma_f32_16x16x32_bf16 v[232:235], v[44:47], v[52:55], 0
    ds_read_b64_tr_b16 v[36:37], v148 offset:10368
    ds_read_b64_tr_b16 v[38:39], v148 offset:15488
    s_add_u32 m0, s29, 124928
    v_mfma_f32_16x16x32_bf16 v[236:239], v[44:47], v[56:59], 0
    s_nop 0
    buffer_load_dwordx4 v3, s[16:19], s31 offen lds
    s_waitcnt lgkmcnt(12)
    v_mfma_f32_16x16x32_bf16 v[240:243], v[48:51], v[52:55], 0
    ds_read_b64_tr_b16 v[40:41], v149 offset:10400
    ds_read_b64_tr_b16 v[42:43], v149 offset:15520
    s_add_u32 m0, s29, 125952
    v_mfma_f32_16x16x32_bf16 v[244:247], v[48:51], v[56:59], 0
    s_nop 0
    buffer_load_dwordx4 v4, s[16:19], s31 offen lds
    s_waitcnt lgkmcnt(12)
    v_mfma_f32_16x16x32_bf16 v[248:251], v[16:19], v[52:55], 0
    ds_read_b64_tr_b16 v[44:45], v148 offset:10432
    ds_read_b64_tr_b16 v[46:47], v148 offset:15552
    s_add_u32 m0, s29, 126976
    v_mfma_f32_16x16x32_bf16 v[252:255], v[16:19], v[56:59], 0
    s_nop 0
    buffer_load_dwordx4 v5, s[16:19], s31 offen lds
    s_waitcnt lgkmcnt(12)
    v_mfma_f32_16x16x32_bf16 v[176:179], v[20:23], v[60:63], v[176:179]
    ds_read_b64_tr_b16 v[48:49], v149 offset:10464
    v_mfma_f32_16x16x32_bf16 v[180:183], v[20:23], v[64:67], v[180:183]
    ds_read_b64_tr_b16 v[50:51], v149 offset:15584
    s_waitcnt lgkmcnt(12)
    v_mfma_f32_16x16x32_bf16 v[184:187], v[24:27], v[60:63], v[184:187]
    ds_read_b64_tr_b16 v[16:17], v148 offset:10496
    v_mfma_f32_16x16x32_bf16 v[188:191], v[24:27], v[64:67], v[188:191]
    ds_read_b64_tr_b16 v[18:19], v148 offset:15616
    s_waitcnt lgkmcnt(12)
    v_mfma_f32_16x16x32_bf16 v[192:195], v[28:31], v[60:63], v[192:195]
    ds_read_b64_tr_b16 v[20:21], v149 offset:10528
    v_mfma_f32_16x16x32_bf16 v[196:199], v[28:31], v[64:67], v[196:199]
    ds_read_b64_tr_b16 v[22:23], v149 offset:15648
    s_waitcnt lgkmcnt(12)
    v_mfma_f32_16x16x32_bf16 v[200:203], v[32:35], v[60:63], v[200:203]
    v_mfma_f32_16x16x32_bf16 v[204:207], v[32:35], v[64:67], v[204:207]
    s_waitcnt lgkmcnt(10)
    v_mfma_f32_16x16x32_bf16 v[208:211], v[36:39], v[60:63], v[208:211]
    v_mfma_f32_16x16x32_bf16 v[212:215], v[36:39], v[64:67], v[212:215]
    s_waitcnt lgkmcnt(8)
    v_mfma_f32_16x16x32_bf16 v[216:219], v[40:43], v[60:63], v[216:219]
    v_mfma_f32_16x16x32_bf16 v[220:223], v[40:43], v[64:67], v[220:223]
    s_waitcnt vmcnt(10) lgkmcnt(0)
    s_barrier
    v_mfma_f32_16x16x32_bf16 v[224:227], v[44:47], v[60:63], v[224:227]
    ds_read_b64_tr_b16 v[24:25], v148 offset:40960
    ds_read_b64_tr_b16 v[26:27], v148 offset:46080
    ds_read_b64_tr_b16 v[28:29], v149 offset:40992
    ds_read_b64_tr_b16 v[30:31], v149 offset:46112
    v_mfma_f32_16x16x32_bf16 v[228:231], v[44:47], v[64:67], v[228:231]
    s_add_u32 s31, s38, 81920
    s_add_u32 m0, s29, 0
    s_nop 0
    buffer_load_dwordx4 v1, s[16:19], s31 offen lds
    v_mfma_f32_16x16x32_bf16 v[232:235], v[48:51], v[60:63], v[232:235]
    ds_read_b64_tr_b16 v[32:33], v148 offset:41024
    ds_read_b64_tr_b16 v[34:35], v148 offset:46144
    ds_read_b64_tr_b16 v[36:37], v149 offset:41056
    ds_read_b64_tr_b16 v[38:39], v149 offset:46176
    v_mfma_f32_16x16x32_bf16 v[236:239], v[48:51], v[64:67], v[236:239]
    s_add_u32 m0, s29, 1024
    s_nop 0
    buffer_load_dwordx4 v2, s[16:19], s31 offen lds
    v_mfma_f32_16x16x32_bf16 v[240:243], v[16:19], v[60:63], v[240:243]
    ds_read_b64_tr_b16 v[40:41], v148 offset:41088
    ds_read_b64_tr_b16 v[42:43], v148 offset:46208
    ds_read_b64_tr_b16 v[44:45], v149 offset:41120
    ds_read_b64_tr_b16 v[46:47], v149 offset:46240
    v_mfma_f32_16x16x32_bf16 v[244:247], v[16:19], v[64:67], v[244:247]
    s_add_u32 m0, s29, 2048
    s_nop 0
    buffer_load_dwordx4 v3, s[16:19], s31 offen lds
    v_mfma_f32_16x16x32_bf16 v[248:251], v[20:23], v[60:63], v[248:251]
    ds_read_b64_tr_b16 v[48:49], v148 offset:41152
    ds_read_b64_tr_b16 v[50:51], v148 offset:46272
    s_add_u32 m0, s29, 3072
    v_mfma_f32_16x16x32_bf16 v[252:255], v[20:23], v[64:67], v[252:255]
    s_nop 0
    buffer_load_dwordx4 v4, s[16:19], s31 offen lds
    s_waitcnt lgkmcnt(12)
    v_mfma_f32_16x16x32_bf16 v[176:179], v[24:27], v[68:71], v[176:179]
    ds_read_b64_tr_b16 v[16:17], v149 offset:41184
    ds_read_b64_tr_b16 v[18:19], v149 offset:46304
    s_add_u32 m0, s29, 4096
    v_mfma_f32_16x16x32_bf16 v[180:183], v[24:27], v[72:75], v[180:183]
    s_nop 0
    buffer_load_dwordx4 v5, s[16:19], s31 offen lds
    s_waitcnt lgkmcnt(12)
    v_mfma_f32_16x16x32_bf16 v[184:187], v[28:31], v[68:71], v[184:187]
    ds_read_b64_tr_b16 v[20:21], v148 offset:41216
    v_mfma_f32_16x16x32_bf16 v[188:191], v[28:31], v[72:75], v[188:191]
    ds_read_b64_tr_b16 v[22:23], v148 offset:46336
    s_waitcnt lgkmcnt(12)
    v_mfma_f32_16x16x32_bf16 v[192:195], v[32:35], v[68:71], v[192:195]
    ds_read_b64_tr_b16 v[24:25], v149 offset:41248
    v_mfma_f32_16x16x32_bf16 v[196:199], v[32:35], v[72:75], v[196:199]
    ds_read_b64_tr_b16 v[26:27], v149 offset:46368
    s_waitcnt lgkmcnt(12)
    v_mfma_f32_16x16x32_bf16 v[200:203], v[36:39], v[68:71], v[200:203]
    ds_read_b64_tr_b16 v[28:29], v148 offset:51200
    v_mfma_f32_16x16x32_bf16 v[204:207], v[36:39], v[72:75], v[204:207]
    ds_read_b64_tr_b16 v[30:31], v148 offset:56320
    s_waitcnt lgkmcnt(12)
    v_mfma_f32_16x16x32_bf16 v[208:211], v[40:43], v[68:71], v[208:211]
    ds_read_b64_tr_b16 v[32:33], v149 offset:51232
    v_mfma_f32_16x16x32_bf16 v[212:215], v[40:43], v[72:75], v[212:215]
    ds_read_b64_tr_b16 v[34:35], v149 offset:56352
    s_waitcnt lgkmcnt(12)
    v_mfma_f32_16x16x32_bf16 v[216:219], v[44:47], v[68:71], v[216:219]
    ds_read_b64_tr_b16 v[36:37], v148 offset:51264
    v_mfma_f32_16x16x32_bf16 v[220:223], v[44:47], v[72:75], v[220:223]
    ds_read_b64_tr_b16 v[38:39], v148 offset:56384
    s_waitcnt lgkmcnt(12)
    v_mfma_f32_16x16x32_bf16 v[224:227], v[48:51], v[68:71], v[224:227]
    ds_read_b64_tr_b16 v[40:41], v149 offset:51296
    v_mfma_f32_16x16x32_bf16 v[228:231], v[48:51], v[72:75], v[228:231]
    ds_read_b64_tr_b16 v[42:43], v149 offset:56416
    s_waitcnt lgkmcnt(12)
    v_mfma_f32_16x16x32_bf16 v[232:235], v[16:19], v[68:71], v[232:235]
    ds_read_b64_tr_b16 v[44:45], v148 offset:51328
    v_mfma_f32_16x16x32_bf16 v[236:239], v[16:19], v[72:75], v[236:239]
    ds_read_b64_tr_b16 v[46:47], v148 offset:56448
    s_waitcnt lgkmcnt(12)
    v_mfma_f32_16x16x32_bf16 v[240:243], v[20:23], v[68:71], v[240:243]
    ds_read_b64_tr_b16 v[48:49], v149 offset:51360
    v_mfma_f32_16x16x32_bf16 v[244:247], v[20:23], v[72:75], v[244:247]
    ds_read_b64_tr_b16 v[50:51], v149 offset:56480
    s_waitcnt lgkmcnt(12)
    v_mfma_f32_16x16x32_bf16 v[248:251], v[24:27], v[68:71], v[248:251]
    ds_read_b64_tr_b16 v[16:17], v148 offset:51392
    v_mfma_f32_16x16x32_bf16 v[252:255], v[24:27], v[72:75], v[252:255]
    ds_read_b64_tr_b16 v[18:19], v148 offset:56512
    s_waitcnt lgkmcnt(12)
    v_mfma_f32_16x16x32_bf16 v[176:179], v[28:31], v[76:79], v[176:179]
    ds_read_b64_tr_b16 v[20:21], v149 offset:51424
    v_mfma_f32_16x16x32_bf16 v[180:183], v[28:31], v[80:83], v[180:183]
    ds_read_b64_tr_b16 v[22:23], v149 offset:56544
    s_waitcnt lgkmcnt(12)
    v_mfma_f32_16x16x32_bf16 v[184:187], v[32:35], v[76:79], v[184:187]
    ds_read_b64_tr_b16 v[24:25], v148 offset:51456
    v_mfma_f32_16x16x32_bf16 v[188:191], v[32:35], v[80:83], v[188:191]
    ds_read_b64_tr_b16 v[26:27], v148 offset:56576
    s_waitcnt lgkmcnt(12)
    v_mfma_f32_16x16x32_bf16 v[192:195], v[36:39], v[76:79], v[192:195]
    ds_read_b64_tr_b16 v[28:29], v149 offset:51488
    v_mfma_f32_16x16x32_bf16 v[196:199], v[36:39], v[80:83], v[196:199]
    ds_read_b64_tr_b16 v[30:31], v149 offset:56608
    s_waitcnt lgkmcnt(12)
    v_mfma_f32_16x16x32_bf16 v[200:203], v[40:43], v[76:79], v[200:203]
    v_mfma_f32_16x16x32_bf16 v[204:207], v[40:43], v[80:83], v[204:207]
    s_waitcnt lgkmcnt(10)
    v_mfma_f32_16x16x32_bf16 v[208:211], v[44:47], v[76:79], v[208:211]
    v_mfma_f32_16x16x32_bf16 v[212:215], v[44:47], v[80:83], v[212:215]
    s_waitcnt lgkmcnt(8)
    v_mfma_f32_16x16x32_bf16 v[216:219], v[48:51], v[76:79], v[216:219]
    v_mfma_f32_16x16x32_bf16 v[220:223], v[48:51], v[80:83], v[220:223]
    s_waitcnt vmcnt(10) lgkmcnt(0)
    s_barrier
    v_mfma_f32_16x16x32_bf16 v[224:227], v[16:19], v[76:79], v[224:227]
    ds_read_b64_tr_b16 v[32:33], v150 offset:0
    ds_read_b64_tr_b16 v[34:35], v150 offset:5120
    ds_read_b64_tr_b16 v[36:37], v151 offset:32
    ds_read_b64_tr_b16 v[38:39], v151 offset:5152
    v_mfma_f32_16x16x32_bf16 v[228:231], v[16:19], v[80:83], v[228:231]
    s_add_u32 s31, s38, 163840
    s_add_u32 m0, s29, 40960
    s_nop 0
    buffer_load_dwordx4 v1, s[16:19], s31 offen lds
    v_mfma_f32_16x16x32_bf16 v[232:235], v[20:23], v[76:79], v[232:235]
    ds_read_b64_tr_b16 v[40:41], v150 offset:64
    ds_read_b64_tr_b16 v[42:43], v150 offset:5184
    ds_read_b64_tr_b16 v[44:45], v151 offset:96
    ds_read_b64_tr_b16 v[46:47], v151 offset:5216
    v_mfma_f32_16x16x32_bf16 v[236:239], v[20:23], v[80:83], v[236:239]
    s_add_u32 m0, s29, 41984
    s_nop 0
    buffer_load_dwordx4 v2, s[16:19], s31 offen lds
    v_mfma_f32_16x16x32_bf16 v[240:243], v[24:27], v[76:79], v[240:243]
    ds_read_b64_tr_b16 v[48:49], v150 offset:128
    ds_read_b64_tr_b16 v[50:51], v150 offset:5248
    ds_read_b64_tr_b16 v[16:17], v151 offset:160
    ds_read_b64_tr_b16 v[18:19], v151 offset:5280
    v_mfma_f32_16x16x32_bf16 v[244:247], v[24:27], v[80:83], v[244:247]
    s_add_u32 m0, s29, 43008
    s_nop 0
    buffer_load_dwordx4 v3, s[16:19], s31 offen lds
    v_mfma_f32_16x16x32_bf16 v[248:251], v[28:31], v[76:79], v[248:251]
    ds_read_b64_tr_b16 v[20:21], v150 offset:192
    ds_read_b64_tr_b16 v[22:23], v150 offset:5312
    s_add_u32 m0, s29, 44032
    v_mfma_f32_16x16x32_bf16 v[252:255], v[28:31], v[80:83], v[252:255]
    s_nop 0
    buffer_load_dwordx4 v4, s[16:19], s31 offen lds
    s_waitcnt lgkmcnt(12)
    v_mfma_f32_16x16x32_bf16 v[176:179], v[32:35], v[84:87], v[176:179]
    ds_read_b64_tr_b16 v[24:25], v151 offset:224
    ds_read_b64_tr_b16 v[26:27], v151 offset:5344
    s_add_u32 m0, s29, 45056
    v_mfma_f32_16x16x32_bf16 v[180:183], v[32:35], v[88:91], v[180:183]
    s_nop 0
    buffer_load_dwordx4 v5, s[16:19], s31 offen lds
    s_waitcnt lgkmcnt(12)
    v_mfma_f32_16x16x32_bf16 v[184:187], v[36:39], v[84:87], v[184:187]
    ds_read_b64_tr_b16 v[28:29], v150 offset:256
    v_mfma_f32_16x16x32_bf16 v[188:191], v[36:39], v[88:91], v[188:191]
    ds_read_b64_tr_b16 v[30:31], v150 offset:5376
    s_waitcnt lgkmcnt(12)
    v_mfma_f32_16x16x32_bf16 v[192:195], v[40:43], v[84:87], v[192:195]
    ds_read_b64_tr_b16 v[32:33], v151 offset:288
    v_mfma_f32_16x16x32_bf16 v[196:199], v[40:43], v[88:91], v[196:199]
    ds_read_b64_tr_b16 v[34:35], v151 offset:5408
    s_waitcnt lgkmcnt(12)
    v_mfma_f32_16x16x32_bf16 v[200:203], v[44:47], v[84:87], v[200:203]
    ds_read_b64_tr_b16 v[36:37], v150 offset:10240
    v_mfma_f32_16x16x32_bf16 v[204:207], v[44:47], v[88:91], v[204:207]
    ds_read_b64_tr_b16 v[38:39], v150 offset:15360
    s_waitcnt lgkmcnt(12)
    v_mfma_f32_16x16x32_bf16 v[208:211], v[48:51], v[84:87], v[208:211]
    ds_read_b64_tr_b16 v[40:41], v151 offset:10272
    v_mfma_f32_16x16x32_bf16 v[212:215], v[48:51], v[88:91], v[212:215]
    ds_read_b64_tr_b16 v[42:43], v151 offset:15392
    s_waitcnt lgkmcnt(12)
    v_mfma_f32_16x16x32_bf16 v[216:219], v[16:19], v[84:87], v[216:219]
    ds_read_b64_tr_b16 v[44:45], v150 offset:10304
    v_mfma_f32_16x16x32_bf16 v[220:223], v[16:19], v[88:91], v[220:223]
    ds_read_b64_tr_b16 v[46:47], v150 offset:15424
    s_waitcnt lgkmcnt(12)
    v_mfma_f32_16x16x32_bf16 v[224:227], v[20:23], v[84:87], v[224:227]
    ds_read_b64_tr_b16 v[48:49], v151 offset:10336
    v_mfma_f32_16x16x32_bf16 v[228:231], v[20:23], v[88:91], v[228:231]
    ds_read_b64_tr_b16 v[50:51], v151 offset:15456
    s_waitcnt lgkmcnt(12)
    v_mfma_f32_16x16x32_bf16 v[232:235], v[24:27], v[84:87], v[232:235]
    ds_read_b64_tr_b16 v[16:17], v150 offset:10368
    v_mfma_f32_16x16x32_bf16 v[236:239], v[24:27], v[88:91], v[236:239]
    ds_read_b64_tr_b16 v[18:19], v150 offset:15488
    s_waitcnt lgkmcnt(12)
    v_mfma_f32_16x16x32_bf16 v[240:243], v[28:31], v[84:87], v[240:243]
    ds_read_b64_tr_b16 v[20:21], v151 offset:10400
    v_mfma_f32_16x16x32_bf16 v[244:247], v[28:31], v[88:91], v[244:247]
    ds_read_b64_tr_b16 v[22:23], v151 offset:15520
    s_waitcnt lgkmcnt(12)
    v_mfma_f32_16x16x32_bf16 v[248:251], v[32:35], v[84:87], v[248:251]
    ds_read_b64_tr_b16 v[24:25], v150 offset:10432
    v_mfma_f32_16x16x32_bf16 v[252:255], v[32:35], v[88:91], v[252:255]
    ds_read_b64_tr_b16 v[26:27], v150 offset:15552
    s_waitcnt lgkmcnt(12)
    v_mfma_f32_16x16x32_bf16 v[176:179], v[36:39], v[92:95], v[176:179]
    ds_read_b64_tr_b16 v[28:29], v151 offset:10464
    v_mfma_f32_16x16x32_bf16 v[180:183], v[36:39], v[96:99], v[180:183]
    ds_read_b64_tr_b16 v[30:31], v151 offset:15584
    s_waitcnt lgkmcnt(12)
    v_mfma_f32_16x16x32_bf16 v[184:187], v[40:43], v[92:95], v[184:187]
    ds_read_b64_tr_b16 v[32:33], v150 offset:10496
    v_mfma_f32_16x16x32_bf16 v[188:191], v[40:43], v[96:99], v[188:191]
    ds_read_b64_tr_b16 v[34:35], v150 offset:15616
    s_waitcnt lgkmcnt(12)
    v_mfma_f32_16x16x32_bf16 v[192:195], v[44:47], v[92:95], v[192:195]
    ds_read_b64_tr_b16 v[36:37], v151 offset:10528
    v_mfma_f32_16x16x32_bf16 v[196:199], v[44:47], v[96:99], v[196:199]
    ds_read_b64_tr_b16 v[38:39], v151 offset:15648
    s_waitcnt lgkmcnt(12)
    v_mfma_f32_16x16x32_bf16 v[200:203], v[48:51], v[92:95], v[200:203]
    v_mfma_f32_16x16x32_bf16 v[204:207], v[48:51], v[96:99], v[204:207]
    s_waitcnt lgkmcnt(10)
    v_mfma_f32_16x16x32_bf16 v[208:211], v[16:19], v[92:95], v[208:211]
    v_mfma_f32_16x16x32_bf16 v[212:215], v[16:19], v[96:99], v[212:215]
    s_waitcnt lgkmcnt(8)
    v_mfma_f32_16x16x32_bf16 v[216:219], v[20:23], v[92:95], v[216:219]
    v_mfma_f32_16x16x32_bf16 v[220:223], v[20:23], v[96:99], v[220:223]
    s_waitcnt vmcnt(10) lgkmcnt(0)
    s_barrier
    v_mfma_f32_16x16x32_bf16 v[224:227], v[24:27], v[92:95], v[224:227]
    ds_read_b64_tr_b16 v[40:41], v150 offset:40960
    ds_read_b64_tr_b16 v[42:43], v150 offset:46080
    ds_read_b64_tr_b16 v[44:45], v151 offset:40992
    ds_read_b64_tr_b16 v[46:47], v151 offset:46112
    v_mfma_f32_16x16x32_bf16 v[228:231], v[24:27], v[96:99], v[228:231]
    s_add_u32 s31, s37, 320
    s_add_u32 m0, s29, 81920
    s_nop 0
    buffer_load_dwordx4 v1, s[16:19], s31 offen lds
    v_mfma_f32_16x16x32_bf16 v[232:235], v[28:31], v[92:95], v[232:235]
    ds_read_b64_tr_b16 v[48:49], v150 offset:41024
    ds_read_b64_tr_b16 v[50:51], v150 offset:46144
    ds_read_b64_tr_b16 v[16:17], v151 offset:41056
    ds_read_b64_tr_b16 v[18:19], v151 offset:46176
    v_mfma_f32_16x16x32_bf16 v[236:239], v[28:31], v[96:99], v[236:239]
    s_add_u32 m0, s29, 82944
    s_nop 0
    buffer_load_dwordx4 v2, s[16:19], s31 offen lds
    v_mfma_f32_16x16x32_bf16 v[240:243], v[32:35], v[92:95], v[240:243]
    ds_read_b64_tr_b16 v[20:21], v150 offset:41088
    ds_read_b64_tr_b16 v[22:23], v150 offset:46208
    ds_read_b64_tr_b16 v[24:25], v151 offset:41120
    ds_read_b64_tr_b16 v[26:27], v151 offset:46240
    v_mfma_f32_16x16x32_bf16 v[244:247], v[32:35], v[96:99], v[244:247]
    s_add_u32 m0, s29, 83968
    s_nop 0
    buffer_load_dwordx4 v3, s[16:19], s31 offen lds
    v_mfma_f32_16x16x32_bf16 v[248:251], v[36:39], v[92:95], v[248:251]
    ds_read_b64_tr_b16 v[28:29], v150 offset:41152
    ds_read_b64_tr_b16 v[30:31], v150 offset:46272
    s_add_u32 m0, s29, 84992
    v_mfma_f32_16x16x32_bf16 v[252:255], v[36:39], v[96:99], v[252:255]
    s_nop 0
    buffer_load_dwordx4 v4, s[16:19], s31 offen lds
    s_waitcnt lgkmcnt(12)
    v_mfma_f32_16x16x32_bf16 v[176:179], v[40:43], v[100:103], v[176:179]
    ds_read_b64_tr_b16 v[32:33], v151 offset:41184
    ds_read_b64_tr_b16 v[34:35], v151 offset:46304
    s_add_u32 m0, s29, 86016
    v_mfma_f32_16x16x32_bf16 v[180:183], v[40:43], v[104:107], v[180:183]
    s_nop 0
    buffer_load_dwordx4 v5, s[16:19], s31 offen lds
    s_waitcnt lgkmcnt(12)
    v_mfma_f32_16x16x32_bf16 v[184:187], v[44:47], v[100:103], v[184:187]
    ds_read_b64_tr_b16 v[36:37], v150 offset:41216
    v_mfma_f32_16x16x32_bf16 v[188:191], v[44:47], v[104:107], v[188:191]
    ds_read_b64_tr_b16 v[38:39], v150 offset:46336
    s_waitcnt lgkmcnt(12)
    v_mfma_f32_16x16x32_bf16 v[192:195], v[48:51], v[100:103], v[192:195]
    ds_read_b64_tr_b16 v[40:41], v151 offset:41248
    v_mfma_f32_16x16x32_bf16 v[196:199], v[48:51], v[104:107], v[196:199]
    ds_read_b64_tr_b16 v[42:43], v151 offset:46368
    s_waitcnt lgkmcnt(12)
    v_mfma_f32_16x16x32_bf16 v[200:203], v[16:19], v[100:103], v[200:203]
    ds_read_b64_tr_b16 v[44:45], v150 offset:51200
    v_mfma_f32_16x16x32_bf16 v[204:207], v[16:19], v[104:107], v[204:207]
    ds_read_b64_tr_b16 v[46:47], v150 offset:56320
    s_waitcnt lgkmcnt(12)
    v_mfma_f32_16x16x32_bf16 v[208:211], v[20:23], v[100:103], v[208:211]
    ds_read_b64_tr_b16 v[48:49], v151 offset:51232
    v_mfma_f32_16x16x32_bf16 v[212:215], v[20:23], v[104:107], v[212:215]
    ds_read_b64_tr_b16 v[50:51], v151 offset:56352
    s_waitcnt lgkmcnt(12)
    v_mfma_f32_16x16x32_bf16 v[216:219], v[24:27], v[100:103], v[216:219]
    ds_read_b64_tr_b16 v[16:17], v150 offset:51264
    v_mfma_f32_16x16x32_bf16 v[220:223], v[24:27], v[104:107], v[220:223]
    ds_read_b64_tr_b16 v[18:19], v150 offset:56384
    s_waitcnt lgkmcnt(12)
    v_mfma_f32_16x16x32_bf16 v[224:227], v[28:31], v[100:103], v[224:227]
    ds_read_b64_tr_b16 v[20:21], v151 offset:51296
    v_mfma_f32_16x16x32_bf16 v[228:231], v[28:31], v[104:107], v[228:231]
    ds_read_b64_tr_b16 v[22:23], v151 offset:56416
    s_waitcnt lgkmcnt(12)
    v_mfma_f32_16x16x32_bf16 v[232:235], v[32:35], v[100:103], v[232:235]
    ds_read_b64_tr_b16 v[24:25], v150 offset:51328
    v_mfma_f32_16x16x32_bf16 v[236:239], v[32:35], v[104:107], v[236:239]
    ds_read_b64_tr_b16 v[26:27], v150 offset:56448
    s_waitcnt lgkmcnt(12)
    v_mfma_f32_16x16x32_bf16 v[240:243], v[36:39], v[100:103], v[240:243]
    ds_read_b64_tr_b16 v[28:29], v151 offset:51360
    v_mfma_f32_16x16x32_bf16 v[244:247], v[36:39], v[104:107], v[244:247]
    ds_read_b64_tr_b16 v[30:31], v151 offset:56480
    s_waitcnt lgkmcnt(12)
    v_mfma_f32_16x16x32_bf16 v[248:251], v[40:43], v[100:103], v[248:251]
    ds_read_b64_tr_b16 v[32:33], v150 offset:51392
    v_mfma_f32_16x16x32_bf16 v[252:255], v[40:43], v[104:107], v[252:255]
    ds_read_b64_tr_b16 v[34:35], v150 offset:56512
    s_waitcnt lgkmcnt(12)
    v_mfma_f32_16x16x32_bf16 v[176:179], v[44:47], v[108:111], v[176:179]
    ds_read_b64_tr_b16 v[36:37], v151 offset:51424
    v_mfma_f32_16x16x32_bf16 v[180:183], v[44:47], v[112:115], v[180:183]
    ds_read_b64_tr_b16 v[38:39], v151 offset:56544
    s_waitcnt lgkmcnt(12)
    v_mfma_f32_16x16x32_bf16 v[184:187], v[48:51], v[108:111], v[184:187]
    ds_read_b64_tr_b16 v[40:41], v150 offset:51456
    v_mfma_f32_16x16x32_bf16 v[188:191], v[48:51], v[112:115], v[188:191]
    ds_read_b64_tr_b16 v[42:43], v150 offset:56576
    s_waitcnt lgkmcnt(12)
    v_mfma_f32_16x16x32_bf16 v[192:195], v[16:19], v[108:111], v[192:195]
    ds_read_b64_tr_b16 v[44:45], v151 offset:51488
    v_mfma_f32_16x16x32_bf16 v[196:199], v[16:19], v[112:115], v[196:199]
    ds_read_b64_tr_b16 v[46:47], v151 offset:56608
    s_waitcnt lgkmcnt(12)
    v_mfma_f32_16x16x32_bf16 v[200:203], v[20:23], v[108:111], v[200:203]
    v_mfma_f32_16x16x32_bf16 v[204:207], v[20:23], v[112:115], v[204:207]
    s_waitcnt lgkmcnt(10)
    v_mfma_f32_16x16x32_bf16 v[208:211], v[24:27], v[108:111], v[208:211]
    v_mfma_f32_16x16x32_bf16 v[212:215], v[24:27], v[112:115], v[212:215]
    s_waitcnt lgkmcnt(8)
    v_mfma_f32_16x16x32_bf16 v[216:219], v[28:31], v[108:111], v[216:219]
    v_mfma_f32_16x16x32_bf16 v[220:223], v[28:31], v[112:115], v[220:223]
    s_waitcnt vmcnt(10) lgkmcnt(0)
    s_barrier
    v_mfma_f32_16x16x32_bf16 v[224:227], v[32:35], v[108:111], v[224:227]
    ds_read_b64_tr_b16 v[48:49], v148 offset:0
    ds_read_b64_tr_b16 v[50:51], v148 offset:5120
    ds_read_b64_tr_b16 v[16:17], v149 offset:32
    ds_read_b64_tr_b16 v[18:19], v149 offset:5152
    v_mfma_f32_16x16x32_bf16 v[228:231], v[32:35], v[112:115], v[228:231]
    s_add_u32 s31, s37, 82240
    s_add_u32 m0, s29, 122880
    s_nop 0
    buffer_load_dwordx4 v1, s[16:19], s31 offen lds
    v_mfma_f32_16x16x32_bf16 v[232:235], v[36:39], v[108:111], v[232:235]
    ds_read_b64_tr_b16 v[20:21], v148 offset:64
    ds_read_b64_tr_b16 v[22:23], v148 offset:5184
    ds_read_b64_tr_b16 v[24:25], v149 offset:96
    ds_read_b64_tr_b16 v[26:27], v149 offset:5216
    v_mfma_f32_16x16x32_bf16 v[236:239], v[36:39], v[112:115], v[236:239]
    s_add_u32 m0, s29, 123904
    s_nop 0
    buffer_load_dwordx4 v2, s[16:19], s31 offen lds
    v_mfma_f32_16x16x32_bf16 v[240:243], v[40:43], v[108:111], v[240:243]
    ds_read_b64_tr_b16 v[28:29], v148 offset:128
    ds_read_b64_tr_b16 v[30:31], v148 offset:5248
    ds_read_b64_tr_b16 v[32:33], v149 offset:160
    ds_read_b64_tr_b16 v[34:35], v149 offset:5280
    v_mfma_f32_16x16x32_bf16 v[244:247], v[40:43], v[112:115], v[244:247]
    s_add_u32 m0, s29, 124928
    s_nop 0
    buffer_load_dwordx4 v3, s[16:19], s31 offen lds
    v_mfma_f32_16x16x32_bf16 v[248:251], v[44:47], v[108:111], v[248:251]
    ds_read_b64_tr_b16 v[36:37], v148 offset:192
    ds_read_b64_tr_b16 v[38:39], v148 offset:5312
    s_add_u32 m0, s29, 125952
    v_mfma_f32_16x16x32_bf16 v[252:255], v[44:47], v[112:115], v[252:255]
    s_nop 0
    buffer_load_dwordx4 v4, s[16:19], s31 offen lds
    s_waitcnt lgkmcnt(12)
    v_mfma_f32_16x16x32_bf16 v[176:179], v[48:51], v[116:119], v[176:179]
    ds_read_b64_tr_b16 v[40:41], v149 offset:224
    ds_read_b64_tr_b16 v[42:43], v149 offset:5344
    s_add_u32 m0, s29, 126976
    v_mfma_f32_16x16x32_bf16 v[180:183], v[48:51], v[120:123], v[180:183]
    s_nop 0
    buffer_load_dwordx4 v5, s[16:19], s31 offen lds
    s_waitcnt lgkmcnt(12)
    v_mfma_f32_16x16x32_bf16 v[184:187], v[16:19], v[116:119], v[184:187]
    ds_read_b64_tr_b16 v[44:45], v148 offset:256
    v_mfma_f32_16x16x32_bf16 v[188:191], v[16:19], v[120:123], v[188:191]
    ds_read_b64_tr_b16 v[46:47], v148 offset:5376
    s_waitcnt lgkmcnt(12)
    v_mfma_f32_16x16x32_bf16 v[192:195], v[20:23], v[116:119], v[192:195]
    ds_read_b64_tr_b16 v[48:49], v149 offset:288
    v_mfma_f32_16x16x32_bf16 v[196:199], v[20:23], v[120:123], v[196:199]
    ds_read_b64_tr_b16 v[50:51], v149 offset:5408
    s_waitcnt lgkmcnt(12)
    v_mfma_f32_16x16x32_bf16 v[200:203], v[24:27], v[116:119], v[200:203]
    ds_read_b64_tr_b16 v[16:17], v148 offset:10240
    v_mfma_f32_16x16x32_bf16 v[204:207], v[24:27], v[120:123], v[204:207]
    ds_read_b64_tr_b16 v[18:19], v148 offset:15360
    s_waitcnt lgkmcnt(12)
    v_mfma_f32_16x16x32_bf16 v[208:211], v[28:31], v[116:119], v[208:211]
    ds_read_b64_tr_b16 v[20:21], v149 offset:10272
    v_mfma_f32_16x16x32_bf16 v[212:215], v[28:31], v[120:123], v[212:215]
    ds_read_b64_tr_b16 v[22:23], v149 offset:15392
    s_waitcnt lgkmcnt(12)
    v_mfma_f32_16x16x32_bf16 v[216:219], v[32:35], v[116:119], v[216:219]
    ds_read_b64_tr_b16 v[24:25], v148 offset:10304
    v_mfma_f32_16x16x32_bf16 v[220:223], v[32:35], v[120:123], v[220:223]
    ds_read_b64_tr_b16 v[26:27], v148 offset:15424
    s_waitcnt lgkmcnt(12)
    v_mfma_f32_16x16x32_bf16 v[224:227], v[36:39], v[116:119], v[224:227]
    ds_read_b64_tr_b16 v[28:29], v149 offset:10336
    v_mfma_f32_16x16x32_bf16 v[228:231], v[36:39], v[120:123], v[228:231]
    ds_read_b64_tr_b16 v[30:31], v149 offset:15456
    s_waitcnt lgkmcnt(12)
    v_mfma_f32_16x16x32_bf16 v[232:235], v[40:43], v[116:119], v[232:235]
    ds_read_b64_tr_b16 v[32:33], v148 offset:10368
    v_mfma_f32_16x16x32_bf16 v[236:239], v[40:43], v[120:123], v[236:239]
    ds_read_b64_tr_b16 v[34:35], v148 offset:15488
    s_waitcnt lgkmcnt(12)
    v_mfma_f32_16x16x32_bf16 v[240:243], v[44:47], v[116:119], v[240:243]
    ds_read_b64_tr_b16 v[36:37], v149 offset:10400
    v_mfma_f32_16x16x32_bf16 v[244:247], v[44:47], v[120:123], v[244:247]
    ds_read_b64_tr_b16 v[38:39], v149 offset:15520
    s_waitcnt lgkmcnt(12)
    v_mfma_f32_16x16x32_bf16 v[248:251], v[48:51], v[116:119], v[248:251]
    ds_read_b64_tr_b16 v[40:41], v148 offset:10432
    v_mfma_f32_16x16x32_bf16 v[252:255], v[48:51], v[120:123], v[252:255]
    ds_read_b64_tr_b16 v[42:43], v148 offset:15552
    s_waitcnt lgkmcnt(12)
    v_mfma_f32_16x16x32_bf16 v[176:179], v[16:19], v[124:127], v[176:179]
    ds_read_b64_tr_b16 v[44:45], v149 offset:10464
    v_mfma_f32_16x16x32_bf16 v[180:183], v[16:19], v[128:131], v[180:183]
    ds_read_b64_tr_b16 v[46:47], v149 offset:15584
    s_waitcnt lgkmcnt(12)
    v_mfma_f32_16x16x32_bf16 v[184:187], v[20:23], v[124:127], v[184:187]
    ds_read_b64_tr_b16 v[48:49], v148 offset:10496
    v_mfma_f32_16x16x32_bf16 v[188:191], v[20:23], v[128:131], v[188:191]
    ds_read_b64_tr_b16 v[50:51], v148 offset:15616
    s_waitcnt lgkmcnt(12)
    v_mfma_f32_16x16x32_bf16 v[192:195], v[24:27], v[124:127], v[192:195]
    ds_read_b64_tr_b16 v[16:17], v149 offset:10528
    v_mfma_f32_16x16x32_bf16 v[196:199], v[24:27], v[128:131], v[196:199]
    ds_read_b64_tr_b16 v[18:19], v149 offset:15648
    s_waitcnt lgkmcnt(12)
    v_mfma_f32_16x16x32_bf16 v[200:203], v[28:31], v[124:127], v[200:203]
    v_mfma_f32_16x16x32_bf16 v[204:207], v[28:31], v[128:131], v[204:207]
    s_waitcnt lgkmcnt(10)
    v_mfma_f32_16x16x32_bf16 v[208:211], v[32:35], v[124:127], v[208:211]
    v_mfma_f32_16x16x32_bf16 v[212:215], v[32:35], v[128:131], v[212:215]
    s_waitcnt lgkmcnt(8)
    v_mfma_f32_16x16x32_bf16 v[216:219], v[36:39], v[124:127], v[216:219]
    v_mfma_f32_16x16x32_bf16 v[220:223], v[36:39], v[128:131], v[220:223]
    s_waitcnt vmcnt(10) lgkmcnt(0)
    s_barrier
    v_mfma_f32_16x16x32_bf16 v[224:227], v[40:43], v[124:127], v[224:227]
    ds_read_b64_tr_b16 v[20:21], v148 offset:40960
    ds_read_b64_tr_b16 v[22:23], v148 offset:46080
    ds_read_b64_tr_b16 v[24:25], v149 offset:40992
    ds_read_b64_tr_b16 v[26:27], v149 offset:46112
    v_mfma_f32_16x16x32_bf16 v[228:231], v[40:43], v[128:131], v[228:231]
    s_add_u32 s31, s37, 164160
    s_add_u32 m0, s29, 0
    s_nop 0
    buffer_load_dwordx4 v1, s[16:19], s31 offen lds
    v_mfma_f32_16x16x32_bf16 v[232:235], v[44:47], v[124:127], v[232:235]
    ds_read_b64_tr_b16 v[28:29], v148 offset:41024
    ds_read_b64_tr_b16 v[30:31], v148 offset:46144
    ds_read_b64_tr_b16 v[32:33], v149 offset:41056
    ds_read_b64_tr_b16 v[34:35], v149 offset:46176
    v_mfma_f32_16x16x32_bf16 v[236:239], v[44:47], v[128:131], v[236:239]
    s_add_u32 m0, s29, 1024
    s_nop 0
    buffer_load_dwordx4 v2, s[16:19], s31 offen lds
    v_mfma_f32_16x16x32_bf16 v[240:243], v[48:51], v[124:127], v[240:243]
    ds_read_b64_tr_b16 v[36:37], v148 offset:41088
    ds_read_b64_tr_b16 v[38:39], v148 offset:46208
    ds_read_b64_tr_b16 v[40:41], v149 offset:41120
    ds_read_b64_tr_b16 v[42:43], v149 offset:46240
    v_mfma_f32_16x16x32_bf16 v[244:247], v[48:51], v[128:131], v[244:247]
    s_add_u32 m0, s29, 2048
    s_nop 0
    buffer_load_dwordx4 v3, s[16:19], s31 offen lds
    v_mfma_f32_16x16x32_bf16 v[248:251], v[16:19], v[124:127], v[248:251]
    ds_read_b64_tr_b16 v[44:45], v148 offset:41152
    ds_read_b64_tr_b16 v[46:47], v148 offset:46272
    s_add_u32 m0, s29, 3072
    v_mfma_f32_16x16x32_bf16 v[252:255], v[16:19], v[128:131], v[252:255]
    s_nop 0
    buffer_load_dwordx4 v4, s[16:19], s31 offen lds
    s_waitcnt lgkmcnt(12)
    v_mfma_f32_16x16x32_bf16 v[176:179], v[20:23], v[132:135], v[176:179]
    ds_read_b64_tr_b16 v[48:49], v149 offset:41184
    ds_read_b64_tr_b16 v[50:51], v149 offset:46304
    s_add_u32 m0, s29, 4096
    v_mfma_f32_16x16x32_bf16 v[180:183], v[20:23], v[136:139], v[180:183]
    s_nop 0
    buffer_load_dwordx4 v5, s[16:19], s31 offen lds
    s_waitcnt lgkmcnt(12)
    v_mfma_f32_16x16x32_bf16 v[184:187], v[24:27], v[132:135], v[184:187]
    ds_read_b64_tr_b16 v[16:17], v148 offset:41216
    v_mfma_f32_16x16x32_bf16 v[188:191], v[24:27], v[136:139], v[188:191]
    ds_read_b64_tr_b16 v[18:19], v148 offset:46336
    s_waitcnt lgkmcnt(12)
    v_mfma_f32_16x16x32_bf16 v[192:195], v[28:31], v[132:135], v[192:195]
    ds_read_b64_tr_b16 v[20:21], v149 offset:41248
    v_mfma_f32_16x16x32_bf16 v[196:199], v[28:31], v[136:139], v[196:199]
    ds_read_b64_tr_b16 v[22:23], v149 offset:46368
    s_waitcnt lgkmcnt(12)
    v_mfma_f32_16x16x32_bf16 v[200:203], v[32:35], v[132:135], v[200:203]
    ds_read_b64_tr_b16 v[24:25], v148 offset:51200
    v_mfma_f32_16x16x32_bf16 v[204:207], v[32:35], v[136:139], v[204:207]
    ds_read_b64_tr_b16 v[26:27], v148 offset:56320
    s_waitcnt lgkmcnt(12)
    v_mfma_f32_16x16x32_bf16 v[208:211], v[36:39], v[132:135], v[208:211]
    ds_read_b64_tr_b16 v[28:29], v149 offset:51232
    v_mfma_f32_16x16x32_bf16 v[212:215], v[36:39], v[136:139], v[212:215]
    ds_read_b64_tr_b16 v[30:31], v149 offset:56352
    s_waitcnt lgkmcnt(12)
    v_mfma_f32_16x16x32_bf16 v[216:219], v[40:43], v[132:135], v[216:219]
    ds_read_b64_tr_b16 v[32:33], v148 offset:51264
    v_mfma_f32_16x16x32_bf16 v[220:223], v[40:43], v[136:139], v[220:223]
    ds_read_b64_tr_b16 v[34:35], v148 offset:56384
    s_waitcnt lgkmcnt(12)
    v_mfma_f32_16x16x32_bf16 v[224:227], v[44:47], v[132:135], v[224:227]
    ds_read_b64_tr_b16 v[36:37], v149 offset:51296
    v_mfma_f32_16x16x32_bf16 v[228:231], v[44:47], v[136:139], v[228:231]
    ds_read_b64_tr_b16 v[38:39], v149 offset:56416
    s_waitcnt lgkmcnt(12)
    v_mfma_f32_16x16x32_bf16 v[232:235], v[48:51], v[132:135], v[232:235]
    ds_read_b64_tr_b16 v[40:41], v148 offset:51328
    v_mfma_f32_16x16x32_bf16 v[236:239], v[48:51], v[136:139], v[236:239]
    ds_read_b64_tr_b16 v[42:43], v148 offset:56448
    s_waitcnt lgkmcnt(12)
    v_mfma_f32_16x16x32_bf16 v[240:243], v[16:19], v[132:135], v[240:243]
    ds_read_b64_tr_b16 v[44:45], v149 offset:51360
    v_mfma_f32_16x16x32_bf16 v[244:247], v[16:19], v[136:139], v[244:247]
    ds_read_b64_tr_b16 v[46:47], v149 offset:56480
    s_waitcnt lgkmcnt(12)
    v_mfma_f32_16x16x32_bf16 v[248:251], v[20:23], v[132:135], v[248:251]
    ds_read_b64_tr_b16 v[48:49], v148 offset:51392
    v_mfma_f32_16x16x32_bf16 v[252:255], v[20:23], v[136:139], v[252:255]
    ds_read_b64_tr_b16 v[50:51], v148 offset:56512
    s_waitcnt lgkmcnt(12)
    v_mfma_f32_16x16x32_bf16 v[176:179], v[24:27], v[140:143], v[176:179]
    ds_read_b64_tr_b16 v[16:17], v149 offset:51424
    v_mfma_f32_16x16x32_bf16 v[180:183], v[24:27], v[144:147], v[180:183]
    ds_read_b64_tr_b16 v[18:19], v149 offset:56544
    s_waitcnt lgkmcnt(12)
    v_mfma_f32_16x16x32_bf16 v[184:187], v[28:31], v[140:143], v[184:187]
    ds_read_b64_tr_b16 v[20:21], v148 offset:51456
    v_mfma_f32_16x16x32_bf16 v[188:191], v[28:31], v[144:147], v[188:191]
    ds_read_b64_tr_b16 v[22:23], v148 offset:56576
    s_waitcnt lgkmcnt(12)
    v_mfma_f32_16x16x32_bf16 v[192:195], v[32:35], v[140:143], v[192:195]
    ds_read_b64_tr_b16 v[24:25], v149 offset:51488
    v_mfma_f32_16x16x32_bf16 v[196:199], v[32:35], v[144:147], v[196:199]
    ds_read_b64_tr_b16 v[26:27], v149 offset:56608
    s_waitcnt lgkmcnt(12)
    v_mfma_f32_16x16x32_bf16 v[200:203], v[36:39], v[140:143], v[200:203]
    v_mfma_f32_16x16x32_bf16 v[204:207], v[36:39], v[144:147], v[204:207]
    s_waitcnt lgkmcnt(10)
    v_mfma_f32_16x16x32_bf16 v[208:211], v[40:43], v[140:143], v[208:211]
    v_mfma_f32_16x16x32_bf16 v[212:215], v[40:43], v[144:147], v[212:215]
    s_waitcnt lgkmcnt(8)
    v_mfma_f32_16x16x32_bf16 v[216:219], v[44:47], v[140:143], v[216:219]
    v_mfma_f32_16x16x32_bf16 v[220:223], v[44:47], v[144:147], v[220:223]
    s_waitcnt vmcnt(10) lgkmcnt(0)
    s_barrier
    v_mfma_f32_16x16x32_bf16 v[224:227], v[48:51], v[140:143], v[224:227]
    ds_read_b64_tr_b16 v[28:29], v150 offset:0
    ds_read_b64_tr_b16 v[30:31], v150 offset:5120
    ds_read_b64_tr_b16 v[32:33], v151 offset:32
    ds_read_b64_tr_b16 v[34:35], v151 offset:5152
    v_mfma_f32_16x16x32_bf16 v[228:231], v[48:51], v[144:147], v[228:231]
    s_add_u32 s31, s38, 320
    s_add_u32 m0, s29, 40960
    s_nop 0
    buffer_load_dwordx4 v1, s[16:19], s31 offen lds
    v_mfma_f32_16x16x32_bf16 v[232:235], v[16:19], v[140:143], v[232:235]
    ds_read_b64_tr_b16 v[36:37], v150 offset:64
    ds_read_b64_tr_b16 v[38:39], v150 offset:5184
    ds_read_b64_tr_b16 v[40:41], v151 offset:96
    ds_read_b64_tr_b16 v[42:43], v151 offset:5216
    v_mfma_f32_16x16x32_bf16 v[236:239], v[16:19], v[144:147], v[236:239]
    s_add_u32 m0, s29, 41984
    s_nop 0
    buffer_load_dwordx4 v2, s[16:19], s31 offen lds
    v_mfma_f32_16x16x32_bf16 v[240:243], v[20:23], v[140:143], v[240:243]
    ds_read_b64_tr_b16 v[44:45], v150 offset:128
    ds_read_b64_tr_b16 v[46:47], v150 offset:5248
    ds_read_b64_tr_b16 v[48:49], v151 offset:160
    ds_read_b64_tr_b16 v[50:51], v151 offset:5280
    v_mfma_f32_16x16x32_bf16 v[244:247], v[20:23], v[144:147], v[244:247]
    s_add_u32 m0, s29, 43008
    s_nop 0
    buffer_load_dwordx4 v3, s[16:19], s31 offen lds
    v_mfma_f32_16x16x32_bf16 v[248:251], v[24:27], v[140:143], v[248:251]
    ds_read_b64_tr_b16 v[16:17], v150 offset:192
    ds_read_b64_tr_b16 v[18:19], v150 offset:5312
    s_add_u32 m0, s29, 44032
    s_nop 0
    v_mfma_f32_16x16x32_bf16 v[252:255], v[24:27], v[144:147], v[252:255]
    buffer_load_dwordx4 v4, s[16:19], s31 offen lds
    s_add_u32 m0, s29, 45056
    s_nop 0
    buffer_load_dwordx4 v5, s[16:19], s31 offen lds
    s_nop 7
    s_nop 7
    v_cvt_pk_bf16_f32 v152, v176, v177
    v_cvt_pk_bf16_f32 v153, v178, v179
    v_cvt_pk_bf16_f32 v154, v180, v181
    v_cvt_pk_bf16_f32 v155, v182, v183
    s_nop 1
    v_permlane16_swap_b32 v152, v154
    v_permlane16_swap_b32 v153, v155
    s_nop 1
    buffer_store_dwordx4 v[152:155], v10, s[24:27], s49 offen offset:0 sc0 sc1
    v_cvt_pk_bf16_f32 v156, v184, v185
    v_cvt_pk_bf16_f32 v157, v186, v187
    v_cvt_pk_bf16_f32 v158, v188, v189
    v_cvt_pk_bf16_f32 v159, v190, v191
    s_nop 1
    v_permlane16_swap_b32 v156, v158
    v_permlane16_swap_b32 v157, v159
    s_nop 1
    buffer_store_dwordx4 v[156:159], v10, s[24:27], s49 offen offset:1024 sc0 sc1
    v_cvt_pk_bf16_f32 v160, v192, v193
    v_cvt_pk_bf16_f32 v161, v194, v195
    v_cvt_pk_bf16_f32 v162, v196, v197
    v_cvt_pk_bf16_f32 v163, v198, v199
    s_nop 1
    v_permlane16_swap_b32 v160, v162
    v_permlane16_swap_b32 v161, v163
    s_nop 1
    buffer_store_dwordx4 v[160:163], v10, s[24:27], s49 offen offset:2048 sc0 sc1
    v_cvt_pk_bf16_f32 v164, v200, v201
    v_cvt_pk_bf16_f32 v165, v202, v203
    v_cvt_pk_bf16_f32 v166, v204, v205
    v_cvt_pk_bf16_f32 v167, v206, v207
    s_nop 1
    v_permlane16_swap_b32 v164, v166
    v_permlane16_swap_b32 v165, v167
    s_nop 1
    buffer_store_dwordx4 v[164:167], v10, s[24:27], s49 offen offset:3072 sc0 sc1
    v_cvt_pk_bf16_f32 v152, v208, v209
    v_cvt_pk_bf16_f32 v153, v210, v211
    v_cvt_pk_bf16_f32 v154, v212, v213
    v_cvt_pk_bf16_f32 v155, v214, v215
    s_nop 1
    v_permlane16_swap_b32 v152, v154
    v_permlane16_swap_b32 v153, v155
    s_nop 1
    s_add_u32 s49, s49, 4096
    buffer_store_dwordx4 v[152:155], v10, s[24:27], s49 offen offset:0 sc0 sc1
    v_cvt_pk_bf16_f32 v156, v216, v217
    v_cvt_pk_bf16_f32 v157, v218, v219
    v_cvt_pk_bf16_f32 v158, v220, v221
    v_cvt_pk_bf16_f32 v159, v222, v223
    s_nop 1
    v_permlane16_swap_b32 v156, v158
    v_permlane16_swap_b32 v157, v159
    s_nop 1
    buffer_store_dwordx4 v[156:159], v10, s[24:27], s49 offen offset:1024 sc0 sc1
    v_cvt_pk_bf16_f32 v160, v224, v225
    v_cvt_pk_bf16_f32 v161, v226, v227
    v_cvt_pk_bf16_f32 v162, v228, v229
    v_cvt_pk_bf16_f32 v163, v230, v231
    s_nop 1
    v_permlane16_swap_b32 v160, v162
    v_permlane16_swap_b32 v161, v163
    s_nop 1
    buffer_store_dwordx4 v[160:163], v10, s[24:27], s49 offen offset:2048 sc0 sc1
    v_cvt_pk_bf16_f32 v164, v232, v233
    v_cvt_pk_bf16_f32 v165, v234, v235
    v_cvt_pk_bf16_f32 v166, v236, v237
    v_cvt_pk_bf16_f32 v167, v238, v239
    s_nop 1
    v_permlane16_swap_b32 v164, v166
    v_permlane16_swap_b32 v165, v167
    s_nop 1
    buffer_store_dwordx4 v[164:167], v10, s[24:27], s49 offen offset:3072 sc0 sc1
    v_cvt_pk_bf16_f32 v152, v240, v241
    v_cvt_pk_bf16_f32 v153, v242, v243
    v_cvt_pk_bf16_f32 v154, v244, v245
    v_cvt_pk_bf16_f32 v155, v246, v247
    s_nop 1
    v_permlane16_swap_b32 v152, v154
    v_permlane16_swap_b32 v153, v155
    s_nop 1
    s_add_u32 s49, s49, 4096
    buffer_store_dwordx4 v[152:155], v10, s[24:27], s49 offen offset:0 sc0 sc1
    v_cvt_pk_bf16_f32 v156, v248, v249
    v_cvt_pk_bf16_f32 v157, v250, v251
    v_cvt_pk_bf16_f32 v158, v252, v253
    v_cvt_pk_bf16_f32 v159, v254, v255
    s_nop 1
    v_permlane16_swap_b32 v156, v158
    v_permlane16_swap_b32 v157, v159
    s_nop 1
    buffer_store_dwordx4 v[156:159], v10, s[24:27], s49 offen offset:1024 sc0 sc1
    s_waitcnt lgkmcnt(12)
    v_mfma_f32_16x16x32_bf16 v[176:179], v[28:31], v[52:55], 0
    ds_read_b64_tr_b16 v[20:21], v151 offset:224
    v_mfma_f32_16x16x32_bf16 v[180:183], v[28:31], v[56:59], 0
    ds_read_b64_tr_b16 v[22:23], v151 offset:5344
    s_waitcnt lgkmcnt(12)
    v_mfma_f32_16x16x32_bf16 v[184:187], v[32:35], v[52:55], 0
    ds_read_b64_tr_b16 v[24:25], v150 offset:256
    v_mfma_f32_16x16x32_bf16 v[188:191], v[32:35], v[56:59], 0
    ds_read_b64_tr_b16 v[26:27], v150 offset:5376
    s_waitcnt lgkmcnt(12)
    v_mfma_f32_16x16x32_bf16 v[192:195], v[36:39], v[52:55], 0
    ds_read_b64_tr_b16 v[28:29], v151 offset:288
    v_mfma_f32_16x16x32_bf16 v[196:199], v[36:39], v[56:59], 0
    ds_read_b64_tr_b16 v[30:31], v151 offset:5408
    s_waitcnt lgkmcnt(12)
    v_mfma_f32_16x16x32_bf16 v[200:203], v[40:43], v[52:55], 0
    ds_read_b64_tr_b16 v[32:33], v150 offset:10240
    v_mfma_f32_16x16x32_bf16 v[204:207], v[40:43], v[56:59], 0
    ds_read_b64_tr_b16 v[34:35], v150 offset:15360
    s_waitcnt lgkmcnt(12)
    v_mfma_f32_16x16x32_bf16 v[208:211], v[44:47], v[52:55], 0
    ds_read_b64_tr_b16 v[36:37], v151 offset:10272
    v_mfma_f32_16x16x32_bf16 v[212:215], v[44:47], v[56:59], 0
    ds_read_b64_tr_b16 v[38:39], v151 offset:15392
    s_waitcnt lgkmcnt(12)
    v_mfma_f32_16x16x32_bf16 v[216:219], v[48:51], v[52:55], 0
    ds_read_b64_tr_b16 v[40:41], v150 offset:10304
    v_mfma_f32_16x16x32_bf16 v[220:223], v[48:51], v[56:59], 0
    ds_read_b64_tr_b16 v[42:43], v150 offset:15424
    s_waitcnt lgkmcnt(12)
    v_mfma_f32_16x16x32_bf16 v[224:227], v[16:19], v[52:55], 0
    ds_read_b64_tr_b16 v[44:45], v151 offset:10336
    v_mfma_f32_16x16x32_bf16 v[228:231], v[16:19], v[56:59], 0
    ds_read_b64_tr_b16 v[46:47], v151 offset:15456
    s_waitcnt lgkmcnt(12)
    v_mfma_f32_16x16x32_bf16 v[232:235], v[20:23], v[52:55], 0
    ds_read_b64_tr_b16 v[48:49], v150 offset:10368
    v_mfma_f32_16x16x32_bf16 v[236:239], v[20:23], v[56:59], 0
    ds_read_b64_tr_b16 v[50:51], v150 offset:15488
    s_waitcnt lgkmcnt(12)
    v_mfma_f32_16x16x32_bf16 v[240:243], v[24:27], v[52:55], 0
    ds_read_b64_tr_b16 v[16:17], v151 offset:10400
    v_mfma_f32_16x16x32_bf16 v[244:247], v[24:27], v[56:59], 0
    ds_read_b64_tr_b16 v[18:19], v151 offset:15520
    s_waitcnt lgkmcnt(12)
    v_mfma_f32_16x16x32_bf16 v[248:251], v[28:31], v[52:55], 0
    ds_read_b64_tr_b16 v[20:21], v150 offset:10432
    v_mfma_f32_16x16x32_bf16 v[252:255], v[28:31], v[56:59], 0
    ds_read_b64_tr_b16 v[22:23], v150 offset:15552
    s_waitcnt lgkmcnt(12)
    v_mfma_f32_16x16x32_bf16 v[176:179], v[32:35], v[60:63], v[176:179]
    ds_read_b64_tr_b16 v[24:25], v151 offset:10464
    v_mfma_f32_16x16x32_bf16 v[180:183], v[32:35], v[64:67], v[180:183]
    ds_read_b64_tr_b16 v[26:27], v151 offset:15584
    s_waitcnt lgkmcnt(12)
    v_mfma_f32_16x16x32_bf16 v[184:187], v[36:39], v[60:63], v[184:187]
    ds_read_b64_tr_b16 v[28:29], v150 offset:10496
    v_mfma_f32_16x16x32_bf16 v[188:191], v[36:39], v[64:67], v[188:191]
    ds_read_b64_tr_b16 v[30:31], v150 offset:15616
    s_waitcnt lgkmcnt(12)
    v_mfma_f32_16x16x32_bf16 v[192:195], v[40:43], v[60:63], v[192:195]
    ds_read_b64_tr_b16 v[32:33], v151 offset:10528
    v_mfma_f32_16x16x32_bf16 v[196:199], v[40:43], v[64:67], v[196:199]
    ds_read_b64_tr_b16 v[34:35], v151 offset:15648
    s_waitcnt lgkmcnt(12)
    v_mfma_f32_16x16x32_bf16 v[200:203], v[44:47], v[60:63], v[200:203]
    v_mfma_f32_16x16x32_bf16 v[204:207], v[44:47], v[64:67], v[204:207]
    s_waitcnt lgkmcnt(10)
    v_mfma_f32_16x16x32_bf16 v[208:211], v[48:51], v[60:63], v[208:211]
    v_mfma_f32_16x16x32_bf16 v[212:215], v[48:51], v[64:67], v[212:215]
    s_waitcnt lgkmcnt(8)
    v_mfma_f32_16x16x32_bf16 v[216:219], v[16:19], v[60:63], v[216:219]
    v_mfma_f32_16x16x32_bf16 v[220:223], v[16:19], v[64:67], v[220:223]
    s_waitcnt vmcnt(20) lgkmcnt(0)
    s_barrier
    v_mfma_f32_16x16x32_bf16 v[224:227], v[20:23], v[60:63], v[224:227]
    ds_read_b64_tr_b16 v[36:37], v150 offset:40960
    ds_read_b64_tr_b16 v[38:39], v150 offset:46080
    ds_read_b64_tr_b16 v[40:41], v151 offset:40992
    ds_read_b64_tr_b16 v[42:43], v151 offset:46112
    v_mfma_f32_16x16x32_bf16 v[228:231], v[20:23], v[64:67], v[228:231]
    s_add_u32 s31, s38, 82240
    s_add_u32 m0, s29, 81920
    s_nop 0
    buffer_load_dwordx4 v1, s[16:19], s31 offen lds
    v_mfma_f32_16x16x32_bf16 v[232:235], v[24:27], v[60:63], v[232:235]
    ds_read_b64_tr_b16 v[44:45], v150 offset:41024
    ds_read_b64_tr_b16 v[46:47], v150 offset:46144
    ds_read_b64_tr_b16 v[48:49], v151 offset:41056
    ds_read_b64_tr_b16 v[50:51], v151 offset:46176
    v_mfma_f32_16x16x32_bf16 v[236:239], v[24:27], v[64:67], v[236:239]
    s_add_u32 m0, s29, 82944
    s_nop 0
    buffer_load_dwordx4 v2, s[16:19], s31 offen lds
    v_mfma_f32_16x16x32_bf16 v[240:243], v[28:31], v[60:63], v[240:243]
    ds_read_b64_tr_b16 v[16:17], v150 offset:41088
    ds_read_b64_tr_b16 v[18:19], v150 offset:46208
    ds_read_b64_tr_b16 v[20:21], v151 offset:41120
    ds_read_b64_tr_b16 v[22:23], v151 offset:46240
    v_mfma_f32_16x16x32_bf16 v[244:247], v[28:31], v[64:67], v[244:247]
    s_add_u32 m0, s29, 83968
    s_nop 0
    buffer_load_dwordx4 v3, s[16:19], s31 offen lds
    v_mfma_f32_16x16x32_bf16 v[248:251], v[32:35], v[60:63], v[248:251]
    ds_read_b64_tr_b16 v[24:25], v150 offset:41152
    ds_read_b64_tr_b16 v[26:27], v150 offset:46272
    s_add_u32 m0, s29, 84992
    v_mfma_f32_16x16x32_bf16 v[252:255], v[32:35], v[64:67], v[252:255]
    s_nop 0
    buffer_load_dwordx4 v4, s[16:19], s31 offen lds
    s_waitcnt lgkmcnt(12)
    v_mfma_f32_16x16x32_bf16 v[176:179], v[36:39], v[68:71], v[176:179]
    ds_read_b64_tr_b16 v[28:29], v151 offset:41184
    ds_read_b64_tr_b16 v[30:31], v151 offset:46304
    s_add_u32 m0, s29, 86016
    v_mfma_f32_16x16x32_bf16 v[180:183], v[36:39], v[72:75], v[180:183]
    s_nop 0
    buffer_load_dwordx4 v5, s[16:19], s31 offen lds
    s_waitcnt lgkmcnt(12)
    v_mfma_f32_16x16x32_bf16 v[184:187], v[40:43], v[68:71], v[184:187]
    ds_read_b64_tr_b16 v[32:33], v150 offset:41216
    v_mfma_f32_16x16x32_bf16 v[188:191], v[40:43], v[72:75], v[188:191]
    ds_read_b64_tr_b16 v[34:35], v150 offset:46336
    s_waitcnt lgkmcnt(12)
    v_mfma_f32_16x16x32_bf16 v[192:195], v[44:47], v[68:71], v[192:195]
    ds_read_b64_tr_b16 v[36:37], v151 offset:41248
    v_mfma_f32_16x16x32_bf16 v[196:199], v[44:47], v[72:75], v[196:199]
    ds_read_b64_tr_b16 v[38:39], v151 offset:46368
    s_waitcnt lgkmcnt(12)
    v_mfma_f32_16x16x32_bf16 v[200:203], v[48:51], v[68:71], v[200:203]
    ds_read_b64_tr_b16 v[40:41], v150 offset:51200
    v_mfma_f32_16x16x32_bf16 v[204:207], v[48:51], v[72:75], v[204:207]
    ds_read_b64_tr_b16 v[42:43], v150 offset:56320
    s_waitcnt lgkmcnt(12)
    v_mfma_f32_16x16x32_bf16 v[208:211], v[16:19], v[68:71], v[208:211]
    ds_read_b64_tr_b16 v[44:45], v151 offset:51232
    v_mfma_f32_16x16x32_bf16 v[212:215], v[16:19], v[72:75], v[212:215]
    ds_read_b64_tr_b16 v[46:47], v151 offset:56352
    s_waitcnt lgkmcnt(12)
    v_mfma_f32_16x16x32_bf16 v[216:219], v[20:23], v[68:71], v[216:219]
    ds_read_b64_tr_b16 v[48:49], v150 offset:51264
    v_mfma_f32_16x16x32_bf16 v[220:223], v[20:23], v[72:75], v[220:223]
    ds_read_b64_tr_b16 v[50:51], v150 offset:56384
    s_waitcnt lgkmcnt(12)
    v_mfma_f32_16x16x32_bf16 v[224:227], v[24:27], v[68:71], v[224:227]
    ds_read_b64_tr_b16 v[16:17], v151 offset:51296
    v_mfma_f32_16x16x32_bf16 v[228:231], v[24:27], v[72:75], v[228:231]
    ds_read_b64_tr_b16 v[18:19], v151 offset:56416
    s_waitcnt lgkmcnt(12)
    v_mfma_f32_16x16x32_bf16 v[232:235], v[28:31], v[68:71], v[232:235]
    ds_read_b64_tr_b16 v[20:21], v150 offset:51328
    v_mfma_f32_16x16x32_bf16 v[236:239], v[28:31], v[72:75], v[236:239]
    ds_read_b64_tr_b16 v[22:23], v150 offset:56448
    s_waitcnt lgkmcnt(12)
    v_mfma_f32_16x16x32_bf16 v[240:243], v[32:35], v[68:71], v[240:243]
    ds_read_b64_tr_b16 v[24:25], v151 offset:51360
    v_mfma_f32_16x16x32_bf16 v[244:247], v[32:35], v[72:75], v[244:247]
    ds_read_b64_tr_b16 v[26:27], v151 offset:56480
    s_waitcnt lgkmcnt(12)
    v_mfma_f32_16x16x32_bf16 v[248:251], v[36:39], v[68:71], v[248:251]
    ds_read_b64_tr_b16 v[28:29], v150 offset:51392
    v_mfma_f32_16x16x32_bf16 v[252:255], v[36:39], v[72:75], v[252:255]
    ds_read_b64_tr_b16 v[30:31], v150 offset:56512
    s_waitcnt lgkmcnt(12)
    v_mfma_f32_16x16x32_bf16 v[176:179], v[40:43], v[76:79], v[176:179]
    ds_read_b64_tr_b16 v[32:33], v151 offset:51424
    v_mfma_f32_16x16x32_bf16 v[180:183], v[40:43], v[80:83], v[180:183]
    ds_read_b64_tr_b16 v[34:35], v151 offset:56544
    s_waitcnt lgkmcnt(12)
    v_mfma_f32_16x16x32_bf16 v[184:187], v[44:47], v[76:79], v[184:187]
    ds_read_b64_tr_b16 v[36:37], v150 offset:51456
    v_mfma_f32_16x16x32_bf16 v[188:191], v[44:47], v[80:83], v[188:191]
    ds_read_b64_tr_b16 v[38:39], v150 offset:56576
    s_waitcnt lgkmcnt(12)
    v_mfma_f32_16x16x32_bf16 v[192:195], v[48:51], v[76:79], v[192:195]
    ds_read_b64_tr_b16 v[40:41], v151 offset:51488
    v_mfma_f32_16x16x32_bf16 v[196:199], v[48:51], v[80:83], v[196:199]
    ds_read_b64_tr_b16 v[42:43], v151 offset:56608
    s_waitcnt lgkmcnt(12)
    v_mfma_f32_16x16x32_bf16 v[200:203], v[16:19], v[76:79], v[200:203]
    v_mfma_f32_16x16x32_bf16 v[204:207], v[16:19], v[80:83], v[204:207]
    s_waitcnt lgkmcnt(10)
    v_mfma_f32_16x16x32_bf16 v[208:211], v[20:23], v[76:79], v[208:211]
    v_mfma_f32_16x16x32_bf16 v[212:215], v[20:23], v[80:83], v[212:215]
    s_waitcnt lgkmcnt(8)
    v_mfma_f32_16x16x32_bf16 v[216:219], v[24:27], v[76:79], v[216:219]
    v_mfma_f32_16x16x32_bf16 v[220:223], v[24:27], v[80:83], v[220:223]
    s_waitcnt vmcnt(20) lgkmcnt(0)
    s_barrier
    v_mfma_f32_16x16x32_bf16 v[224:227], v[28:31], v[76:79], v[224:227]
    ds_read_b64_tr_b16 v[44:45], v148 offset:0
    ds_read_b64_tr_b16 v[46:47], v148 offset:5120
    ds_read_b64_tr_b16 v[48:49], v149 offset:32
    ds_read_b64_tr_b16 v[50:51], v149 offset:5152
    v_mfma_f32_16x16x32_bf16 v[228:231], v[28:31], v[80:83], v[228:231]
    s_add_u32 s31, s38, 164160
    s_add_u32 m0, s29, 122880
    s_nop 0
    buffer_load_dwordx4 v1, s[16:19], s31 offen lds
    v_mfma_f32_16x16x32_bf16 v[232:235], v[32:35], v[76:79], v[232:235]
    ds_read_b64_tr_b16 v[16:17], v148 offset:64
    ds_read_b64_tr_b16 v[18:19], v148 offset:5184
    ds_read_b64_tr_b16 v[20:21], v149 offset:96
    ds_read_b64_tr_b16 v[22:23], v149 offset:5216
    v_mfma_f32_16x16x32_bf16 v[236:239], v[32:35], v[80:83], v[236:239]
    s_add_u32 m0, s29, 123904
    s_nop 0
    buffer_load_dwordx4 v2, s[16:19], s31 offen lds
    v_mfma_f32_16x16x32_bf16 v[240:243], v[36:39], v[76:79], v[240:243]
    ds_read_b64_tr_b16 v[24:25], v148 offset:128
    ds_read_b64_tr_b16 v[26:27], v148 offset:5248
    ds_read_b64_tr_b16 v[28:29], v149 offset:160
    ds_read_b64_tr_b16 v[30:31], v149 offset:5280
    v_mfma_f32_16x16x32_bf16 v[244:247], v[36:39], v[80:83], v[244:247]
    s_add_u32 m0, s29, 124928
    s_nop 0
    buffer_load_dwordx4 v3, s[16:19], s31 offen lds
    v_mfma_f32_16x16x32_bf16 v[248:251], v[40:43], v[76:79], v[248:251]
    ds_read_b64_tr_b16 v[32:33], v148 offset:192
    ds_read_b64_tr_b16 v[34:35], v148 offset:5312
    s_add_u32 m0, s29, 125952
    v_mfma_f32_16x16x32_bf16 v[252:255], v[40:43], v[80:83], v[252:255]
    s_nop 0
    buffer_load_dwordx4 v4, s[16:19], s31 offen lds
    s_waitcnt lgkmcnt(12)
    v_mfma_f32_16x16x32_bf16 v[176:179], v[44:47], v[84:87], v[176:179]
    ds_read_b64_tr_b16 v[36:37], v149 offset:224
    ds_read_b64_tr_b16 v[38:39], v149 offset:5344
    s_add_u32 m0, s29, 126976
    v_mfma_f32_16x16x32_bf16 v[180:183], v[44:47], v[88:91], v[180:183]
    s_nop 0
    buffer_load_dwordx4 v5, s[16:19], s31 offen lds
    s_waitcnt lgkmcnt(12)
    v_mfma_f32_16x16x32_bf16 v[184:187], v[48:51], v[84:87], v[184:187]
    ds_read_b64_tr_b16 v[40:41], v148 offset:256
    v_mfma_f32_16x16x32_bf16 v[188:191], v[48:51], v[88:91], v[188:191]
    ds_read_b64_tr_b16 v[42:43], v148 offset:5376
    s_waitcnt lgkmcnt(12)
    v_mfma_f32_16x16x32_bf16 v[192:195], v[16:19], v[84:87], v[192:195]
    ds_read_b64_tr_b16 v[44:45], v149 offset:288
    v_mfma_f32_16x16x32_bf16 v[196:199], v[16:19], v[88:91], v[196:199]
    ds_read_b64_tr_b16 v[46:47], v149 offset:5408
    s_waitcnt lgkmcnt(12)
    v_mfma_f32_16x16x32_bf16 v[200:203], v[20:23], v[84:87], v[200:203]
    ds_read_b64_tr_b16 v[48:49], v148 offset:10240
    v_mfma_f32_16x16x32_bf16 v[204:207], v[20:23], v[88:91], v[204:207]
    ds_read_b64_tr_b16 v[50:51], v148 offset:15360
    s_waitcnt lgkmcnt(12)
    v_mfma_f32_16x16x32_bf16 v[208:211], v[24:27], v[84:87], v[208:211]
    ds_read_b64_tr_b16 v[16:17], v149 offset:10272
    v_mfma_f32_16x16x32_bf16 v[212:215], v[24:27], v[88:91], v[212:215]
    ds_read_b64_tr_b16 v[18:19], v149 offset:15392
    s_waitcnt lgkmcnt(12)
    v_mfma_f32_16x16x32_bf16 v[216:219], v[28:31], v[84:87], v[216:219]
    ds_read_b64_tr_b16 v[20:21], v148 offset:10304
    v_mfma_f32_16x16x32_bf16 v[220:223], v[28:31], v[88:91], v[220:223]
    ds_read_b64_tr_b16 v[22:23], v148 offset:15424
    s_waitcnt lgkmcnt(12)
    v_mfma_f32_16x16x32_bf16 v[224:227], v[32:35], v[84:87], v[224:227]
    ds_read_b64_tr_b16 v[24:25], v149 offset:10336
    v_mfma_f32_16x16x32_bf16 v[228:231], v[32:35], v[88:91], v[228:231]
    ds_read_b64_tr_b16 v[26:27], v149 offset:15456
    s_waitcnt lgkmcnt(12)
    v_mfma_f32_16x16x32_bf16 v[232:235], v[36:39], v[84:87], v[232:235]
    ds_read_b64_tr_b16 v[28:29], v148 offset:10368
    v_mfma_f32_16x16x32_bf16 v[236:239], v[36:39], v[88:91], v[236:239]
    ds_read_b64_tr_b16 v[30:31], v148 offset:15488
    s_waitcnt lgkmcnt(12)
    v_mfma_f32_16x16x32_bf16 v[240:243], v[40:43], v[84:87], v[240:243]
    ds_read_b64_tr_b16 v[32:33], v149 offset:10400
    v_mfma_f32_16x16x32_bf16 v[244:247], v[40:43], v[88:91], v[244:247]
    ds_read_b64_tr_b16 v[34:35], v149 offset:15520
    s_waitcnt lgkmcnt(12)
    v_mfma_f32_16x16x32_bf16 v[248:251], v[44:47], v[84:87], v[248:251]
    ds_read_b64_tr_b16 v[36:37], v148 offset:10432
    v_mfma_f32_16x16x32_bf16 v[252:255], v[44:47], v[88:91], v[252:255]
    ds_read_b64_tr_b16 v[38:39], v148 offset:15552
    s_waitcnt lgkmcnt(12)
    v_mfma_f32_16x16x32_bf16 v[176:179], v[48:51], v[92:95], v[176:179]
    ds_read_b64_tr_b16 v[40:41], v149 offset:10464
    v_mfma_f32_16x16x32_bf16 v[180:183], v[48:51], v[96:99], v[180:183]
    ds_read_b64_tr_b16 v[42:43], v149 offset:15584
    s_waitcnt lgkmcnt(12)
    v_mfma_f32_16x16x32_bf16 v[184:187], v[16:19], v[92:95], v[184:187]
    ds_read_b64_tr_b16 v[44:45], v148 offset:10496
    v_mfma_f32_16x16x32_bf16 v[188:191], v[16:19], v[96:99], v[188:191]
    ds_read_b64_tr_b16 v[46:47], v148 offset:15616
    s_waitcnt lgkmcnt(12)
    v_mfma_f32_16x16x32_bf16 v[192:195], v[20:23], v[92:95], v[192:195]
    ds_read_b64_tr_b16 v[48:49], v149 offset:10528
    v_mfma_f32_16x16x32_bf16 v[196:199], v[20:23], v[96:99], v[196:199]
    ds_read_b64_tr_b16 v[50:51], v149 offset:15648
    s_waitcnt lgkmcnt(12)
    v_mfma_f32_16x16x32_bf16 v[200:203], v[24:27], v[92:95], v[200:203]
    v_mfma_f32_16x16x32_bf16 v[204:207], v[24:27], v[96:99], v[204:207]
    s_waitcnt lgkmcnt(10)
    v_mfma_f32_16x16x32_bf16 v[208:211], v[28:31], v[92:95], v[208:211]
    v_mfma_f32_16x16x32_bf16 v[212:215], v[28:31], v[96:99], v[212:215]
    s_waitcnt lgkmcnt(8)
    v_mfma_f32_16x16x32_bf16 v[216:219], v[32:35], v[92:95], v[216:219]
    v_mfma_f32_16x16x32_bf16 v[220:223], v[32:35], v[96:99], v[220:223]
    s_waitcnt vmcnt(20) lgkmcnt(0)
    s_barrier
    buffer_load_dword v13, off, s[40:43], s45 offset:252 sc0 sc1
    v_mfma_f32_16x16x32_bf16 v[224:227], v[36:39], v[92:95], v[224:227]
    ds_read_b64_tr_b16 v[16:17], v148 offset:40960
    ds_read_b64_tr_b16 v[18:19], v148 offset:46080
    v_mfma_f32_16x16x32_bf16 v[228:231], v[36:39], v[96:99], v[228:231]
    ds_read_b64_tr_b16 v[20:21], v149 offset:40992
    ds_read_b64_tr_b16 v[22:23], v149 offset:46112
    v_mfma_f32_16x16x32_bf16 v[232:235], v[40:43], v[92:95], v[232:235]
    ds_read_b64_tr_b16 v[24:25], v148 offset:41024
    ds_read_b64_tr_b16 v[26:27], v148 offset:46144
    v_mfma_f32_16x16x32_bf16 v[236:239], v[40:43], v[96:99], v[236:239]
    ds_read_b64_tr_b16 v[28:29], v149 offset:41056
    ds_read_b64_tr_b16 v[30:31], v149 offset:46176
    v_mfma_f32_16x16x32_bf16 v[240:243], v[44:47], v[92:95], v[240:243]
    ds_read_b64_tr_b16 v[32:33], v148 offset:41088
    ds_read_b64_tr_b16 v[34:35], v148 offset:46208
    v_mfma_f32_16x16x32_bf16 v[244:247], v[44:47], v[96:99], v[244:247]
    ds_read_b64_tr_b16 v[36:37], v149 offset:41120
    ds_read_b64_tr_b16 v[38:39], v149 offset:46240
    v_mfma_f32_16x16x32_bf16 v[248:251], v[48:51], v[92:95], v[248:251]
    ds_read_b64_tr_b16 v[40:41], v148 offset:41152
    v_mfma_f32_16x16x32_bf16 v[252:255], v[48:51], v[96:99], v[252:255]
    ds_read_b64_tr_b16 v[42:43], v148 offset:46272
    s_waitcnt lgkmcnt(12)
    v_mfma_f32_16x16x32_bf16 v[176:179], v[16:19], v[100:103], v[176:179]
    ds_read_b64_tr_b16 v[44:45], v149 offset:41184
    v_mfma_f32_16x16x32_bf16 v[180:183], v[16:19], v[104:107], v[180:183]
    ds_read_b64_tr_b16 v[46:47], v149 offset:46304
    s_waitcnt lgkmcnt(12)
    v_mfma_f32_16x16x32_bf16 v[184:187], v[20:23], v[100:103], v[184:187]
    ds_read_b64_tr_b16 v[48:49], v148 offset:41216
    v_mfma_f32_16x16x32_bf16 v[188:191], v[20:23], v[104:107], v[188:191]
    ds_read_b64_tr_b16 v[50:51], v148 offset:46336
    s_waitcnt lgkmcnt(12)
    v_mfma_f32_16x16x32_bf16 v[192:195], v[24:27], v[100:103], v[192:195]
    ds_read_b64_tr_b16 v[16:17], v149 offset:41248
    v_mfma_f32_16x16x32_bf16 v[196:199], v[24:27], v[104:107], v[196:199]
    ds_read_b64_tr_b16 v[18:19], v149 offset:46368
    s_waitcnt lgkmcnt(12)
    v_mfma_f32_16x16x32_bf16 v[200:203], v[28:31], v[100:103], v[200:203]
    ds_read_b64_tr_b16 v[20:21], v148 offset:51200
    v_mfma_f32_16x16x32_bf16 v[204:207], v[28:31], v[104:107], v[204:207]
    ds_read_b64_tr_b16 v[22:23], v148 offset:56320
    s_waitcnt lgkmcnt(12)
    v_mfma_f32_16x16x32_bf16 v[208:211], v[32:35], v[100:103], v[208:211]
    ds_read_b64_tr_b16 v[24:25], v149 offset:51232
    v_mfma_f32_16x16x32_bf16 v[212:215], v[32:35], v[104:107], v[212:215]
    ds_read_b64_tr_b16 v[26:27], v149 offset:56352
    s_waitcnt lgkmcnt(12)
    v_mfma_f32_16x16x32_bf16 v[216:219], v[36:39], v[100:103], v[216:219]
    ds_read_b64_tr_b16 v[28:29], v148 offset:51264
    v_mfma_f32_16x16x32_bf16 v[220:223], v[36:39], v[104:107], v[220:223]
    ds_read_b64_tr_b16 v[30:31], v148 offset:56384
    s_waitcnt lgkmcnt(12)
    v_mfma_f32_16x16x32_bf16 v[224:227], v[40:43], v[100:103], v[224:227]
    ds_read_b64_tr_b16 v[32:33], v149 offset:51296
    v_mfma_f32_16x16x32_bf16 v[228:231], v[40:43], v[104:107], v[228:231]
    ds_read_b64_tr_b16 v[34:35], v149 offset:56416
    s_waitcnt lgkmcnt(12)
    v_mfma_f32_16x16x32_bf16 v[232:235], v[44:47], v[100:103], v[232:235]
    ds_read_b64_tr_b16 v[36:37], v148 offset:51328
    v_mfma_f32_16x16x32_bf16 v[236:239], v[44:47], v[104:107], v[236:239]
    ds_read_b64_tr_b16 v[38:39], v148 offset:56448
    s_waitcnt lgkmcnt(12)
    v_mfma_f32_16x16x32_bf16 v[240:243], v[48:51], v[100:103], v[240:243]
    ds_read_b64_tr_b16 v[40:41], v149 offset:51360
    v_mfma_f32_16x16x32_bf16 v[244:247], v[48:51], v[104:107], v[244:247]
    ds_read_b64_tr_b16 v[42:43], v149 offset:56480
    s_waitcnt lgkmcnt(12)
    v_mfma_f32_16x16x32_bf16 v[248:251], v[16:19], v[100:103], v[248:251]
    ds_read_b64_tr_b16 v[44:45], v148 offset:51392
    v_mfma_f32_16x16x32_bf16 v[252:255], v[16:19], v[104:107], v[252:255]
    ds_read_b64_tr_b16 v[46:47], v148 offset:56512
    s_waitcnt lgkmcnt(12)
    v_mfma_f32_16x16x32_bf16 v[176:179], v[20:23], v[108:111], v[176:179]
    ds_read_b64_tr_b16 v[48:49], v149 offset:51424
    v_mfma_f32_16x16x32_bf16 v[180:183], v[20:23], v[112:115], v[180:183]
    ds_read_b64_tr_b16 v[50:51], v149 offset:56544
    s_waitcnt lgkmcnt(12)
    v_mfma_f32_16x16x32_bf16 v[184:187], v[24:27], v[108:111], v[184:187]
    ds_read_b64_tr_b16 v[16:17], v148 offset:51456
    v_mfma_f32_16x16x32_bf16 v[188:191], v[24:27], v[112:115], v[188:191]
    ds_read_b64_tr_b16 v[18:19], v148 offset:56576
    s_waitcnt lgkmcnt(12)
    v_mfma_f32_16x16x32_bf16 v[192:195], v[28:31], v[108:111], v[192:195]
    ds_read_b64_tr_b16 v[20:21], v149 offset:51488
    v_mfma_f32_16x16x32_bf16 v[196:199], v[28:31], v[112:115], v[196:199]
    ds_read_b64_tr_b16 v[22:23], v149 offset:56608
    s_waitcnt lgkmcnt(12)
    v_mfma_f32_16x16x32_bf16 v[200:203], v[32:35], v[108:111], v[200:203]
    v_mfma_f32_16x16x32_bf16 v[204:207], v[32:35], v[112:115], v[204:207]
    s_waitcnt lgkmcnt(10)
    v_mfma_f32_16x16x32_bf16 v[208:211], v[36:39], v[108:111], v[208:211]
    v_mfma_f32_16x16x32_bf16 v[212:215], v[36:39], v[112:115], v[212:215]
    s_waitcnt lgkmcnt(8)
    v_mfma_f32_16x16x32_bf16 v[216:219], v[40:43], v[108:111], v[216:219]
    v_mfma_f32_16x16x32_bf16 v[220:223], v[40:43], v[112:115], v[220:223]
    s_waitcnt vmcnt(6) lgkmcnt(0)
    s_barrier
    s_mov_b64 exec, 1
    buffer_store_dword v11, off, s[84:87], s46 sc0 sc1
    s_mov_b64 exec, -1
    v_mfma_f32_16x16x32_bf16 v[224:227], v[44:47], v[108:111], v[224:227]
    ds_read_b64_tr_b16 v[24:25], v150 offset:0
    ds_read_b64_tr_b16 v[26:27], v150 offset:5120
    v_mfma_f32_16x16x32_bf16 v[228:231], v[44:47], v[112:115], v[228:231]
    ds_read_b64_tr_b16 v[28:29], v151 offset:32
    ds_read_b64_tr_b16 v[30:31], v151 offset:5152
    v_mfma_f32_16x16x32_bf16 v[232:235], v[48:51], v[108:111], v[232:235]
    ds_read_b64_tr_b16 v[32:33], v150 offset:64
    ds_read_b64_tr_b16 v[34:35], v150 offset:5184
    v_mfma_f32_16x16x32_bf16 v[236:239], v[48:51], v[112:115], v[236:239]
    ds_read_b64_tr_b16 v[36:37], v151 offset:96
    ds_read_b64_tr_b16 v[38:39], v151 offset:5216
    v_mfma_f32_16x16x32_bf16 v[240:243], v[16:19], v[108:111], v[240:243]
    ds_read_b64_tr_b16 v[40:41], v150 offset:128
    ds_read_b64_tr_b16 v[42:43], v150 offset:5248
    v_mfma_f32_16x16x32_bf16 v[244:247], v[16:19], v[112:115], v[244:247]
    ds_read_b64_tr_b16 v[44:45], v151 offset:160
    ds_read_b64_tr_b16 v[46:47], v151 offset:5280
    v_mfma_f32_16x16x32_bf16 v[248:251], v[20:23], v[108:111], v[248:251]
    ds_read_b64_tr_b16 v[48:49], v150 offset:192
    v_mfma_f32_16x16x32_bf16 v[252:255], v[20:23], v[112:115], v[252:255]
    ds_read_b64_tr_b16 v[50:51], v150 offset:5312
    s_waitcnt lgkmcnt(12)
    v_mfma_f32_16x16x32_bf16 v[176:179], v[24:27], v[116:119], v[176:179]
    ds_read_b64_tr_b16 v[16:17], v151 offset:224
    v_mfma_f32_16x16x32_bf16 v[180:183], v[24:27], v[120:123], v[180:183]
    ds_read_b64_tr_b16 v[18:19], v151 offset:5344
    s_waitcnt lgkmcnt(12)
    v_mfma_f32_16x16x32_bf16 v[184:187], v[28:31], v[116:119], v[184:187]
    ds_read_b64_tr_b16 v[20:21], v150 offset:256
    v_mfma_f32_16x16x32_bf16 v[188:191], v[28:31], v[120:123], v[188:191]
    ds_read_b64_tr_b16 v[22:23], v150 offset:5376
    s_waitcnt lgkmcnt(12)
    v_mfma_f32_16x16x32_bf16 v[192:195], v[32:35], v[116:119], v[192:195]
    ds_read_b64_tr_b16 v[24:25], v151 offset:288
    v_mfma_f32_16x16x32_bf16 v[196:199], v[32:35], v[120:123], v[196:199]
    ds_read_b64_tr_b16 v[26:27], v151 offset:5408
    s_waitcnt lgkmcnt(12)
    v_mfma_f32_16x16x32_bf16 v[200:203], v[36:39], v[116:119], v[200:203]
    ds_read_b64_tr_b16 v[28:29], v150 offset:10240
    v_mfma_f32_16x16x32_bf16 v[204:207], v[36:39], v[120:123], v[204:207]
    ds_read_b64_tr_b16 v[30:31], v150 offset:15360
    s_waitcnt lgkmcnt(12)
    v_mfma_f32_16x16x32_bf16 v[208:211], v[40:43], v[116:119], v[208:211]
    ds_read_b64_tr_b16 v[32:33], v151 offset:10272
    v_mfma_f32_16x16x32_bf16 v[212:215], v[40:43], v[120:123], v[212:215]
    ds_read_b64_tr_b16 v[34:35], v151 offset:15392
    s_waitcnt lgkmcnt(12)
    v_mfma_f32_16x16x32_bf16 v[216:219], v[44:47], v[116:119], v[216:219]
    ds_read_b64_tr_b16 v[36:37], v150 offset:10304
    v_mfma_f32_16x16x32_bf16 v[220:223], v[44:47], v[120:123], v[220:223]
    ds_read_b64_tr_b16 v[38:39], v150 offset:15424
    s_waitcnt lgkmcnt(12)
    v_mfma_f32_16x16x32_bf16 v[224:227], v[48:51], v[116:119], v[224:227]
    ds_read_b64_tr_b16 v[40:41], v151 offset:10336
    v_mfma_f32_16x16x32_bf16 v[228:231], v[48:51], v[120:123], v[228:231]
    ds_read_b64_tr_b16 v[42:43], v151 offset:15456
    s_waitcnt lgkmcnt(12)
    v_mfma_f32_16x16x32_bf16 v[232:235], v[16:19], v[116:119], v[232:235]
    ds_read_b64_tr_b16 v[44:45], v150 offset:10368
    v_mfma_f32_16x16x32_bf16 v[236:239], v[16:19], v[120:123], v[236:239]
    ds_read_b64_tr_b16 v[46:47], v150 offset:15488
    s_waitcnt lgkmcnt(12)
    v_mfma_f32_16x16x32_bf16 v[240:243], v[20:23], v[116:119], v[240:243]
    ds_read_b64_tr_b16 v[48:49], v151 offset:10400
    v_mfma_f32_16x16x32_bf16 v[244:247], v[20:23], v[120:123], v[244:247]
    ds_read_b64_tr_b16 v[50:51], v151 offset:15520
    s_waitcnt lgkmcnt(12)
    v_mfma_f32_16x16x32_bf16 v[248:251], v[24:27], v[116:119], v[248:251]
    ds_read_b64_tr_b16 v[16:17], v150 offset:10432
    v_mfma_f32_16x16x32_bf16 v[252:255], v[24:27], v[120:123], v[252:255]
    ds_read_b64_tr_b16 v[18:19], v150 offset:15552
    s_waitcnt lgkmcnt(12)
    v_mfma_f32_16x16x32_bf16 v[176:179], v[28:31], v[124:127], v[176:179]
    ds_read_b64_tr_b16 v[20:21], v151 offset:10464
    v_mfma_f32_16x16x32_bf16 v[180:183], v[28:31], v[128:131], v[180:183]
    ds_read_b64_tr_b16 v[22:23], v151 offset:15584
    s_waitcnt lgkmcnt(12)
    v_mfma_f32_16x16x32_bf16 v[184:187], v[32:35], v[124:127], v[184:187]
    ds_read_b64_tr_b16 v[24:25], v150 offset:10496
    v_mfma_f32_16x16x32_bf16 v[188:191], v[32:35], v[128:131], v[188:191]
    ds_read_b64_tr_b16 v[26:27], v150 offset:15616
    s_waitcnt lgkmcnt(12)
    v_mfma_f32_16x16x32_bf16 v[192:195], v[36:39], v[124:127], v[192:195]
    ds_read_b64_tr_b16 v[28:29], v151 offset:10528
    v_mfma_f32_16x16x32_bf16 v[196:199], v[36:39], v[128:131], v[196:199]
    ds_read_b64_tr_b16 v[30:31], v151 offset:15648
    s_waitcnt lgkmcnt(12)
    v_mfma_f32_16x16x32_bf16 v[200:203], v[40:43], v[124:127], v[200:203]
    v_mfma_f32_16x16x32_bf16 v[204:207], v[40:43], v[128:131], v[204:207]
    s_waitcnt lgkmcnt(10)
    v_mfma_f32_16x16x32_bf16 v[208:211], v[44:47], v[124:127], v[208:211]
    v_mfma_f32_16x16x32_bf16 v[212:215], v[44:47], v[128:131], v[212:215]
    s_waitcnt lgkmcnt(8)
    v_mfma_f32_16x16x32_bf16 v[216:219], v[48:51], v[124:127], v[216:219]
    v_mfma_f32_16x16x32_bf16 v[220:223], v[48:51], v[128:131], v[220:223]
    s_waitcnt vmcnt(2) lgkmcnt(0)
    s_barrier
    v_mfma_f32_16x16x32_bf16 v[224:227], v[16:19], v[124:127], v[224:227]
    ds_read_b64_tr_b16 v[32:33], v150 offset:40960
    ds_read_b64_tr_b16 v[34:35], v150 offset:46080
    v_mfma_f32_16x16x32_bf16 v[228:231], v[16:19], v[128:131], v[228:231]
    ds_read_b64_tr_b16 v[36:37], v151 offset:40992
    ds_read_b64_tr_b16 v[38:39], v151 offset:46112
    v_mfma_f32_16x16x32_bf16 v[232:235], v[20:23], v[124:127], v[232:235]
    ds_read_b64_tr_b16 v[40:41], v150 offset:41024
    ds_read_b64_tr_b16 v[42:43], v150 offset:46144
    v_mfma_f32_16x16x32_bf16 v[236:239], v[20:23], v[128:131], v[236:239]
    ds_read_b64_tr_b16 v[44:45], v151 offset:41056
    ds_read_b64_tr_b16 v[46:47], v151 offset:46176
    v_mfma_f32_16x16x32_bf16 v[240:243], v[24:27], v[124:127], v[240:243]
    ds_read_b64_tr_b16 v[48:49], v150 offset:41088
    ds_read_b64_tr_b16 v[50:51], v150 offset:46208
    v_mfma_f32_16x16x32_bf16 v[244:247], v[24:27], v[128:131], v[244:247]
    ds_read_b64_tr_b16 v[16:17], v151 offset:41120
    ds_read_b64_tr_b16 v[18:19], v151 offset:46240
    v_mfma_f32_16x16x32_bf16 v[248:251], v[28:31], v[124:127], v[248:251]
    ds_read_b64_tr_b16 v[20:21], v150 offset:41152
    v_mfma_f32_16x16x32_bf16 v[252:255], v[28:31], v[128:131], v[252:255]
    ds_read_b64_tr_b16 v[22:23], v150 offset:46272
    s_waitcnt lgkmcnt(12)
    v_mfma_f32_16x16x32_bf16 v[176:179], v[32:35], v[132:135], v[176:179]
    ds_read_b64_tr_b16 v[24:25], v151 offset:41184
    v_mfma_f32_16x16x32_bf16 v[180:183], v[32:35], v[136:139], v[180:183]
    ds_read_b64_tr_b16 v[26:27], v151 offset:46304
    s_waitcnt lgkmcnt(12)
    v_mfma_f32_16x16x32_bf16 v[184:187], v[36:39], v[132:135], v[184:187]
    ds_read_b64_tr_b16 v[28:29], v150 offset:41216
    v_mfma_f32_16x16x32_bf16 v[188:191], v[36:39], v[136:139], v[188:191]
    ds_read_b64_tr_b16 v[30:31], v150 offset:46336
    s_waitcnt lgkmcnt(12)
    v_mfma_f32_16x16x32_bf16 v[192:195], v[40:43], v[132:135], v[192:195]
    ds_read_b64_tr_b16 v[32:33], v151 offset:41248
    v_mfma_f32_16x16x32_bf16 v[196:199], v[40:43], v[136:139], v[196:199]
    ds_read_b64_tr_b16 v[34:35], v151 offset:46368
    s_waitcnt lgkmcnt(12)
    v_mfma_f32_16x16x32_bf16 v[200:203], v[44:47], v[132:135], v[200:203]
    ds_read_b64_tr_b16 v[36:37], v150 offset:51200
    v_mfma_f32_16x16x32_bf16 v[204:207], v[44:47], v[136:139], v[204:207]
    ds_read_b64_tr_b16 v[38:39], v150 offset:56320
    s_waitcnt lgkmcnt(12)
    v_mfma_f32_16x16x32_bf16 v[208:211], v[48:51], v[132:135], v[208:211]
    ds_read_b64_tr_b16 v[40:41], v151 offset:51232
    v_mfma_f32_16x16x32_bf16 v[212:215], v[48:51], v[136:139], v[212:215]
    ds_read_b64_tr_b16 v[42:43], v151 offset:56352
    s_waitcnt lgkmcnt(12)
    v_mfma_f32_16x16x32_bf16 v[216:219], v[16:19], v[132:135], v[216:219]
    ds_read_b64_tr_b16 v[44:45], v150 offset:51264
    v_mfma_f32_16x16x32_bf16 v[220:223], v[16:19], v[136:139], v[220:223]
    ds_read_b64_tr_b16 v[46:47], v150 offset:56384
    s_waitcnt lgkmcnt(12)
    v_mfma_f32_16x16x32_bf16 v[224:227], v[20:23], v[132:135], v[224:227]
    ds_read_b64_tr_b16 v[48:49], v151 offset:51296
    v_mfma_f32_16x16x32_bf16 v[228:231], v[20:23], v[136:139], v[228:231]
    ds_read_b64_tr_b16 v[50:51], v151 offset:56416
    s_waitcnt lgkmcnt(12)
    v_mfma_f32_16x16x32_bf16 v[232:235], v[24:27], v[132:135], v[232:235]
    ds_read_b64_tr_b16 v[16:17], v150 offset:51328
    v_mfma_f32_16x16x32_bf16 v[236:239], v[24:27], v[136:139], v[236:239]
    ds_read_b64_tr_b16 v[18:19], v150 offset:56448
    s_waitcnt lgkmcnt(12)
    v_mfma_f32_16x16x32_bf16 v[240:243], v[28:31], v[132:135], v[240:243]
    ds_read_b64_tr_b16 v[20:21], v151 offset:51360
    v_mfma_f32_16x16x32_bf16 v[244:247], v[28:31], v[136:139], v[244:247]
    ds_read_b64_tr_b16 v[22:23], v151 offset:56480
    s_waitcnt lgkmcnt(12)
    v_mfma_f32_16x16x32_bf16 v[248:251], v[32:35], v[132:135], v[248:251]
    ds_read_b64_tr_b16 v[24:25], v150 offset:51392
    v_mfma_f32_16x16x32_bf16 v[252:255], v[32:35], v[136:139], v[252:255]
    ds_read_b64_tr_b16 v[26:27], v150 offset:56512
    s_waitcnt lgkmcnt(12)
    v_mfma_f32_16x16x32_bf16 v[176:179], v[36:39], v[140:143], v[176:179]
    ds_read_b64_tr_b16 v[28:29], v151 offset:51424
    v_mfma_f32_16x16x32_bf16 v[180:183], v[36:39], v[144:147], v[180:183]
    ds_read_b64_tr_b16 v[30:31], v151 offset:56544
    s_waitcnt lgkmcnt(12)
    v_mfma_f32_16x16x32_bf16 v[184:187], v[40:43], v[140:143], v[184:187]
    ds_read_b64_tr_b16 v[32:33], v150 offset:51456
    v_mfma_f32_16x16x32_bf16 v[188:191], v[40:43], v[144:147], v[188:191]
    ds_read_b64_tr_b16 v[34:35], v150 offset:56576
    s_waitcnt lgkmcnt(12)
    v_mfma_f32_16x16x32_bf16 v[192:195], v[44:47], v[140:143], v[192:195]
    ds_read_b64_tr_b16 v[36:37], v151 offset:51488
    v_mfma_f32_16x16x32_bf16 v[196:199], v[44:47], v[144:147], v[196:199]
    ds_read_b64_tr_b16 v[38:39], v151 offset:56608
    s_waitcnt lgkmcnt(12)
    v_mfma_f32_16x16x32_bf16 v[200:203], v[48:51], v[140:143], v[200:203]
    v_mfma_f32_16x16x32_bf16 v[204:207], v[48:51], v[144:147], v[204:207]
    s_waitcnt lgkmcnt(10)
    v_mfma_f32_16x16x32_bf16 v[208:211], v[16:19], v[140:143], v[208:211]
    v_mfma_f32_16x16x32_bf16 v[212:215], v[16:19], v[144:147], v[212:215]
    s_waitcnt lgkmcnt(8)
    v_mfma_f32_16x16x32_bf16 v[216:219], v[20:23], v[140:143], v[216:219]
    v_mfma_f32_16x16x32_bf16 v[220:223], v[20:23], v[144:147], v[220:223]
    s_waitcnt lgkmcnt(6)
    v_mfma_f32_16x16x32_bf16 v[224:227], v[24:27], v[140:143], v[224:227]
    v_mfma_f32_16x16x32_bf16 v[228:231], v[24:27], v[144:147], v[228:231]
    s_waitcnt lgkmcnt(4)
    v_mfma_f32_16x16x32_bf16 v[232:235], v[28:31], v[140:143], v[232:235]
    v_mfma_f32_16x16x32_bf16 v[236:239], v[28:31], v[144:147], v[236:239]
    s_waitcnt lgkmcnt(2)
    v_mfma_f32_16x16x32_bf16 v[240:243], v[32:35], v[140:143], v[240:243]
    v_mfma_f32_16x16x32_bf16 v[244:247], v[32:35], v[144:147], v[244:247]
    s_waitcnt lgkmcnt(0)
    v_mfma_f32_16x16x32_bf16 v[248:251], v[36:39], v[140:143], v[248:251]
    v_mfma_f32_16x16x32_bf16 v[252:255], v[36:39], v[144:147], v[252:255]
    s_nop 7
    s_nop 7
    v_cvt_pk_bf16_f32 v152, v176, v177
    v_cvt_pk_bf16_f32 v153, v178, v179
    v_cvt_pk_bf16_f32 v154, v180, v181
    v_cvt_pk_bf16_f32 v155, v182, v183
    s_nop 1
    v_permlane16_swap_b32 v152, v154
    v_permlane16_swap_b32 v153, v155
    s_nop 1
    buffer_store_dwordx4 v[152:155], v10, s[24:27], s49 offen offset:2048 sc0 sc1
    v_cvt_pk_bf16_f32 v156, v184, v185
    v_cvt_pk_bf16_f32 v157, v186, v187
    v_cvt_pk_bf16_f32 v158, v188, v189
    v_cvt_pk_bf16_f32 v159, v190, v191
    s_nop 1
    v_permlane16_swap_b32 v156, v158
    v_permlane16_swap_b32 v157, v159
    s_nop 1
    buffer_store_dwordx4 v[156:159], v10, s[24:27], s49 offen offset:3072 sc0 sc1
    v_cvt_pk_bf16_f32 v160, v192, v193
    v_cvt_pk_bf16_f32 v161, v194, v195
    v_cvt_pk_bf16_f32 v162, v196, v197
    v_cvt_pk_bf16_f32 v163, v198, v199
    s_nop 1
    v_permlane16_swap_b32 v160, v162
    v_permlane16_swap_b32 v161, v163
    s_nop 1
    s_add_u32 s49, s49, 4096
    buffer_store_dwordx4 v[160:163], v10, s[24:27], s49 offen offset:0 sc0 sc1
    v_cvt_pk_bf16_f32 v164, v200, v201
    v_cvt_pk_bf16_f32 v165, v202, v203
    v_cvt_pk_bf16_f32 v166, v204, v205
    v_cvt_pk_bf16_f32 v167, v206, v207
    s_nop 1
    v_permlane16_swap_b32 v164, v166
    v_permlane16_swap_b32 v165, v167
    s_nop 1
    buffer_store_dwordx4 v[164:167], v10, s[24:27], s49 offen offset:1024 sc0 sc1
    v_cvt_pk_bf16_f32 v152, v208, v209
    v_cvt_pk_bf16_f32 v153, v210, v211
    v_cvt_pk_bf16_f32 v154, v212, v213
    v_cvt_pk_bf16_f32 v155, v214, v215
    s_nop 1
    v_permlane16_swap_b32 v152, v154
    v_permlane16_swap_b32 v153, v155
    s_nop 1
    buffer_store_dwordx4 v[152:155], v10, s[24:27], s49 offen offset:2048 sc0 sc1
    v_cvt_pk_bf16_f32 v156, v216, v217
    v_cvt_pk_bf16_f32 v157, v218, v219
    v_cvt_pk_bf16_f32 v158, v220, v221
    v_cvt_pk_bf16_f32 v159, v222, v223
    s_nop 1
    v_permlane16_swap_b32 v156, v158
    v_permlane16_swap_b32 v157, v159
    s_nop 1
    buffer_store_dwordx4 v[156:159], v10, s[24:27], s49 offen offset:3072 sc0 sc1
    v_cvt_pk_bf16_f32 v160, v224, v225
    v_cvt_pk_bf16_f32 v161, v226, v227
    v_cvt_pk_bf16_f32 v162, v228, v229
    v_cvt_pk_bf16_f32 v163, v230, v231
    s_nop 1
    v_permlane16_swap_b32 v160, v162
    v_permlane16_swap_b32 v161, v163
    s_nop 1
    s_add_u32 s49, s49, 4096
    buffer_store_dwordx4 v[160:163], v10, s[24:27], s49 offen offset:0 sc0 sc1
    v_cvt_pk_bf16_f32 v164, v232, v233
    v_cvt_pk_bf16_f32 v165, v234, v235
    v_cvt_pk_bf16_f32 v166, v236, v237
    v_cvt_pk_bf16_f32 v167, v238, v239
    s_nop 1
    v_permlane16_swap_b32 v164, v166
    v_permlane16_swap_b32 v165, v167
    s_nop 1
    buffer_store_dwordx4 v[164:167], v10, s[24:27], s49 offen offset:1024 sc0 sc1
    v_cvt_pk_bf16_f32 v152, v240, v241
    v_cvt_pk_bf16_f32 v153, v242, v243
    v_cvt_pk_bf16_f32 v154, v244, v245
    v_cvt_pk_bf16_f32 v155, v246, v247
    s_nop 1
    v_permlane16_swap_b32 v152, v154
    v_permlane16_swap_b32 v153, v155
    s_nop 1
    buffer_store_dwordx4 v[152:155], v10, s[24:27], s49 offen offset:2048 sc0 sc1
    v_cvt_pk_bf16_f32 v156, v248, v249
    v_cvt_pk_bf16_f32 v157, v250, v251
    v_cvt_pk_bf16_f32 v158, v252, v253
    v_cvt_pk_bf16_f32 v159, v254, v255
    s_nop 1
    v_permlane16_swap_b32 v156, v158
    v_permlane16_swap_b32 v157, v159
    s_nop 1
    buffer_store_dwordx4 v[156:159], v10, s[24:27], s49 offen offset:3072 sc0 sc1
    s_and_b32 s47, s88, 0xf0
    v_add_u32 v12, s47, v0
    v_lshlrev_b32 v12, 8, v12
    s_mul_i32 s50, s47, 163840
    s_lshr_b32 s48, s90, 1
    s_mul_i32 s48, s48, 20480
    s_add_u32 s50, s50, s48
    s_and_b32 s48, s90, 1
    s_mul_i32 s48, s48, 5
    s_add_u32 s51, s48, s92
    s_lshl_b32 s48, s51, 10
    s_add_u32 s50, s50, s48
    s_lshl_b32 s47, s89, 2
    s_bfe_u32 s48, s90, 0x20001
    s_add_u32 s47, s47, s48
    s_mul_i32 s47, s47, 81920
    s_mul_i32 s48, s91, 1280
    s_add_u32 s47, s47, s48
    s_lshr_b32 s48, s90, 3
    s_mul_i32 s48, s48, 640
    s_add_u32 s47, s47, s48
    s_lshl_b32 s48, s51, 5
    s_add_u32 s47, s47, s48
    s_add_u32 s51, s50, 10240
    v_and_b32 v2, 31, v0
    v_mul_u32_u24 v2, 2560, v2
    v_lshrrev_b32 v3, 5, v0
    v_lshl_add_u32 v2, v3, 4, v2
    s_mov_b32 s48, 0xffff0000
    s_waitcnt vmcnt(0)
    s_barrier
    s_cmp_lg_u32 s92, 7
    s_cbranch_scc1 L_skA
    s_mov_b64 exec, 1
    buffer_store_dword v11, off, s[84:87], s46 offset:4 sc0 sc1
    s_branch L_pkA
L_pcA:
    buffer_load_dword v13, off, s[40:43], 0 offset:252 sc0 sc1
    s_waitcnt vmcnt(0)
L_pkA:
    v_cmp_gt_u32 vcc, 256, v13
    s_cbranch_vccnz L_pcA
    s_mov_b64 exec, 0xffff
    s_bitset0_b32 exec_lo, s90
L_pfA:
    buffer_load_dwordx2 v[14:15], v12, s[84:87], 0 offen sc0 sc1
    s_waitcnt vmcnt(0)
L_pgA:
    v_cmp_ne_u32 vcc, 1, v14
    s_cbranch_vccnz L_pfA
    s_mov_b64 exec, -1
L_skA:
    s_barrier
    s_cmp_ge_u32 s92, 5
    s_cbranch_scc1 L_nold
    buffer_load_dwordx4 v[16:19], v10, s[24:27], s50 offen sc0 sc1
    s_add_u32 s50, s50, 163840
    buffer_load_dwordx4 v[20:23], v10, s[24:27], s50 offen sc0 sc1
    s_add_u32 s50, s50, 163840
    buffer_load_dwordx4 v[24:27], v10, s[24:27], s50 offen sc0 sc1
    s_add_u32 s50, s50, 163840
    buffer_load_dwordx4 v[28:31], v10, s[24:27], s50 offen sc0 sc1
    s_add_u32 s50, s50, 163840
    buffer_load_dwordx4 v[32:35], v10, s[24:27], s50 offen sc0 sc1
    s_add_u32 s50, s50, 163840
    buffer_load_dwordx4 v[36:39], v10, s[24:27], s50 offen sc0 sc1
    s_add_u32 s50, s50, 163840
    buffer_load_dwordx4 v[40:43], v10, s[24:27], s50 offen sc0 sc1
    s_add_u32 s50, s50, 163840
    buffer_load_dwordx4 v[44:47], v10, s[24:27], s50 offen sc0 sc1
    s_add_u32 s50, s50, 163840
    buffer_load_dwordx4 v[48:51], v10, s[24:27], s50 offen sc0 sc1
    s_add_u32 s50, s50, 163840
    buffer_load_dwordx4 v[52:55], v10, s[24:27], s50 offen sc0 sc1
    s_add_u32 s50, s50, 163840
    buffer_load_dwordx4 v[56:59], v10, s[24:27], s50 offen sc0 sc1
    s_add_u32 s50, s50, 163840
    buffer_load_dwordx4 v[60:63], v10, s[24:27], s50 offen sc0 sc1
    s_add_u32 s50, s50, 163840
    buffer_load_dwordx4 v[64:67], v10, s[24:27], s50 offen sc0 sc1
    s_add_u32 s50, s50, 163840
    buffer_load_dwordx4 v[68:71], v10, s[24:27], s50 offen sc0 sc1
    s_add_u32 s50, s50, 163840
    buffer_load_dwordx4 v[72:75], v10, s[24:27], s50 offen sc0 sc1
    s_add_u32 s50, s50, 163840
    buffer_load_dwordx4 v[76:79], v10, s[24:27], s50 offen sc0 sc1
    s_add_u32 s50, s50, 163840
L_nold:
    s_cmp_lg_u32 s92, 7
    s_cbranch_scc1 L_skB
    s_mov_b64 exec, 0xffff
    s_bitset0_b32 exec_lo, s90
    s_branch L_pgB
L_pfB:
    buffer_load_dwordx2 v[14:15], v12, s[84:87], 0 offen sc0 sc1
    s_waitcnt vmcnt(0)
L_pgB:
    v_cmp_ne_u32 vcc, 1, v15
    s_cbranch_vccnz L_pfB
    s_mov_b64 exec, -1
L_skB:
    s_barrier
    s_cmp_ge_u32 s92, 5
    s_cbranch_scc1 L_k1_end
    buffer_load_dwordx4 v[80:83], v10, s[24:27], s51 offen sc0 sc1
    s_add_u32 s51, s51, 163840
    buffer_load_dwordx4 v[84:87], v10, s[24:27], s51 offen sc0 sc1
    s_add_u32 s51, s51, 163840
    buffer_load_dwordx4 v[88:91], v10, s[24:27], s51 offen sc0 sc1
    s_add_u32 s51, s51, 163840
    buffer_load_dwordx4 v[92:95], v10, s[24:27], s51 offen sc0 sc1
    s_add_u32 s51, s51, 163840
    buffer_load_dwordx4 v[96:99], v10, s[24:27], s51 offen sc0 sc1
    s_add_u32 s51, s51, 163840
    buffer_load_dwordx4 v[100:103], v10, s[24:27], s51 offen sc0 sc1
    s_add_u32 s51, s51, 163840
    buffer_load_dwordx4 v[104:107], v10, s[24:27], s51 offen sc0 sc1
    s_add_u32 s51, s51, 163840
    buffer_load_dwordx4 v[108:111], v10, s[24:27], s51 offen sc0 sc1
    s_add_u32 s51, s51, 163840
    buffer_load_dwordx4 v[112:115], v10, s[24:27], s51 offen sc0 sc1
    s_add_u32 s51, s51, 163840
    buffer_load_dwordx4 v[116:119], v10, s[24:27], s51 offen sc0 sc1
    s_add_u32 s51, s51, 163840
    buffer_load_dwordx4 v[120:123], v10, s[24:27], s51 offen sc0 sc1
    s_add_u32 s51, s51, 163840
    buffer_load_dwordx4 v[124:127], v10, s[24:27], s51 offen sc0 sc1
    s_add_u32 s51, s51, 163840
    buffer_load_dwordx4 v[128:131], v10, s[24:27], s51 offen sc0 sc1
    s_add_u32 s51, s51, 163840
    buffer_load_dwordx4 v[132:135], v10, s[24:27], s51 offen sc0 sc1
    s_add_u32 s51, s51, 163840
    buffer_load_dwordx4 v[136:139], v10, s[24:27], s51 offen sc0 sc1
    s_add_u32 s51, s51, 163840
    buffer_load_dwordx4 v[140:143], v10, s[24:27], s51 offen sc0 sc1
    s_add_u32 s51, s51, 163840
    s_waitcnt vmcnt(28)
    v_lshlrev_b32 v160, 16, v16
    v_and_b32 v161, s48, v16
    v_lshlrev_b32 v162, 16, v17
    v_and_b32 v163, s48, v17
    v_lshlrev_b32 v164, 16, v18
    v_and_b32 v165, s48, v18
    v_lshlrev_b32 v166, 16, v19
    v_and_b32 v167, s48, v19
    v_lshlrev_b32 v168, 16, v20
    v_and_b32 v20, s48, v20
    v_add_f32 v160, v160, v168
    v_add_f32 v161, v161, v20
    v_lshlrev_b32 v170, 16, v21
    v_and_b32 v21, s48, v21
    v_add_f32 v162, v162, v170
    v_add_f32 v163, v163, v21
    v_lshlrev_b32 v172, 16, v22
    v_and_b32 v22, s48, v22
    v_add_f32 v164, v164, v172
    v_add_f32 v165, v165, v22
    v_lshlrev_b32 v174, 16, v23
    v_and_b32 v23, s48, v23
    v_add_f32 v166, v166, v174
    v_add_f32 v167, v167, v23
    v_lshlrev_b32 v168, 16, v24
    v_and_b32 v24, s48, v24
    v_add_f32 v160, v160, v168
    v_add_f32 v161, v161, v24
    v_lshlrev_b32 v170, 16, v25
    v_and_b32 v25, s48, v25
    v_add_f32 v162, v162, v170
    v_add_f32 v163, v163, v25
    v_lshlrev_b32 v172, 16, v26
    v_and_b32 v26, s48, v26
    v_add_f32 v164, v164, v172
    v_add_f32 v165, v165, v26
    v_lshlrev_b32 v174, 16, v27
    v_and_b32 v27, s48, v27
    v_add_f32 v166, v166, v174
    v_add_f32 v167, v167, v27
    v_lshlrev_b32 v168, 16, v28
    v_and_b32 v28, s48, v28
    v_add_f32 v160, v160, v168
    v_add_f32 v161, v161, v28
    v_lshlrev_b32 v170, 16, v29
    v_and_b32 v29, s48, v29
    v_add_f32 v162, v162, v170
    v_add_f32 v163, v163, v29
    v_lshlrev_b32 v172, 16, v30
    v_and_b32 v30, s48, v30
    v_add_f32 v164, v164, v172
    v_add_f32 v165, v165, v30
    v_lshlrev_b32 v174, 16, v31
    v_and_b32 v31, s48, v31
    v_add_f32 v166, v166, v174
    v_add_f32 v167, v167, v31
    s_waitcnt vmcnt(24)
    v_lshlrev_b32 v168, 16, v32
    v_and_b32 v32, s48, v32
    v_add_f32 v160, v160, v168
    v_add_f32 v161, v161, v32
    v_lshlrev_b32 v170, 16, v33
    v_and_b32 v33, s48, v33
    v_add_f32 v162, v162, v170
    v_add_f32 v163, v163, v33
    v_lshlrev_b32 v172, 16, v34
    v_and_b32 v34, s48, v34
    v_add_f32 v164, v164, v172
    v_add_f32 v165, v165, v34
    v_lshlrev_b32 v174, 16, v35
    v_and_b32 v35, s48, v35
    v_add_f32 v166, v166, v174
    v_add_f32 v167, v167, v35
    v_lshlrev_b32 v168, 16, v36
    v_and_b32 v36, s48, v36
    v_add_f32 v160, v160, v168
    v_add_f32 v161, v161, v36
    v_lshlrev_b32 v170, 16, v37
    v_and_b32 v37, s48, v37
    v_add_f32 v162, v162, v170
    v_add_f32 v163, v163, v37
    v_lshlrev_b32 v172, 16, v38
    v_and_b32 v38, s48, v38
    v_add_f32 v164, v164, v172
    v_add_f32 v165, v165, v38
    v_lshlrev_b32 v174, 16, v39
    v_and_b32 v39, s48, v39
    v_add_f32 v166, v166, v174
    v_add_f32 v167, v167, v39
    v_lshlrev_b32 v168, 16, v40
    v_and_b32 v40, s48, v40
    v_add_f32 v160, v160, v168
    v_add_f32 v161, v161, v40
    v_lshlrev_b32 v170, 16, v41
    v_and_b32 v41, s48, v41
    v_add_f32 v162, v162, v170
    v_add_f32 v163, v163, v41
    v_lshlrev_b32 v172, 16, v42
    v_and_b32 v42, s48, v42
    v_add_f32 v164, v164, v172
    v_add_f32 v165, v165, v42
    v_lshlrev_b32 v174, 16, v43
    v_and_b32 v43, s48, v43
    v_add_f32 v166, v166, v174
    v_add_f32 v167, v167, v43
    v_lshlrev_b32 v168, 16, v44
    v_and_b32 v44, s48, v44
    v_add_f32 v160, v160, v168
    v_add_f32 v161, v161, v44
    v_lshlrev_b32 v170, 16, v45
    v_and_b32 v45, s48, v45
    v_add_f32 v162, v162, v170
    v_add_f32 v163, v163, v45
    v_lshlrev_b32 v172, 16, v46
    v_and_b32 v46, s48, v46
    v_add_f32 v164, v164, v172
    v_add_f32 v165, v165, v46
    v_lshlrev_b32 v174, 16, v47
    v_and_b32 v47, s48, v47
    v_add_f32 v166, v166, v174
    v_add_f32 v167, v167, v47
    s_waitcnt vmcnt(20)
    v_lshlrev_b32 v168, 16, v48
    v_and_b32 v48, s48, v48
    v_add_f32 v160, v160, v168
    v_add_f32 v161, v161, v48
    v_lshlrev_b32 v170, 16, v49
    v_and_b32 v49, s48, v49
    v_add_f32 v162, v162, v170
    v_add_f32 v163, v163, v49
    v_lshlrev_b32 v172, 16, v50
    v_and_b32 v50, s48, v50
    v_add_f32 v164, v164, v172
    v_add_f32 v165, v165, v50
    v_lshlrev_b32 v174, 16, v51
    v_and_b32 v51, s48, v51
    v_add_f32 v166, v166, v174
    v_add_f32 v167, v167, v51
    v_lshlrev_b32 v168, 16, v52
    v_and_b32 v52, s48, v52
    v_add_f32 v160, v160, v168
    v_add_f32 v161, v161, v52
    v_lshlrev_b32 v170, 16, v53
    v_and_b32 v53, s48, v53
    v_add_f32 v162, v162, v170
    v_add_f32 v163, v163, v53
    v_lshlrev_b32 v172, 16, v54
    v_and_b32 v54, s48, v54
    v_add_f32 v164, v164, v172
    v_add_f32 v165, v165, v54
    v_lshlrev_b32 v174, 16, v55
    v_and_b32 v55, s48, v55
    v_add_f32 v166, v166, v174
    v_add_f32 v167, v167, v55
    v_lshlrev_b32 v168, 16, v56
    v_and_b32 v56, s48, v56
    v_add_f32 v160, v160, v168
    v_add_f32 v161, v161, v56
    v_lshlrev_b32 v170, 16, v57
    v_and_b32 v57, s48, v57
    v_add_f32 v162, v162, v170
    v_add_f32 v163, v163, v57
    v_lshlrev_b32 v172, 16, v58
    v_and_b32 v58, s48, v58
    v_add_f32 v164, v164, v172
    v_add_f32 v165, v165, v58
    v_lshlrev_b32 v174, 16, v59
    v_and_b32 v59, s48, v59
    v_add_f32 v166, v166, v174
    v_add_f32 v167, v167, v59
    v_lshlrev_b32 v168, 16, v60
    v_and_b32 v60, s48, v60
    v_add_f32 v160, v160, v168
    v_add_f32 v161, v161, v60
    v_lshlrev_b32 v170, 16, v61
    v_and_b32 v61, s48, v61
    v_add_f32 v162, v162, v170
    v_add_f32 v163, v163, v61
    v_lshlrev_b32 v172, 16, v62
    v_and_b32 v62, s48, v62
    v_add_f32 v164, v164, v172
    v_add_f32 v165, v165, v62
    v_lshlrev_b32 v174, 16, v63
    v_and_b32 v63, s48, v63
    v_add_f32 v166, v166, v174
    v_add_f32 v167, v167, v63
    s_waitcnt vmcnt(16)
    v_lshlrev_b32 v168, 16, v64
    v_and_b32 v64, s48, v64
    v_add_f32 v160, v160, v168
    v_add_f32 v161, v161, v64
    v_lshlrev_b32 v170, 16, v65
    v_and_b32 v65, s48, v65
    v_add_f32 v162, v162, v170
    v_add_f32 v163, v163, v65
    v_lshlrev_b32 v172, 16, v66
    v_and_b32 v66, s48, v66
    v_add_f32 v164, v164, v172
    v_add_f32 v165, v165, v66
    v_lshlrev_b32 v174, 16, v67
    v_and_b32 v67, s48, v67
    v_add_f32 v166, v166, v174
    v_add_f32 v167, v167, v67
    v_lshlrev_b32 v168, 16, v68
    v_and_b32 v68, s48, v68
    v_add_f32 v160, v160, v168
    v_add_f32 v161, v161, v68
    v_lshlrev_b32 v170, 16, v69
    v_and_b32 v69, s48, v69
    v_add_f32 v162, v162, v170
    v_add_f32 v163, v163, v69
    v_lshlrev_b32 v172, 16, v70
    v_and_b32 v70, s48, v70
    v_add_f32 v164, v164, v172
    v_add_f32 v165, v165, v70
    v_lshlrev_b32 v174, 16, v71
    v_and_b32 v71, s48, v71
    v_add_f32 v166, v166, v174
    v_add_f32 v167, v167, v71
    v_lshlrev_b32 v168, 16, v72
    v_and_b32 v72, s48, v72
    v_add_f32 v160, v160, v168
    v_add_f32 v161, v161, v72
    v_lshlrev_b32 v170, 16, v73
    v_and_b32 v73, s48, v73
    v_add_f32 v162, v162, v170
    v_add_f32 v163, v163, v73
    v_lshlrev_b32 v172, 16, v74
    v_and_b32 v74, s48, v74
    v_add_f32 v164, v164, v172
    v_add_f32 v165, v165, v74
    v_lshlrev_b32 v174, 16, v75
    v_and_b32 v75, s48, v75
    v_add_f32 v166, v166, v174
    v_add_f32 v167, v167, v75
    v_lshlrev_b32 v168, 16, v76
    v_and_b32 v76, s48, v76
    v_add_f32 v160, v160, v168
    v_add_f32 v161, v161, v76
    v_lshlrev_b32 v170, 16, v77
    v_and_b32 v77, s48, v77
    v_add_f32 v162, v162, v170
    v_add_f32 v163, v163, v77
    v_lshlrev_b32 v172, 16, v78
    v_and_b32 v78, s48, v78
    v_add_f32 v164, v164, v172
    v_add_f32 v165, v165, v78
    v_lshlrev_b32 v174, 16, v79
    v_and_b32 v79, s48, v79
    v_add_f32 v166, v166, v174
    v_add_f32 v167, v167, v79
    v_cvt_pk_bf16_f32 v168, v160, v161
    v_cvt_pk_bf16_f32 v169, v162, v163
    v_cvt_pk_bf16_f32 v170, v164, v165
    v_cvt_pk_bf16_f32 v171, v166, v167
    buffer_store_dwordx4 v[168:171], v2, s[8:11], s47 offen offset:0
    s_waitcnt vmcnt(13)
    v_lshlrev_b32 v176, 16, v80
    v_and_b32 v177, s48, v80
    v_lshlrev_b32 v178, 16, v81
    v_and_b32 v179, s48, v81
    v_lshlrev_b32 v180, 16, v82
    v_and_b32 v181, s48, v82
    v_lshlrev_b32 v182, 16, v83
    v_and_b32 v183, s48, v83
    v_lshlrev_b32 v184, 16, v84
    v_and_b32 v84, s48, v84
    v_add_f32 v176, v176, v184
    v_add_f32 v177, v177, v84
    v_lshlrev_b32 v186, 16, v85
    v_and_b32 v85, s48, v85
    v_add_f32 v178, v178, v186
    v_add_f32 v179, v179, v85
    v_lshlrev_b32 v188, 16, v86
    v_and_b32 v86, s48, v86
    v_add_f32 v180, v180, v188
    v_add_f32 v181, v181, v86
    v_lshlrev_b32 v190, 16, v87
    v_and_b32 v87, s48, v87
    v_add_f32 v182, v182, v190
    v_add_f32 v183, v183, v87
    v_lshlrev_b32 v184, 16, v88
    v_and_b32 v88, s48, v88
    v_add_f32 v176, v176, v184
    v_add_f32 v177, v177, v88
    v_lshlrev_b32 v186, 16, v89
    v_and_b32 v89, s48, v89
    v_add_f32 v178, v178, v186
    v_add_f32 v179, v179, v89
    v_lshlrev_b32 v188, 16, v90
    v_and_b32 v90, s48, v90
    v_add_f32 v180, v180, v188
    v_add_f32 v181, v181, v90
    v_lshlrev_b32 v190, 16, v91
    v_and_b32 v91, s48, v91
    v_add_f32 v182, v182, v190
    v_add_f32 v183, v183, v91
    v_lshlrev_b32 v184, 16, v92
    v_and_b32 v92, s48, v92
    v_add_f32 v176, v176, v184
    v_add_f32 v177, v177, v92
    v_lshlrev_b32 v186, 16, v93
    v_and_b32 v93, s48, v93
    v_add_f32 v178, v178, v186
    v_add_f32 v179, v179, v93
    v_lshlrev_b32 v188, 16, v94
    v_and_b32 v94, s48, v94
    v_add_f32 v180, v180, v188
    v_add_f32 v181, v181, v94
    v_lshlrev_b32 v190, 16, v95
    v_and_b32 v95, s48, v95
    v_add_f32 v182, v182, v190
    v_add_f32 v183, v183, v95
    s_waitcnt vmcnt(9)
    v_lshlrev_b32 v184, 16, v96
    v_and_b32 v96, s48, v96
    v_add_f32 v176, v176, v184
    v_add_f32 v177, v177, v96
    v_lshlrev_b32 v186, 16, v97
    v_and_b32 v97, s48, v97
    v_add_f32 v178, v178, v186
    v_add_f32 v179, v179, v97
    v_lshlrev_b32 v188, 16, v98
    v_and_b32 v98, s48, v98
    v_add_f32 v180, v180, v188
    v_add_f32 v181, v181, v98
    v_lshlrev_b32 v190, 16, v99
    v_and_b32 v99, s48, v99
    v_add_f32 v182, v182, v190
    v_add_f32 v183, v183, v99
    v_lshlrev_b32 v184, 16, v100
    v_and_b32 v100, s48, v100
    v_add_f32 v176, v176, v184
    v_add_f32 v177, v177, v100
    v_lshlrev_b32 v186, 16, v101
    v_and_b32 v101, s48, v101
    v_add_f32 v178, v178, v186
    v_add_f32 v179, v179, v101
    v_lshlrev_b32 v188, 16, v102
    v_and_b32 v102, s48, v102
    v_add_f32 v180, v180, v188
    v_add_f32 v181, v181, v102
    v_lshlrev_b32 v190, 16, v103
    v_and_b32 v103, s48, v103
    v_add_f32 v182, v182, v190
    v_add_f32 v183, v183, v103
    v_lshlrev_b32 v184, 16, v104
    v_and_b32 v104, s48, v104
    v_add_f32 v176, v176, v184
    v_add_f32 v177, v177, v104
    v_lshlrev_b32 v186, 16, v105
    v_and_b32 v105, s48, v105
    v_add_f32 v178, v178, v186
    v_add_f32 v179, v179, v105
    v_lshlrev_b32 v188, 16, v106
    v_and_b32 v106, s48, v106
    v_add_f32 v180, v180, v188
    v_add_f32 v181, v181, v106
    v_lshlrev_b32 v190, 16, v107
    v_and_b32 v107, s48, v107
    v_add_f32 v182, v182, v190
    v_add_f32 v183, v183, v107
    v_lshlrev_b32 v184, 16, v108
    v_and_b32 v108, s48, v108
    v_add_f32 v176, v176, v184
    v_add_f32 v177, v177, v108
    v_lshlrev_b32 v186, 16, v109
    v_and_b32 v109, s48, v109
    v_add_f32 v178, v178, v186
    v_add_f32 v179, v179, v109
    v_lshlrev_b32 v188, 16, v110
    v_and_b32 v110, s48, v110
    v_add_f32 v180, v180, v188
    v_add_f32 v181, v181, v110
    v_lshlrev_b32 v190, 16, v111
    v_and_b32 v111, s48, v111
    v_add_f32 v182, v182, v190
    v_add_f32 v183, v183, v111
    s_waitcnt vmcnt(5)
    v_lshlrev_b32 v184, 16, v112
    v_and_b32 v112, s48, v112
    v_add_f32 v176, v176, v184
    v_add_f32 v177, v177, v112
    v_lshlrev_b32 v186, 16, v113
    v_and_b32 v113, s48, v113
    v_add_f32 v178, v178, v186
    v_add_f32 v179, v179, v113
    v_lshlrev_b32 v188, 16, v114
    v_and_b32 v114, s48, v114
    v_add_f32 v180, v180, v188
    v_add_f32 v181, v181, v114
    v_lshlrev_b32 v190, 16, v115
    v_and_b32 v115, s48, v115
    v_add_f32 v182, v182, v190
    v_add_f32 v183, v183, v115
    v_lshlrev_b32 v184, 16, v116
    v_and_b32 v116, s48, v116
    v_add_f32 v176, v176, v184
    v_add_f32 v177, v177, v116
    v_lshlrev_b32 v186, 16, v117
    v_and_b32 v117, s48, v117
    v_add_f32 v178, v178, v186
    v_add_f32 v179, v179, v117
    v_lshlrev_b32 v188, 16, v118
    v_and_b32 v118, s48, v118
    v_add_f32 v180, v180, v188
    v_add_f32 v181, v181, v118
    v_lshlrev_b32 v190, 16, v119
    v_and_b32 v119, s48, v119
    v_add_f32 v182, v182, v190
    v_add_f32 v183, v183, v119
    v_lshlrev_b32 v184, 16, v120
    v_and_b32 v120, s48, v120
    v_add_f32 v176, v176, v184
    v_add_f32 v177, v177, v120
    v_lshlrev_b32 v186, 16, v121
    v_and_b32 v121, s48, v121
    v_add_f32 v178, v178, v186
    v_add_f32 v179, v179, v121
    v_lshlrev_b32 v188, 16, v122
    v_and_b32 v122, s48, v122
    v_add_f32 v180, v180, v188
    v_add_f32 v181, v181, v122
    v_lshlrev_b32 v190, 16, v123
    v_and_b32 v123, s48, v123
    v_add_f32 v182, v182, v190
    v_add_f32 v183, v183, v123
    v_lshlrev_b32 v184, 16, v124
    v_and_b32 v124, s48, v124
    v_add_f32 v176, v176, v184
    v_add_f32 v177, v177, v124
    v_lshlrev_b32 v186, 16, v125
    v_and_b32 v125, s48, v125
    v_add_f32 v178, v178, v186
    v_add_f32 v179, v179, v125
    v_lshlrev_b32 v188, 16, v126
    v_and_b32 v126, s48, v126
    v_add_f32 v180, v180, v188
    v_add_f32 v181, v181, v126
    v_lshlrev_b32 v190, 16, v127
    v_and_b32 v127, s48, v127
    v_add_f32 v182, v182, v190
    v_add_f32 v183, v183, v127
    s_waitcnt vmcnt(1)
    v_lshlrev_b32 v184, 16, v128
    v_and_b32 v128, s48, v128
    v_add_f32 v176, v176, v184
    v_add_f32 v177, v177, v128
    v_lshlrev_b32 v186, 16, v129
    v_and_b32 v129, s48, v129
    v_add_f32 v178, v178, v186
    v_add_f32 v179, v179, v129
    v_lshlrev_b32 v188, 16, v130
    v_and_b32 v130, s48, v130
    v_add_f32 v180, v180, v188
    v_add_f32 v181, v181, v130
    v_lshlrev_b32 v190, 16, v131
    v_and_b32 v131, s48, v131
    v_add_f32 v182, v182, v190
    v_add_f32 v183, v183, v131
    v_lshlrev_b32 v184, 16, v132
    v_and_b32 v132, s48, v132
    v_add_f32 v176, v176, v184
    v_add_f32 v177, v177, v132
    v_lshlrev_b32 v186, 16, v133
    v_and_b32 v133, s48, v133
    v_add_f32 v178, v178, v186
    v_add_f32 v179, v179, v133
    v_lshlrev_b32 v188, 16, v134
    v_and_b32 v134, s48, v134
    v_add_f32 v180, v180, v188
    v_add_f32 v181, v181, v134
    v_lshlrev_b32 v190, 16, v135
    v_and_b32 v135, s48, v135
    v_add_f32 v182, v182, v190
    v_add_f32 v183, v183, v135
    v_lshlrev_b32 v184, 16, v136
    v_and_b32 v136, s48, v136
    v_add_f32 v176, v176, v184
    v_add_f32 v177, v177, v136
    v_lshlrev_b32 v186, 16, v137
    v_and_b32 v137, s48, v137
    v_add_f32 v178, v178, v186
    v_add_f32 v179, v179, v137
    v_lshlrev_b32 v188, 16, v138
    v_and_b32 v138, s48, v138
    v_add_f32 v180, v180, v188
    v_add_f32 v181, v181, v138
    v_lshlrev_b32 v190, 16, v139
    v_and_b32 v139, s48, v139
    v_add_f32 v182, v182, v190
    v_add_f32 v183, v183, v139
    v_lshlrev_b32 v184, 16, v140
    v_and_b32 v140, s48, v140
    v_add_f32 v176, v176, v184
    v_add_f32 v177, v177, v140
    v_lshlrev_b32 v186, 16, v141
    v_and_b32 v141, s48, v141
    v_add_f32 v178, v178, v186
    v_add_f32 v179, v179, v141
    v_lshlrev_b32 v188, 16, v142
    v_and_b32 v142, s48, v142
    v_add_f32 v180, v180, v188
    v_add_f32 v181, v181, v142
    v_lshlrev_b32 v190, 16, v143
    v_and_b32 v143, s48, v143
    v_add_f32 v182, v182, v190
    v_add_f32 v183, v183, v143
    v_cvt_pk_bf16_f32 v184, v176, v177
    v_cvt_pk_bf16_f32 v185, v178, v179
    v_cvt_pk_bf16_f32 v186, v180, v181
    v_cvt_pk_bf16_f32 v187, v182, v183
    buffer_store_dwordx4 v[184:187], v2, s[8:11], s47 offen offset:320
L_k1_end:
    s_endpgm
.section .rodata,"a"
.p2align 6
.amdhsa_kernel concat_heads__mha_block_cached__mha_block_cached__near_ridge_kernel
  .amdhsa_next_free_vgpr 256
  .amdhsa_next_free_sgpr 102
  .amdhsa_accum_offset 256
  .amdhsa_group_segment_fixed_size 0
  .amdhsa_kernarg_size 104
  .amdhsa_user_sgpr_count 2
  .amdhsa_user_sgpr_kernarg_segment_ptr 1
  .amdhsa_system_sgpr_workgroup_id_x 1
.end_amdhsa_kernel
```
